```python
import torch

def _softmax(x, axis=-1):
    return torch.softmax(x, dim=axis)

def _gelu(x):
    return torch.nn.functional.gelu(x, approximate='tanh')

def _silu(x):
    return torch.nn.functional.silu(x)

def _sigmoid(x):
    return torch.sigmoid(x)

def _layernorm(x, axis=-1, eps=1e-05):
    m = x.mean(dim=axis, keepdim=True)
    v = x.var(dim=axis, keepdim=True, unbiased=False)
    return (x - m) / torch.sqrt(v + eps)

def _scatter_add(tgt, idx, src, axis=0):
    return tgt.clone().index_add_(axis, idx, src)

def _segment_sum(src, seg, n):
    out = torch.zeros((n,) + src.shape[1:], dtype=src.dtype)
    return out.index_add_(0, seg, src)

def _pad(x, pw):
    flat = tuple((v for pair in reversed(pw) for v in pair))
    return torch.nn.functional.pad(x, flat)
kernel_name = 'adaLN_cond__grouped_kv_mqa__glu_gated_reglu__prompt'

def setup_inputs():

    _w = lambda a: (lambda t: t.to(torch.bfloat16) if t.is_floating_point() else t)(torch.as_tensor(a))

    def _A_setup():
        B, S, D, H = (1, 2048, 448, 16)
        Dh = D // H
        return {'x': _w((lambda *s: torch.randn(*s, dtype=torch.bfloat16) * 0.05)(B, S, D)), 'wq': _w((lambda *s: torch.randn(*s, dtype=torch.bfloat16) * 0.05)(D, H * Dh)), 'wk': _w((lambda *s: torch.randn(*s, dtype=torch.bfloat16) * 0.05)(D, Dh)), 'wv': _w((lambda *s: torch.randn(*s, dtype=torch.bfloat16) * 0.05)(D, Dh)), 'wo': _w((lambda *s: torch.randn(*s, dtype=torch.bfloat16) * 0.05)(H * Dh, D))}
    _A_in = _A_setup()

    def _B_setup():
        B, S, D, F = (1, 2048, 448, 1792)
        return {'x': _w((lambda *s: torch.randn(*s, dtype=torch.bfloat16) * 0.05)(B, S, D)), 'W_gate': _w((lambda *s: torch.randn(*s, dtype=torch.bfloat16) * 0.8)(D, F) * (2.0 / D) ** 0.5), 'W_up': _w((lambda *s: torch.randn(*s, dtype=torch.bfloat16) * 0.8)(D, F) * (2.0 / D) ** 0.5), 'W_down': _w((lambda *s: torch.randn(*s, dtype=torch.bfloat16) * 0.8)(F, D) * (1.0 / F) ** 0.5)}
    _B_in = _B_setup()
    return {'A_x': _A_in['x'], 'A_wq': _A_in['wq'], 'A_wk': _A_in['wk'], 'A_wv': _A_in['wv'], 'A_wo': _A_in['wo'], 'B_x': _B_in['x'], 'B_W_gate': _B_in['W_gate'], 'B_W_up': _B_in['W_up'], 'B_W_down': _B_in['W_down'], 'c': _w((lambda *s: torch.randn(*s, dtype=torch.bfloat16) * 0.2)(1, 448) * 8.0), 'w_mod': _w((lambda *s: torch.randn(*s, dtype=torch.bfloat16) * 0.2)(448, 6 * 448) * 448 ** (-0.5) * 8.0)}

def reference(A_x, A_wq, A_wk, A_wv, A_wo, B_x, B_W_gate, B_W_up, B_W_down, c, w_mod):

    def _A_ref(x, wq, wk, wv, wo):
        B, S, D = x.shape
        H = 16
        Dh = D // H
        q = (lambda x, *d: x.permute(*d))((x @ wq).reshape(B, S, H, Dh), 0, 2, 1, 3)
        k = x @ wk
        v = x @ wv
        scores = torch.einsum('bhqd,bkd->bhqk', q, k) * Dh ** (-0.5)
        p = _softmax(scores, axis=-1)
        o = torch.einsum('bhqk,bkd->bhqd', p, v)
        return (lambda x, *d: x.permute(*d))(o, 0, 2, 1, 3).reshape(B, S, H * Dh) @ wo

    def _B_ref(x, W_gate, W_up, W_down):
        gate = torch.einsum('bsd,df->bsf', x, W_gate)
        up = torch.einsum('bsd,df->bsf', x, W_up)
        gate = gate * (lambda x, dt: x.to(dt))(gate > 0, gate.dtype)
        h = gate * up
        return torch.einsum('bsf,fd->bsd', h, W_down)
    x = A_x
    mod = (_silu(c) @ w_mod).reshape(c.shape[0], 6, 1, -1)
    sa, ca, ga, sb, cb, gb = (mod[:, 0].clone(), mod[:, 1].clone(), mod[:, 2].clone(), mod[:, 3].clone(), mod[:, 4].clone(), mod[:, 5].clone())
    h = _layernorm(x, axis=-1) * (1 + ca) + sa
    x = x + ga * _A_ref(h, A_wq, A_wk, A_wv, A_wo)
    h = _layernorm(x, axis=-1) * (1 + cb) + sb
    x = x + gb * _B_ref(h, B_W_gate, B_W_up, B_W_down)
    return x
```

```asm
; @launch grid=(256,1,1) block=(256,1,1) lds=163840
.amdgcn_target "amdgcn-amd-amdhsa--gfx950"
.text
.globl adaLN_cond__grouped_kv_mqa__glu_gated_reglu__prompt_kernel
.p2align 12
.p2align 8
.type adaLN_cond__grouped_kv_mqa__glu_gated_reglu__prompt_kernel,@function
adaLN_cond__grouped_kv_mqa__glu_gated_reglu__prompt_kernel:
    s_cmp_ge_u32 s2, 256
    s_cbranch_scc1 L_end
    s_load_dwordx4 s[28:31], s[0:1], 96
    s_load_dwordx8 s[20:27], s[0:1], 64
    s_load_dwordx16 s[4:19], s[0:1], 0
    s_getpc_b64 s[48:49]
L_pc:
    v_lshlrev_b32 v206, 3, v0
    s_lshl_b32 s70, s2, 8
    s_and_b32 s70, s70, 0xf800
    s_mov_b32 s50, L_code_end-L_pc
    s_mov_b32 s51, 0x20000
    buffer_load_dword v206, v206, s[48:51], s70 offen
    v_lshrrev_b32 v2, 6, v0
    v_and_b32 v1, 63, v0
    s_and_b32 s55, s2, 7
    v_readfirstlane_b32 s53, v2
    s_lshr_b32 s56, s2, 3
    s_lshl_b32 s52, s55, 5
    s_add_u32 s52, s52, s56
    s_mov_b32 s61, 0xffff0000
    s_mov_b32 s63, 0
    v_lshrrev_b32 v3, 2, v1
    v_and_b32 v4, 3, v1
    v_mul_u32_u24 v3, 5376, v3
    v_lshl_add_u32 v200, v4, 4, v3
    v_min_u32 v4, 55, v1
    s_sub_u32 s65, s52, 32
    s_lshr_b32 s66, s65, 1
    s_bitcmp1_b32 s52, 0
    s_cselect_b32 s66, 255, s66
    s_min_u32 s66, s66, 255
    s_mul_i32 s68, s66, 2341
    s_lshr_b32 s68, s68, 16
    s_mul_i32 s69, s68, 28
    s_sub_u32 s69, s66, s69
    s_mul_i32 s70, s68, 224
    v_lshl_add_u32 v201, v4, 2, s70
    s_mul_i32 s64, s68, 602112
    s_lshl_b32 s70, s69, 6
    s_add_u32 s64, s64, s70
    s_cmp_lt_u32 s66, 112
    s_cselect_b32 s67, 1, 0
    s_cmp_lt_u32 s65, 224
    s_cselect_b32 s70, 0x3000, 0
    s_or_b32 s67, s67, s70
    s_lshl_b32 s71, s53, 2
    s_lshr_b32 s67, s67, s71
    s_and_b32 s67, s67, 15
    s_mov_b32 m0, 114688
    s_lshl_b32 s66, s69, 2
    s_add_u32 s66, s66, s68
    s_lshr_b32 s77, s52, 2
    s_and_b32 s81, s77, 7
    s_lshl_b32 s77, s77, 2
    s_add_u32 s77, s77, s53
    s_mul_i32 s77, s77, 7168
    v_lshlrev_b32 v13, 4, v1
    v_mov_b32 v2, 1879048192
    v_cmp_gt_u32 vcc, 56, v1
    v_add_u32 v177, s77, v13
    s_movk_i32 s72, 3584
    v_cndmask_b32_e64 v177, v2, v177, vcc
    s_and_b32 s76, s52, 3
    s_lshl_b32 s76, s76, 2
    s_add_u32 s76, s76, s53
    s_lshr_b32 s78, s76, 1
    s_lshl_b32 s78, s78, 7
    s_and_b32 s73, s53, 1
    s_mul_i32 s71, s73, 7168
    s_add_u32 s78, s78, s71
    s_cmp_lt_u32 s76, 14
    s_mov_b32 s70, 401792
    s_cselect_b32 s46, s70, 25472
    s_mov_b32 s47, 0x20000
    s_cselect_b32 s78, s78, 0
    s_cselect_b32 s70, 896, 56
    s_cselect_b64 vcc, -1, 0
    s_lshl_b32 s80, s70, 6
    s_mul_i32 s81, s81, 7
    s_lshr_b32 s81, s81, 3
    s_mul_i32 s79, s81, s80
    s_add_u32 s79, s79, s78
    s_mul_i32 s77, s80, 7
    s_add_u32 s77, s77, s78
    v_lshrrev_b32 v176, 3, v1
    v_lshrrev_b32 v204, 2, v1
    v_and_b32 v205, 4, v204
    v_xor_b32 v205, v205, v1
    v_and_b32 v205, 7, v205
    v_mul_u32_u24 v176, 896, v176
    v_lshl_add_u32 v176, v205, 4, v176
    v_and_b32_e64 v204, 3, v204
    v_bfe_u32 v205, v1, 4, 1
    v_lshl_add_u32 v178, v205, 3, v204
    v_lshrrev_b32 v179, 5, v1
    v_lshl_add_u32 v178, v179, 2, v178
    v_mul_u32_u24 v178, 56, v178
    v_and_b32_e64 v180, 3, v1
    v_lshl_add_u32 v178, v180, 4, v178
    v_cndmask_b32 v176, v178, v176, vcc
    s_lshl_b32 s70, s70, 4
    s_sub_u32 s70, s70, 1024
    v_add_u32 v176, 384, v176
    v_add_u32 v208, s70, v176
    v_add_u32 v209, s70, v208
    v_add_u32 v210, s70, v209
    v_mul_u32_u24 v178, 224, v179
    v_add_u32 v178, v178, v204
    v_lshrrev_b32 v180, 1, v204
    v_xor_b32 v180, s73, v180
    v_lshl_add_u32 v178, v178, 1, v180
    v_lshl_add_u32 v179, v179, 2, v204
    s_mul_i32 s73, s73, 448
    v_add_u32 v179, s73, v179
    v_cndmask_b32 v178, v179, v178, vcc
    v_lshl_add_u32 v178, v178, 1, v205
    v_and_b32_e64 v204, 1, v1
    v_lshl_add_u32 v178, v178, 1, v204
    v_bfe_u32 v204, v1, 1, 1
    v_lshl_add_u32 v178, v178, 1, v204
    s_lshr_b32 s70, s53, 1
    s_mul_i32 s70, s70, 57344
    v_lshl_add_u32 v178, v178, 3, s70
    s_lshl_b32 s70, s81, 3
    v_subrev_u32 v179, s70, v1
    v_add_u32 v204, 56, v179
    v_min_u32 v179, v179, v204
    v_cmp_gt_u32 vcc, 56, v1
    s_mul_i32 s71, s53, 7296
    s_add_u32 s71, s71, 114688
    v_cndmask_b32 v179, 56, v179, vcc
    v_lshl_add_u32 v179, v179, 4, s71
    v_and_b32 v204, 31, v1
    v_lshrrev_b32_e64 v205, 5, v1
    v_mul_u32_u24 v180, 912, v204
    v_bfe_u32 v181, v1, 4, 1
    v_mul_u32_u24 v181, 43008, v181
    v_lshl_add_u32 v180, v205, 4, v180
    v_lshl_add_u32 v181, v205, 8, v181
    v_and_b32 v205, 15, v1
    v_lshl_add_u32 v181, v205, 3, v181
    v_add_u32 v180, 114688, v180
    s_lshl_b32 s70, s55, 7
    s_add_u32 s70, s70, 1024
    v_lshl_add_u32 v184, v204, 2, s70
    v_lshlrev_b32_e64 v182, 5, v1
    v_add_u32 v182, 143872, v182
    v_min_u32 v186, 223, v0
    v_lshrrev_b32 v183, 3, v186
    v_and_b32 v204, 7, v186
    v_lshlrev_b32_e64 v183, 9, v183
    v_lshl_add_u32 v183, v204, 4, v183
    v_cmp_le_u32 vcc, 112, v186
    v_add_u32 v183, 98304, v183
    v_lshlrev_b32_e64 v185, 4, v186
    v_add_u32 v185, 143872, v185
    v_cndmask_b32 v186, 0, 1.0, vcc
    s_waitcnt lgkmcnt(0)
    s_mov_b32 s40, s24
    s_mov_b32 s41, s25
    s_mov_b32 s42, 2408448
    s_mov_b32 s43, 0x20000
    s_cmp_eq_u32 s67, 1
    s_cbranch_scc0 L_skip_p0c_1
    global_load_dword v202, v201, s[22:23]
    buffer_load_dwordx4 v200, s[40:43], s64 offen offset:0 lds
    s_add_u32 s64, s64, 84992
    buffer_load_dwordx4 v200, s[40:43], s64 offen offset:1024 lds
    s_add_u32 s64, s64, 84992
    buffer_load_dwordx4 v200, s[40:43], s64 offen offset:2048 lds
    s_add_u32 s64, s64, 84992
    buffer_load_dwordx4 v200, s[40:43], s64 offen offset:3072 lds
    s_add_u32 s64, s64, 89088
    s_mov_b32 m0, 118784
    s_nop 0
    buffer_load_dwordx4 v200, s[40:43], s64 offen offset:0 lds
    s_add_u32 s64, s64, 84992
    buffer_load_dwordx4 v200, s[40:43], s64 offen offset:1024 lds
    s_add_u32 s64, s64, 84992
    buffer_load_dwordx4 v200, s[40:43], s64 offen offset:2048 lds
L_skip_p0c_1:
    s_load_dword s3, s[30:31], 0
    s_mov_b32 s36, s4
    s_mov_b32 s37, s5
    s_mov_b32 s38, 1835008
    s_mov_b32 s39, 0x20000
    s_barrier
    s_mov_b32 s32, s30
    s_mov_b32 s33, s31
    s_mov_b32 s34, 33554432
    s_mov_b32 s35, 0x20000
    s_cmp_eq_u32 s76, 15
    s_cselect_b32 s44, s10, s8
    s_cselect_b32 s45, s11, s9
    s_cmp_lt_u32 s76, 14
    s_cselect_b32 s44, s6, s44
    s_cselect_b32 s45, s7, s45
    s_sub_u32 s44, s44, 384
    s_subb_u32 s45, s45, 0
    s_mul_i32 m0, s53, 28672
    buffer_load_dwordx4 v[16:19], v177, s[36:39], 0 offen offset:0
    buffer_load_dwordx4 v[20:23], v177, s[36:39], 0 offen offset:896
    buffer_load_dwordx4 v[24:27], v177, s[36:39], 0 offen offset:1792
    buffer_load_dwordx4 v[28:31], v177, s[36:39], 0 offen offset:2688
    buffer_load_dwordx4 v[32:35], v177, s[36:39], s72 offen offset:0
    buffer_load_dwordx4 v[36:39], v177, s[36:39], s72 offen offset:896
    buffer_load_dwordx4 v[40:43], v177, s[36:39], s72 offen offset:1792
    buffer_load_dwordx4 v[44:47], v177, s[36:39], s72 offen offset:2688
    s_sub_u32 s73, s52, 32
    s_min_u32 s73, s73, 196
    s_mul_i32 s70, s73, 9363
    s_lshr_b32 s70, s70, 16
    s_mul_i32 s71, s70, 7
    s_sub_u32 s71, s73, s71
    s_lshl_b32 s72, s71, 7
    v_and_b32 v204, 31, v1
    v_lshl_add_u32 v194, v204, 2, s72
    s_mul_i32 s71, s71, 344064
    s_lshl_b32 s70, s70, 7
    s_add_u32 s70, s70, s71
    s_mul_i32 s71, s53, 86016
    s_add_u32 s70, s70, s71
    s_add_u32 s70, s70, 1792
    s_lshl_b32 s71, s73, 2
    s_add_u32 s71, s71, s53
    s_lshl_b32 s71, s71, 7
    s_add_u32 s71, s71, 147456
    s_cmp_lt_u32 s73, 196
    s_cselect_b32 s70, s70, 1879048192
    s_cselect_b32 s71, s71, 1879048192
    v_lshrrev_b32_e64 v187, 3, v1
    v_mul_u32_u24 v187, 5248, v187
    v_add3_u32 v187, v187, s70, v13
    v_lshl_add_u32 v188, v1, 2, s71
    v_mov_b32 v203, 1879048192
    v_cmp_gt_u32 vcc, 32, v1
    s_lshl_b32 s70, s53, 7
    s_add_u32 s70, s70, 155648
    v_cndmask_b32_e64 v188, v203, v188, vcc
    v_lshl_add_u32 v191, v204, 2, s70
    v_lshrrev_b32 v204, 4, v1
    v_lshl_add_u32 v189, v204, 4, s70
    s_lshl_b32 s70, s53, 5
    s_add_u32 s70, s70, 147456
    v_lshl_add_u32 v190, v204, 10, s70
    v_bfe_u32 v204, v1, 2, 2
    v_lshl_add_u32 v190, v204, 7, v190
    v_and_b32 v204, 3, v1
    v_lshl_add_u32 v190, v204, 3, v190
    s_mov_b32 s48, s12
    s_mov_b32 s49, s13
    s_mov_b32 s50, 401408
    s_mov_b32 s51, 0x20000
    s_sub_u32 s73, s52, 33
    s_lshr_b32 s73, s73, 1
    s_bitcmp0_b32 s52, 0
    s_cselect_b32 s73, 98, s73
    s_min_u32 s73, s73, 98
    s_mul_i32 s70, s73, 9363
    s_lshr_b32 s70, s70, 17
    s_mul_i32 s71, s70, 14
    s_sub_u32 s71, s73, s71
    s_lshl_b32 s72, s71, 2
    s_add_u32 s72, s72, s53
    s_mul_i32 s72, s72, 7168
    s_lshl_b32 s13, s70, 7
    s_add_u32 s72, s72, s13
    s_lshl_b32 s70, s70, 2
    s_add_u32 s70, s70, s53
    s_mul_i32 s70, s70, 14
    s_add_u32 s70, s70, s71
    s_lshl_b32 s13, s73, 7
    s_add_u32 s13, s13, 32768
    s_cmp_eq_u32 s53, 0
    s_cselect_b32 s13, s13, 1879048192
    s_lshl_b32 s70, s70, 10
    s_add_u32 s70, s70, 4718592
    s_cmp_lt_u32 s73, 98
    s_cselect_b32 s13, s13, 1879048192
    s_cselect_b32 s70, s70, 1879048192
    s_cselect_b32 s72, s72, 1879048192
    v_lshrrev_b32 v198, 3, v1
    v_add_u32 v228, s70, v13
    v_mul_u32_u24 v198, 768, v198
    v_add3_u32 v198, v198, s72, v13
    s_mul_i32 s65, s52, 21504
    s_mul_i32 s70, s53, 3584
    s_add_u32 s65, s65, s70
    s_add_u32 s65, s65, 16777216
    s_lshl_b32 s70, s55, 15
    s_mul_i32 s71, s56, 3584
    s_add_u32 s70, s70, s71
    s_add_u32 s70, s70, 524288
    s_cmp_lt_u32 s56, 10
    s_cselect_b32 s70, s70, 1879048192
    s_cmp_eq_u32 s53, 3
    s_cselect_b32 s70, 1879048192, s70
    s_cmp_lt_u32 s53, 2
    s_cselect_b32 s65, s65, s70
    s_lshl_b32 s71, s52, 2
    s_add_u32 s71, s71, 1024
    s_cmp_eq_u32 s53, 2
    s_cselect_b32 s71, s71, 1879048192
    v_mov_b32 v162, 1879048192
    s_getreg_b32 s72, hwreg(HW_REG_XCC_ID, 0, 4)
    v_writelane_b32 v162, s71, 0
    v_and_b32 v192, 3, v1
    v_lshlrev_b32 v192, 3, v192
    s_cmp_eq_u32 s67, 1
    s_cbranch_scc0 L_skip_p0c_2
    v_lshrrev_b32 v161, 2, v1
    v_and_b32 v163, 3, v1
    v_lshlrev_b32 v161, 6, v161
    v_lshl_add_u32 v161, v163, 3, v161
    v_lshrrev_b32 v160, 4, v1
    v_lshlrev_b32 v160, 3, v160
    v_lshlrev_b32 v163, 2, v1
    s_lshl_b32 s66, s66, 7
    s_add_u32 s66, s66, 98304
    s_mov_b32 exec_hi, 0
    v_add_u32 v162, s66, v163
    s_mov_b32 exec_hi, -1
    v_add_u32 v161, 114688, v161
    v_add_u32 v160, 121856, v160
    v_add_u32 v163, 121856, v163
    s_waitcnt vmcnt(15)
    v_lshlrev_b32 v164, 16, v202
    v_and_b32_e64 v165, s61, v202
    v_mul_f32 v166, 0xbfb8aa3b, v164
    v_mul_f32 v167, 0xbfb8aa3b, v165
    v_exp_f32 v166, v166
    v_exp_f32 v167, v167
    v_add_f32 v166, 1.0, v166
    v_add_f32 v167, 1.0, v167
    v_rcp_f32 v166, v166
    v_rcp_f32 v167, v167
    v_mul_f32 v164, v164, v166
    v_mul_f32 v165, v165, v167
    v_cvt_pk_bf16_f32 v164, v164, v165
    ds_write_b32 v163, v164
    ds_read_b64 v[48:49], v160 offset:0
    ds_read_b64 v[50:51], v160 offset:32
    ds_read_b64 v[52:53], v160 offset:64
    ds_read_b64 v[54:55], v160 offset:96
    ds_read_b64 v[56:57], v160 offset:128
    ds_read_b64 v[58:59], v160 offset:160
    ds_read_b64 v[60:61], v160 offset:192
L_skip_p0c_2:
    s_waitcnt lgkmcnt(0)
    s_and_b32 s70, s3, 0x7f7f7f7f
    s_and_b32 s71, s3, 0x80808080
    s_add_u32 s70, s70, 0x01010101
    s_xor_b32 s54, s70, s71
    v_lshrrev_b32 v192, v192, s54
    s_xor_b32 s72, s54, s72
    v_and_b32 v192, 0xff, v192
    v_mov_b32 v164, s72
    s_cmp_eq_u32 s67, 1
    s_cbranch_scc0 L_skip_p0c_3
    s_mov_b32 s71, 0xffffff00
    v_cmp_gt_u32 vcc, 16, v1
    s_waitcnt vmcnt(12)
    ds_read_b64_tr_b16 v[64:65], v161 offset:0
    ds_read_b64_tr_b16 v[66:67], v161 offset:32
    ds_read_b64_tr_b16 v[68:69], v161 offset:1024
    ds_read_b64_tr_b16 v[70:71], v161 offset:1056
    ds_read_b64_tr_b16 v[72:73], v161 offset:2048
    ds_read_b64_tr_b16 v[74:75], v161 offset:2080
    s_waitcnt vmcnt(10)
    ds_read_b64_tr_b16 v[76:77], v161 offset:3072
    ds_read_b64_tr_b16 v[78:79], v161 offset:3104
    ds_read_b64_tr_b16 v[80:81], v161 offset:4096
    ds_read_b64_tr_b16 v[82:83], v161 offset:4128
    s_waitcnt lgkmcnt(9)
    v_mfma_f32_16x16x16_bf16 v[96:99], v[48:49], v[64:65], 0
    s_waitcnt lgkmcnt(8)
    v_mfma_f32_16x16x16_bf16 v[100:103], v[48:49], v[66:67], 0
    s_waitcnt lgkmcnt(7)
    v_mfma_f32_16x16x16_bf16 v[96:99], v[50:51], v[68:69], v[96:99]
    s_waitcnt lgkmcnt(6)
    v_mfma_f32_16x16x16_bf16 v[100:103], v[50:51], v[70:71], v[100:103]
    s_waitcnt lgkmcnt(5)
    v_mfma_f32_16x16x16_bf16 v[96:99], v[52:53], v[72:73], v[96:99]
    s_waitcnt lgkmcnt(4)
    v_mfma_f32_16x16x16_bf16 v[100:103], v[52:53], v[74:75], v[100:103]
    s_waitcnt vmcnt(9)
    ds_read_b64_tr_b16 v[84:85], v161 offset:5120
    ds_read_b64_tr_b16 v[86:87], v161 offset:5152
    s_waitcnt lgkmcnt(5)
    v_mfma_f32_16x16x16_bf16 v[96:99], v[54:55], v[76:77], v[96:99]
    s_waitcnt lgkmcnt(4)
    v_mfma_f32_16x16x16_bf16 v[100:103], v[54:55], v[78:79], v[100:103]
    s_waitcnt lgkmcnt(3)
    v_mfma_f32_16x16x16_bf16 v[96:99], v[56:57], v[80:81], v[96:99]
    s_waitcnt lgkmcnt(2)
    v_mfma_f32_16x16x16_bf16 v[100:103], v[56:57], v[82:83], v[100:103]
    s_waitcnt vmcnt(8)
    ds_read_b64_tr_b16 v[88:89], v161 offset:6144
    ds_read_b64_tr_b16 v[90:91], v161 offset:6176
    s_waitcnt lgkmcnt(3)
    v_mfma_f32_16x16x16_bf16 v[96:99], v[58:59], v[84:85], v[96:99]
    s_waitcnt lgkmcnt(2)
    v_mfma_f32_16x16x16_bf16 v[100:103], v[58:59], v[86:87], v[100:103]
    s_waitcnt lgkmcnt(1)
    v_mfma_f32_16x16x16_bf16 v[96:99], v[60:61], v[88:89], v[96:99]
    s_waitcnt lgkmcnt(0)
    v_mfma_f32_16x16x16_bf16 v[100:103], v[60:61], v[90:91], v[100:103]
    s_nop 7
    v_cndmask_b32_e64 v164, v100, v96, vcc
    v_add_u32 v164, 0x80, v164
    v_and_or_b32 v164, v164, s71, v192
L_skip_p0c_3:
    buffer_store_dword v164, v162, s[32:35], 0 offen sc1
    s_and_b32 s57, s54, 0xff
    s_bfe_u32 s58, s54, 0x80008
    s_bfe_u32 s59, s54, 0x80010
    s_lshr_b32 s60, s54, 24
    v_mov_b32 v241, s54
    v_mov_b32 v14, 1879048192
    v_mov_b32 v251, 0xff
    v_mov_b32 v8, v14
    v_writelane_b32 v8, 0, 0
    v_cmp_gt_u32 vcc, 28, v1
    v_lshlrev_b32 v10, 7, v1
    v_and_b32 v252, 7, v1
    v_cndmask_b32 v7, v14, v10, vcc
    v_lshrrev_b32 v253, 3, v1
    v_and_b32_e64 v254, 15, v1
    v_lshrrev_b32 v255, 4, v1
    s_lshr_b32 s70, s52, 2
    s_and_b32 s71, s52, 1
    s_lshl_b32 s72, s70, 7
    s_mul_i32 s73, s71, 28
    s_add_u32 s72, s72, s73
    s_add_u32 s72, s72, 65536
    v_min_u32 v10, 6, v252
    v_lshl_add_u32 v229, v10, 2, s72
    s_lshl_b32 s72, s55, 3
    s_add_u32 s72, s72, s53
    s_lshl_b32 s73, s72, 12
    s_add_u32 s4, s73, 524288
    s_add_u32 s5, s73, 540672
    s_lshl_b32 s72, s72, 7
    s_add_u32 s72, s72, 65592
    v_and_b32 v10, 1, v1
    v_lshl_add_u32 v10, v10, 2, s72
    v_bfe_u32 v11, v1, 1, 1
    v_cmp_eq_u32 vcc, 1, v255
    v_lshl_add_u32 v10, v11, 9, v10
    s_nop 0
    v_cndmask_b32 v229, v229, v10, vcc
    v_and_b32 v10, 1, v255
    v_mul_u32_u24 v10, 896, v10
    v_lshrrev_b32_e64 v11, 5, v1
    v_lshl_add_u32 v10, v11, 8, v10
    v_lshl_add_u32 v232, v254, 3, v10
    global_load_dword v193, v194, s[22:23]
    s_lshr_b32 s70, s56, 3
    s_lshl_b32 s70, s70, 6
    s_and_b32 s71, s56, 7
    s_add_u32 s70, s70, s71
    s_lshl_b32 s71, s55, 3
    s_add_u32 s70, s70, s71
    s_lshl_b32 s70, s70, 7
    s_add_u32 s70, s70, 65536
    s_lshl_b32 s71, s52, 5
    s_add_u32 s72, s71, 49152
    s_add_u32 s71, s71, 130048
    s_cmp_eq_u32 s53, 2
    s_cselect_b32 s70, s71, s70
    s_cmp_eq_u32 s53, 1
    s_cselect_b32 s70, s72, s70
    s_cmp_eq_u32 s53, 0
    s_cselect_b32 s70, 1879048192, s70
    buffer_load_dword v207, v8, s[32:35], s70 offen sc1
    s_waitcnt vmcnt(10)
    v_lshlrev_b32 v48, 16, v16
    v_and_b32 v49, s61, v16
    v_lshlrev_b32 v50, 16, v17
    v_and_b32 v51, s61, v17
    v_lshlrev_b32 v52, 16, v18
    v_and_b32 v53, s61, v18
    v_pk_add_f32 v[120:121], v[48:49], v[50:51]
    v_lshlrev_b32 v54, 16, v19
    v_and_b32 v55, s61, v19
    buffer_load_dwordx4 v176, s[44:47], s79 offen offset:0 lds
    v_pk_add_f32 v[122:123], v[52:53], v[54:55]
    s_waitcnt vmcnt(10)
    v_lshlrev_b32 v56, 16, v20
    v_and_b32 v57, s61, v20
    v_pk_add_f32 v[120:121], v[120:121], v[122:123]
    v_lshlrev_b32 v58, 16, v21
    v_and_b32 v59, s61, v21
    v_add_f32 v112, v120, v121
    v_lshlrev_b32 v60, 16, v22
    v_and_b32 v61, s61, v22
    v_pk_add_f32 v[120:121], v[56:57], v[58:59]
    v_lshlrev_b32 v62, 16, v23
    v_and_b32 v63, s61, v23
    buffer_load_dwordx4 v208, s[44:47], s79 offen offset:1024 lds
    v_pk_add_f32 v[122:123], v[60:61], v[62:63]
    s_waitcnt vmcnt(10)
    v_lshlrev_b32 v64, 16, v24
    v_and_b32 v65, s61, v24
    v_pk_add_f32 v[120:121], v[120:121], v[122:123]
    v_lshlrev_b32 v66, 16, v25
    v_and_b32 v67, s61, v25
    v_add_f32 v113, v120, v121
    v_lshlrev_b32 v68, 16, v26
    v_and_b32 v69, s61, v26
    v_pk_add_f32 v[120:121], v[64:65], v[66:67]
    v_lshlrev_b32 v70, 16, v27
    v_and_b32 v71, s61, v27
    buffer_load_dwordx4 v209, s[44:47], s79 offen offset:2048 lds
    v_pk_add_f32 v[122:123], v[68:69], v[70:71]
    s_waitcnt vmcnt(10)
    v_lshlrev_b32 v72, 16, v28
    v_and_b32 v73, s61, v28
    v_pk_add_f32 v[120:121], v[120:121], v[122:123]
    v_lshlrev_b32 v74, 16, v29
    v_and_b32 v75, s61, v29
    v_add_f32 v114, v120, v121
    v_lshlrev_b32 v76, 16, v30
    v_and_b32 v77, s61, v30
    v_pk_add_f32 v[120:121], v[72:73], v[74:75]
    v_lshlrev_b32 v78, 16, v31
    v_and_b32 v79, s61, v31
    buffer_load_dwordx4 v210, s[44:47], s79 offen offset:3072 lds
    s_add_u32 m0, m0, 4096
    s_add_u32 s79, s79, s80
    s_cmp_eq_u32 s79, s77
    s_cselect_b32 s79, s78, s79
    v_pk_add_f32 v[122:123], v[76:77], v[78:79]
    s_waitcnt vmcnt(10)
    v_lshlrev_b32 v80, 16, v32
    v_and_b32 v81, s61, v32
    v_pk_add_f32 v[120:121], v[120:121], v[122:123]
    v_lshlrev_b32 v82, 16, v33
    v_and_b32 v83, s61, v33
    v_add_f32 v115, v120, v121
    v_lshlrev_b32 v84, 16, v34
    v_and_b32 v85, s61, v34
    v_pk_add_f32 v[120:121], v[80:81], v[82:83]
    v_lshlrev_b32 v86, 16, v35
    v_and_b32_e64 v87, s61, v35
    buffer_load_dwordx4 v176, s[44:47], s79 offen offset:0 lds
    v_pk_add_f32 v[122:123], v[84:85], v[86:87]
    s_waitcnt vmcnt(10)
    v_lshlrev_b32 v88, 16, v36
    v_and_b32 v89, s61, v36
    v_pk_add_f32 v[120:121], v[120:121], v[122:123]
    v_lshlrev_b32 v90, 16, v37
    v_and_b32 v91, s61, v37
    v_add_f32 v116, v120, v121
    v_lshlrev_b32 v92, 16, v38
    v_and_b32 v93, s61, v38
    v_pk_add_f32 v[120:121], v[88:89], v[90:91]
    v_lshlrev_b32 v94, 16, v39
    v_and_b32 v95, s61, v39
    buffer_load_dwordx4 v208, s[44:47], s79 offen offset:1024 lds
    v_pk_add_f32 v[122:123], v[92:93], v[94:95]
    s_waitcnt vmcnt(10)
    v_lshlrev_b32 v96, 16, v40
    v_and_b32 v97, s61, v40
    v_pk_add_f32 v[120:121], v[120:121], v[122:123]
    v_lshlrev_b32 v98, 16, v41
    v_and_b32 v99, s61, v41
    v_add_f32 v117, v120, v121
    v_lshlrev_b32 v100, 16, v42
    v_and_b32 v101, s61, v42
    v_pk_add_f32 v[120:121], v[96:97], v[98:99]
    v_lshlrev_b32 v102, 16, v43
    v_and_b32 v103, s61, v43
    buffer_load_dwordx4 v209, s[44:47], s79 offen offset:2048 lds
    v_pk_add_f32 v[122:123], v[100:101], v[102:103]
    s_waitcnt vmcnt(10)
    v_lshlrev_b32 v104, 16, v44
    v_and_b32 v105, s61, v44
    v_pk_add_f32 v[120:121], v[120:121], v[122:123]
    v_lshlrev_b32 v106, 16, v45
    v_and_b32 v107, s61, v45
    v_add_f32 v118, v120, v121
    v_lshlrev_b32 v108, 16, v46
    v_and_b32 v109, s61, v46
    v_pk_add_f32 v[120:121], v[104:105], v[106:107]
    v_lshlrev_b32 v110, 16, v47
    v_and_b32 v111, s61, v47
    buffer_load_dwordx4 v210, s[44:47], s79 offen offset:3072 lds
    s_add_u32 m0, m0, 4096
    s_add_u32 s79, s79, s80
    s_cmp_eq_u32 s79, s77
    s_cselect_b32 s79, s78, s79
    v_pk_add_f32 v[122:123], v[108:109], v[110:111]
    v_pk_add_f32 v[120:121], v[120:121], v[122:123]
    v_add_f32 v119, v120, v121
    v_permlane32_swap_b32 v112, v113
    v_permlane32_swap_b32 v114, v115
    v_permlane32_swap_b32 v116, v117
    v_permlane32_swap_b32 v118, v119
    v_add_f32 v112, v112, v113
    v_add_f32 v114, v114, v115
    v_add_f32 v116, v116, v117
    v_add_f32 v118, v118, v119
    v_permlane16_swap_b32 v112, v114
    s_nop 0
    v_permlane16_swap_b32 v116, v118
    v_add_f32 v112, v112, v114
    v_add_f32_e64 v116, v116, v118
    s_nop 0
    v_add_f32_dpp v112, v112, v112 row_ror:8 row_mask:0xf bank_mask:0xf
    v_add_f32_dpp v116, v116, v116 row_ror:8 row_mask:0xf bank_mask:0xf
    s_nop 0
    v_add_f32_dpp v112, v112, v112 row_ror:4 row_mask:0xf bank_mask:0xf
    v_add_f32_dpp v116, v116, v116 row_ror:4 row_mask:0xf bank_mask:0xf
    s_nop 0
    v_add_f32_dpp v112, v112, v112 row_ror:2 row_mask:0xf bank_mask:0xf
    v_add_f32_dpp v116, v116, v116 row_ror:2 row_mask:0xf bank_mask:0xf
    s_nop 0
    v_add_f32_dpp v112, v112, v112 row_ror:1 row_mask:0xf bank_mask:0xf
    v_add_f32_dpp v116, v116, v116 row_ror:1 row_mask:0xf bank_mask:0xf
    v_mul_f32 v112, 0xbb124925, v112
    v_mul_f32 v116, 0xbb124925, v116
    v_readlane_b32 s68, v112, 0
    v_readlane_b32 s70, v112, 16
    v_readlane_b32 s69, v112, 32
    v_readlane_b32 s71, v112, 48
    v_readlane_b32 s72, v116, 0
    v_readlane_b32 s74, v116, 16
    v_readlane_b32 s73, v116, 32
    v_readlane_b32 s75, v116, 48
    s_mov_b32 exec_hi, 0xffffff
    v_pk_add_f32 v[48:49], v[48:49], s[68:69] op_sel:[0,0] op_sel_hi:[1,0]
    v_pk_add_f32 v[50:51], v[50:51], s[68:69] op_sel:[0,0] op_sel_hi:[1,0]
    v_pk_add_f32 v[52:53], v[52:53], s[68:69] op_sel:[0,0] op_sel_hi:[1,0]
    v_pk_add_f32 v[54:55], v[54:55], s[68:69] op_sel:[0,0] op_sel_hi:[1,0]
    v_pk_add_f32 v[56:57], v[56:57], s[68:69] op_sel:[0,1] op_sel_hi:[1,1]
    v_pk_add_f32 v[58:59], v[58:59], s[68:69] op_sel:[0,1] op_sel_hi:[1,1]
    v_pk_add_f32 v[60:61], v[60:61], s[68:69] op_sel:[0,1] op_sel_hi:[1,1]
    v_pk_add_f32 v[62:63], v[62:63], s[68:69] op_sel:[0,1] op_sel_hi:[1,1]
    v_pk_add_f32 v[64:65], v[64:65], s[70:71] op_sel:[0,0] op_sel_hi:[1,0]
    v_pk_add_f32 v[66:67], v[66:67], s[70:71] op_sel:[0,0] op_sel_hi:[1,0]
    v_pk_add_f32 v[68:69], v[68:69], s[70:71] op_sel:[0,0] op_sel_hi:[1,0]
    v_pk_add_f32 v[70:71], v[70:71], s[70:71] op_sel:[0,0] op_sel_hi:[1,0]
    v_pk_add_f32 v[72:73], v[72:73], s[70:71] op_sel:[0,1] op_sel_hi:[1,1]
    v_pk_add_f32 v[74:75], v[74:75], s[70:71] op_sel:[0,1] op_sel_hi:[1,1]
    v_pk_add_f32 v[76:77], v[76:77], s[70:71] op_sel:[0,1] op_sel_hi:[1,1]
    v_pk_add_f32 v[78:79], v[78:79], s[70:71] op_sel:[0,1] op_sel_hi:[1,1]
    v_pk_add_f32 v[80:81], v[80:81], s[72:73] op_sel:[0,0] op_sel_hi:[1,0]
    v_pk_add_f32 v[82:83], v[82:83], s[72:73] op_sel:[0,0] op_sel_hi:[1,0]
    v_pk_add_f32 v[84:85], v[84:85], s[72:73] op_sel:[0,0] op_sel_hi:[1,0]
    v_pk_add_f32 v[86:87], v[86:87], s[72:73] op_sel:[0,0] op_sel_hi:[1,0]
    v_pk_add_f32 v[88:89], v[88:89], s[72:73] op_sel:[0,1] op_sel_hi:[1,1]
    v_pk_add_f32 v[90:91], v[90:91], s[72:73] op_sel:[0,1] op_sel_hi:[1,1]
    v_pk_add_f32 v[92:93], v[92:93], s[72:73] op_sel:[0,1] op_sel_hi:[1,1]
    v_pk_add_f32 v[94:95], v[94:95], s[72:73] op_sel:[0,1] op_sel_hi:[1,1]
    v_pk_add_f32 v[96:97], v[96:97], s[74:75] op_sel:[0,0] op_sel_hi:[1,0]
    v_pk_add_f32 v[98:99], v[98:99], s[74:75] op_sel:[0,0] op_sel_hi:[1,0]
    v_pk_add_f32 v[100:101], v[100:101], s[74:75] op_sel:[0,0] op_sel_hi:[1,0]
    v_pk_add_f32 v[102:103], v[102:103], s[74:75] op_sel:[0,0] op_sel_hi:[1,0]
    v_pk_add_f32 v[104:105], v[104:105], s[74:75] op_sel:[0,1] op_sel_hi:[1,1]
    v_pk_add_f32 v[106:107], v[106:107], s[74:75] op_sel:[0,1] op_sel_hi:[1,1]
    v_pk_add_f32 v[108:109], v[108:109], s[74:75] op_sel:[0,1] op_sel_hi:[1,1]
    v_pk_add_f32 v[110:111], v[110:111], s[74:75] op_sel:[0,1] op_sel_hi:[1,1]
    s_mov_b32 exec_hi, -1
    s_nop 0
    v_pk_mul_f32 v[120:121], v[48:49], v[48:49]
    v_pk_mul_f32 v[122:123], v[56:57], v[56:57]
    v_pk_mul_f32 v[124:125], v[64:65], v[64:65]
    v_pk_mul_f32 v[126:127], v[72:73], v[72:73]
    v_pk_fma_f32 v[120:121], v[50:51], v[50:51], v[120:121]
    v_pk_fma_f32 v[122:123], v[58:59], v[58:59], v[122:123]
    v_pk_fma_f32 v[124:125], v[66:67], v[66:67], v[124:125]
    v_pk_fma_f32 v[126:127], v[74:75], v[74:75], v[126:127]
    v_pk_fma_f32 v[120:121], v[52:53], v[52:53], v[120:121]
    v_pk_fma_f32 v[122:123], v[60:61], v[60:61], v[122:123]
    v_pk_fma_f32 v[124:125], v[68:69], v[68:69], v[124:125]
    v_pk_fma_f32 v[126:127], v[76:77], v[76:77], v[126:127]
    v_pk_fma_f32 v[120:121], v[54:55], v[54:55], v[120:121]
    v_pk_fma_f32 v[122:123], v[62:63], v[62:63], v[122:123]
    v_pk_fma_f32 v[124:125], v[70:71], v[70:71], v[124:125]
    v_pk_fma_f32 v[126:127], v[78:79], v[78:79], v[126:127]
    v_add_f32 v112, v120, v121
    v_add_f32 v113, v122, v123
    v_add_f32 v114, v124, v125
    v_add_f32 v115, v126, v127
    buffer_load_dwordx4 v176, s[44:47], s79 offen offset:0 lds
    v_pk_mul_f32 v[120:121], v[80:81], v[80:81]
    v_pk_mul_f32 v[122:123], v[88:89], v[88:89]
    v_pk_mul_f32 v[124:125], v[96:97], v[96:97]
    v_pk_mul_f32 v[126:127], v[104:105], v[104:105]
    v_pk_fma_f32 v[120:121], v[82:83], v[82:83], v[120:121]
    v_pk_fma_f32 v[122:123], v[90:91], v[90:91], v[122:123]
    v_pk_fma_f32 v[124:125], v[98:99], v[98:99], v[124:125]
    v_pk_fma_f32 v[126:127], v[106:107], v[106:107], v[126:127]
    v_pk_fma_f32 v[120:121], v[84:85], v[84:85], v[120:121]
    v_pk_fma_f32 v[122:123], v[92:93], v[92:93], v[122:123]
    v_pk_fma_f32 v[124:125], v[100:101], v[100:101], v[124:125]
    v_pk_fma_f32 v[126:127], v[108:109], v[108:109], v[126:127]
    v_pk_fma_f32 v[120:121], v[86:87], v[86:87], v[120:121]
    v_pk_fma_f32 v[122:123], v[94:95], v[94:95], v[122:123]
    v_pk_fma_f32 v[124:125], v[102:103], v[102:103], v[124:125]
    v_pk_fma_f32 v[126:127], v[110:111], v[110:111], v[126:127]
    v_add_f32 v116, v120, v121
    v_add_f32 v117, v122, v123
    v_add_f32 v118, v124, v125
    v_add_f32 v119, v126, v127
    buffer_load_dwordx4 v208, s[44:47], s79 offen offset:1024 lds
    v_permlane32_swap_b32 v112, v113
    v_permlane32_swap_b32 v114, v115
    v_permlane32_swap_b32 v116, v117
    v_permlane32_swap_b32 v118, v119
    v_add_f32 v112, v112, v113
    v_add_f32 v114, v114, v115
    v_add_f32 v116, v116, v117
    v_add_f32 v118, v118, v119
    v_permlane16_swap_b32 v112, v114
    s_nop 0
    v_permlane16_swap_b32 v116, v118
    v_add_f32 v112, v112, v114
    v_add_f32_e64 v116, v116, v118
    s_nop 0
    v_add_f32_dpp v112, v112, v112 row_ror:8 row_mask:0xf bank_mask:0xf
    v_add_f32_dpp v116, v116, v116 row_ror:8 row_mask:0xf bank_mask:0xf
    s_nop 0
    v_add_f32_dpp v112, v112, v112 row_ror:4 row_mask:0xf bank_mask:0xf
    v_add_f32_dpp v116, v116, v116 row_ror:4 row_mask:0xf bank_mask:0xf
    s_nop 0
    v_add_f32_dpp v112, v112, v112 row_ror:2 row_mask:0xf bank_mask:0xf
    v_add_f32_dpp v116, v116, v116 row_ror:2 row_mask:0xf bank_mask:0xf
    s_nop 0
    v_add_f32_dpp v112, v112, v112 row_ror:1 row_mask:0xf bank_mask:0xf
    v_add_f32_dpp v116, v116, v116 row_ror:1 row_mask:0xf bank_mask:0xf
    v_mov_b32 v120, 0x3727c5ac
    v_mov_b32 v121, 0x3727c5ac
    v_fmac_f32 v120, 0x3b124925, v112
    v_fmac_f32 v121, 0x3b124925, v116
    v_rsq_f32 v112, v120
    v_rsq_f32 v116, v121
    v_readlane_b32 s68, v112, 0
    v_readlane_b32 s70, v112, 16
    v_readlane_b32 s69, v112, 32
    v_readlane_b32 s71, v112, 48
    v_readlane_b32 s72, v116, 0
    v_readlane_b32 s74, v116, 16
    v_readlane_b32 s73, v116, 32
    v_readlane_b32 s75, v116, 48
    v_pk_mul_f32 v[48:49], v[48:49], s[68:69] op_sel:[0,0] op_sel_hi:[1,0]
    v_pk_mul_f32 v[50:51], v[50:51], s[68:69] op_sel:[0,0] op_sel_hi:[1,0]
    v_pk_mul_f32 v[52:53], v[52:53], s[68:69] op_sel:[0,0] op_sel_hi:[1,0]
    v_pk_mul_f32 v[54:55], v[54:55], s[68:69] op_sel:[0,0] op_sel_hi:[1,0]
    v_pk_mul_f32 v[56:57], v[56:57], s[68:69] op_sel:[0,1] op_sel_hi:[1,1]
    v_pk_mul_f32 v[58:59], v[58:59], s[68:69] op_sel:[0,1] op_sel_hi:[1,1]
    v_pk_mul_f32 v[60:61], v[60:61], s[68:69] op_sel:[0,1] op_sel_hi:[1,1]
    v_pk_mul_f32 v[62:63], v[62:63], s[68:69] op_sel:[0,1] op_sel_hi:[1,1]
    v_pk_mul_f32 v[64:65], v[64:65], s[70:71] op_sel:[0,0] op_sel_hi:[1,0]
    v_pk_mul_f32 v[66:67], v[66:67], s[70:71] op_sel:[0,0] op_sel_hi:[1,0]
    v_pk_mul_f32 v[68:69], v[68:69], s[70:71] op_sel:[0,0] op_sel_hi:[1,0]
    v_pk_mul_f32 v[70:71], v[70:71], s[70:71] op_sel:[0,0] op_sel_hi:[1,0]
    v_pk_mul_f32 v[72:73], v[72:73], s[70:71] op_sel:[0,1] op_sel_hi:[1,1]
    v_pk_mul_f32 v[74:75], v[74:75], s[70:71] op_sel:[0,1] op_sel_hi:[1,1]
    v_pk_mul_f32 v[76:77], v[76:77], s[70:71] op_sel:[0,1] op_sel_hi:[1,1]
    v_pk_mul_f32 v[78:79], v[78:79], s[70:71] op_sel:[0,1] op_sel_hi:[1,1]
    v_pk_mul_f32 v[80:81], v[80:81], s[72:73] op_sel:[0,0] op_sel_hi:[1,0]
    v_pk_mul_f32 v[82:83], v[82:83], s[72:73] op_sel:[0,0] op_sel_hi:[1,0]
    v_pk_mul_f32 v[84:85], v[84:85], s[72:73] op_sel:[0,0] op_sel_hi:[1,0]
    v_pk_mul_f32 v[86:87], v[86:87], s[72:73] op_sel:[0,0] op_sel_hi:[1,0]
    v_pk_mul_f32 v[88:89], v[88:89], s[72:73] op_sel:[0,1] op_sel_hi:[1,1]
    v_pk_mul_f32 v[90:91], v[90:91], s[72:73] op_sel:[0,1] op_sel_hi:[1,1]
    v_pk_mul_f32 v[92:93], v[92:93], s[72:73] op_sel:[0,1] op_sel_hi:[1,1]
    v_pk_mul_f32 v[94:95], v[94:95], s[72:73] op_sel:[0,1] op_sel_hi:[1,1]
    v_pk_mul_f32 v[96:97], v[96:97], s[74:75] op_sel:[0,0] op_sel_hi:[1,0]
    v_pk_mul_f32 v[98:99], v[98:99], s[74:75] op_sel:[0,0] op_sel_hi:[1,0]
    v_pk_mul_f32 v[100:101], v[100:101], s[74:75] op_sel:[0,0] op_sel_hi:[1,0]
    v_pk_mul_f32 v[102:103], v[102:103], s[74:75] op_sel:[0,0] op_sel_hi:[1,0]
    v_pk_mul_f32 v[104:105], v[104:105], s[74:75] op_sel:[0,1] op_sel_hi:[1,1]
    v_pk_mul_f32 v[106:107], v[106:107], s[74:75] op_sel:[0,1] op_sel_hi:[1,1]
    v_pk_mul_f32 v[108:109], v[108:109], s[74:75] op_sel:[0,1] op_sel_hi:[1,1]
    v_pk_mul_f32 v[110:111], v[110:111], s[74:75] op_sel:[0,1] op_sel_hi:[1,1]
    buffer_load_dwordx4 v[128:131], v183, s[32:35], 0 offen offset:0 sc1
    buffer_load_dwordx4 v[132:135], v183, s[32:35], 0 offen offset:128 sc1
    buffer_load_dwordx4 v[136:139], v183, s[32:35], 0 offen offset:256 sc1
    buffer_load_dwordx4 v[140:143], v183, s[32:35], 0 offen offset:384 sc1
    buffer_load_dword v144, v184, s[32:35], 0 offen sc1
    s_waitcnt vmcnt(16)
    v_lshlrev_b32 v194, 16, v193
    v_and_b32_e64 v195, s61, v193
    v_mul_f32 v196, 0xbfb8aa3b, v194
    v_mul_f32 v197, 0xbfb8aa3b, v195
    v_exp_f32 v196, v196
    v_exp_f32 v197, v197
    v_add_f32 v196, 1.0, v196
    v_add_f32 v197, 1.0, v197
    v_rcp_f32 v196, v196
    v_rcp_f32 v197, v197
    v_mul_f32 v194, v194, v196
    v_mul_f32 v195, v195, v197
    v_cvt_pk_bf16_f32 v194, v194, v195
    ds_write_b32 v191, v194
    buffer_load_dwordx4 v209, s[44:47], s79 offen offset:2048 lds
    buffer_load_dwordx4 v210, s[44:47], s79 offen offset:3072 lds
    s_add_u32 m0, m0, 4096
    s_add_u32 s79, s79, s80
    s_cmp_eq_u32 s79, s77
    s_cselect_b32 s79, s78, s79
    buffer_load_dwordx4 v176, s[44:47], s79 offen offset:0 lds
    buffer_load_dwordx4 v208, s[44:47], s79 offen offset:1024 lds
    v_add_u32 v2, 4096, v13
    v_add_u32 v10, s56, v254
    v_mul_u32_u24 v11, 4682, v10
    v_lshrrev_b32 v11, 16, v11
    v_mul_u32_u24 v11, 14, v11
    v_sub_u32 v10, v10, v11
    s_lshl_b32 s72, s55, 1
    s_add_u32 s72, s72, 2
    v_add_u32 v10, s72, v10
    v_and_b32 v10, 15, v10
    s_lshl_b32 s72, s53, 8
    s_add_u32 s72, s72, 16384
    v_lshl_add_u32 v10, v10, 10, s72
    v_lshrrev_b32_e64 v11, 5, v1
    v_lshl_add_u32 v230, v11, 7, v10
    buffer_load_dwordx4 v209, s[44:47], s79 offen offset:2048 lds
    buffer_load_dwordx4 v210, s[44:47], s79 offen offset:3072 lds
    s_add_u32 m0, m0, 4096
    s_add_u32 s79, s79, s80
    s_cmp_eq_u32 s79, s77
    s_cselect_b32 s79, s78, s79
    buffer_load_dwordx4 v176, s[44:47], s79 offen offset:0 lds
    s_and_b32 s73, s52, 1
    s_mul_i32 s72, s53, 7
    s_mul_i32 s73, s73, 896
    s_add_u32 s73, s73, 32768
    v_min_u32 v10, 6, v253
    v_min_u32 v11, 6, v252
    v_add_u32 v10, s72, v10
    v_lshrrev_b32 v10, 2, v10
    v_mul_u32_u24 v10, 14, v10
    v_add_u32_e64 v10, v10, v11
    v_lshl_add_u32 v231, v10, 7, s73
    buffer_load_dwordx4 v208, s[44:47], s79 offen offset:1024 lds
    buffer_load_dwordx4 v209, s[44:47], s79 offen offset:2048 lds
    buffer_load_dwordx4 v210, s[44:47], s79 offen offset:3072 lds
    s_add_u32 m0, m0, 4096
    s_add_u32 s79, s79, s80
    s_cmp_eq_u32 s79, s77
    s_cselect_b32 s79, s78, s79
    buffer_load_dwordx4 v176, s[44:47], s79 offen offset:0 lds
    v_and_b32 v10, 1, v255
    v_mul_u32_u24 v10, 56, v10
    v_lshrrev_b32 v11, 5, v1
    v_lshl_add_u32 v10, v11, 4, v10
    s_mul_i32 s72, s53, 112
    s_add_u32 s72, s72, 154624
    v_mul_u32_u24 v11, 480, v254
    v_add3_u32 v242, v10, v11, s72
    v_lshl_add_u32 v11, v255, 4, v11
    v_add_u32 v243, 154624, v11
    buffer_load_dwordx4 v208, s[44:47], s79 offen offset:1024 lds
    buffer_load_dwordx4 v209, s[44:47], s79 offen offset:2048 lds
    buffer_load_dwordx4 v210, s[44:47], s79 offen offset:3072 lds
    s_add_u32 m0, m0, 4096
    s_add_u32 s79, s79, s80
    s_cmp_eq_u32 s79, s77
    s_cselect_b32 s79, s78, s79
    s_lshr_b32 s72, s52, 3
    s_mul_i32 s72, s72, 3584
    s_and_b32 s73, s52, 7
    s_lshl_b32 s73, s73, 6
    s_add_u32 s72, s72, s73
    s_and_b32 s73, s52, 1
    s_lshl_b32 s73, s73, 5
    s_add_u32 s72, s72, s73
    s_add_u32 s72, s72, 133120
    s_cmp_eq_u32 s67, 3
    s_cselect_b32 s72, s72, 1879048192
    v_lshl_add_u32 v10, v253, 9, s72
    v_lshl_add_u32 v10, v252, 2, v10
    v_and_b32 v11, 3, v1
    v_lshlrev_b32 v11, 3, v11
    v_lshrrev_b32 v11, v11, s54
    v_cmp_gt_u32 vcc, 56, v1
    v_and_b32 v11, 0xff, v11
    s_nop 0
    v_cndmask_b32 v233, v14, v10, vcc
    v_cndmask_b32 v234, 0, v11, vcc
    s_waitcnt vmcnt(14)
    v_xor_b32 v144, s54, v144
    v_cmp_lt_u32 s[70:71], 15, v144
    v_xor_b32 v128, s57, v128
    v_xor_b32 v129, s58, v129
    v_xor_b32 v130, s59, v130
    v_xor_b32 v131, s60, v131
    v_xor_b32 v132, s57, v132
    v_xor_b32 v133, s58, v133
    v_xor_b32 v134, s59, v134
    v_xor_b32 v135, s60, v135
    v_xor_b32 v136, s57, v136
    v_xor_b32 v137, s58, v137
    v_xor_b32 v138, s59, v138
    v_xor_b32 v139, s60, v139
    v_xor_b32 v140, s57, v140
    v_xor_b32 v141, s58, v141
    v_xor_b32 v142, s59, v142
    v_xor_b32 v143, s60, v143
    v_or_b32 v145, v128, v129
    v_or3_b32 v145, v145, v130, v131
    v_or3_b32 v145, v145, v132, v133
    v_or3_b32 v145, v145, v134, v135
    v_or3_b32 v145, v145, v136, v137
    v_or3_b32 v145, v145, v138, v139
    v_or3_b32 v145, v145, v140, v141
    v_or3_b32 v145, v145, v142, v143
    v_and_b32 v145, 0xff, v145
    v_cmp_ne_u32 vcc, 0, v145
    s_nop 0
    s_or_b64 vcc, vcc, s[70:71]
    s_cbranch_vccnz L_d1_w
L_d1_ok:
    v_pk_add_f32 v[128:129], v[128:129], v[132:133]
    v_pk_add_f32 v[130:131], v[130:131], v[134:135]
    v_pk_add_f32 v[136:137], v[136:137], v[140:141]
    v_pk_add_f32 v[138:139], v[138:139], v[142:143]
    v_pk_add_f32 v[128:129], v[128:129], v[136:137]
    v_pk_add_f32 v[130:131], v[130:131], v[138:139]
    v_cvt_pk_bf16_f32 v132, v128, v129
    v_cvt_pk_bf16_f32 v133, v130, v131
    v_lshlrev_b32 v128, 16, v132
    v_and_b32 v129, s61, v132
    v_lshlrev_b32 v130, 16, v133
    v_and_b32 v131, s61, v133
    v_add_f32 v128, v128, v186
    v_add_f32 v129, v129, v186
    v_add_f32 v130, v130, v186
    v_add_f32 v131, v131, v186
    v_cvt_pk_bf16_f32 v132, v128, v129
    v_cvt_pk_bf16_f32 v133, v130, v131
    v_lshlrev_b32 v128, 16, v132
    v_and_b32 v129, s61, v132
    v_lshlrev_b32_e64 v130, 16, v133
    v_and_b32 v131, s61, v133
    ds_write_b128 v185, v[128:131]
    s_getreg_b32 s70, hwreg(HW_REG_XCC_ID, 0, 4)
    v_cmp_ne_u32 vcc, s70, v144
    s_nop 0
    s_cmp_eq_u64 vcc, 0
    s_cselect_b32 s2, 1, 0
    s_waitcnt lgkmcnt(0)
    s_barrier
    ds_read_b128 v[32:35], v182 offset:1792
    ds_read_b128 v[24:27], v182
    ds_read_b128 v[36:39], v182 offset:1808
    ds_read_b128 v[28:31], v182 offset:16
    ds_read_b64_tr_b16 a[0:1], v178 offset:0
    ds_read_b64_tr_b16 a[2:3], v178 offset:512
    buffer_load_dwordx4 v176, s[44:47], s79 offen offset:0 lds
    ds_read_b64_tr_b16 a[4:5], v178 offset:1024
    ds_read_b64_tr_b16 a[6:7], v178 offset:1536
    buffer_load_dwordx4 v208, s[44:47], s79 offen offset:1024 lds
    ds_read_b64_tr_b16 a[8:9], v178 offset:2048
    ds_read_b64_tr_b16 a[10:11], v178 offset:2560
    buffer_load_dwordx4 v209, s[44:47], s79 offen offset:2048 lds
    ds_read_b64_tr_b16 a[12:13], v178 offset:3072
    ds_read_b64_tr_b16 a[14:15], v178 offset:3584
    buffer_load_dwordx4 v210, s[44:47], s79 offen offset:3072 lds
    s_waitcnt lgkmcnt(10)
    v_pk_fma_f32 v[48:49], v[48:49], v[32:33], v[24:25]
    v_pk_fma_f32 v[50:51], v[50:51], v[34:35], v[26:27]
    s_waitcnt lgkmcnt(8)
    v_pk_fma_f32 v[52:53], v[52:53], v[36:37], v[28:29]
    v_pk_fma_f32 v[54:55], v[54:55], v[38:39], v[30:31]
    v_cvt_pk_bf16_f32 v48, v48, v49
    v_cvt_pk_bf16_f32 v49, v50, v51
    v_cvt_pk_bf16_f32 v50, v52, v53
    v_cvt_pk_bf16_f32 v51, v54, v55
    ds_write_b128 v179, v[48:51] offset:0
    v_pk_fma_f32 v[56:57], v[56:57], v[32:33], v[24:25]
    v_pk_fma_f32 v[58:59], v[58:59], v[34:35], v[26:27]
    v_pk_fma_f32 v[60:61], v[60:61], v[36:37], v[28:29]
    v_pk_fma_f32 v[62:63], v[62:63], v[38:39], v[30:31]
    v_cvt_pk_bf16_f32 v56, v56, v57
    v_cvt_pk_bf16_f32 v57, v58, v59
    v_cvt_pk_bf16_f32 v58, v60, v61
    v_cvt_pk_bf16_f32 v59, v62, v63
    ds_write_b128 v179, v[56:59] offset:912
    v_pk_fma_f32 v[64:65], v[64:65], v[32:33], v[24:25]
    v_pk_fma_f32 v[66:67], v[66:67], v[34:35], v[26:27]
    v_pk_fma_f32 v[68:69], v[68:69], v[36:37], v[28:29]
    v_pk_fma_f32 v[70:71], v[70:71], v[38:39], v[30:31]
    v_cvt_pk_bf16_f32 v64, v64, v65
    v_cvt_pk_bf16_f32 v65, v66, v67
    v_cvt_pk_bf16_f32 v66, v68, v69
    v_cvt_pk_bf16_f32 v67, v70, v71
    ds_write_b128 v179, v[64:67] offset:1824
    v_pk_fma_f32 v[72:73], v[72:73], v[32:33], v[24:25]
    v_pk_fma_f32 v[74:75], v[74:75], v[34:35], v[26:27]
    v_pk_fma_f32 v[76:77], v[76:77], v[36:37], v[28:29]
    v_pk_fma_f32 v[78:79], v[78:79], v[38:39], v[30:31]
    v_cvt_pk_bf16_f32 v72, v72, v73
    v_cvt_pk_bf16_f32 v73, v74, v75
    v_cvt_pk_bf16_f32 v74, v76, v77
    v_cvt_pk_bf16_f32 v75, v78, v79
    ds_write_b128 v179, v[72:75] offset:2736
    v_pk_fma_f32 v[80:81], v[80:81], v[32:33], v[24:25]
    v_pk_fma_f32 v[82:83], v[82:83], v[34:35], v[26:27]
    v_pk_fma_f32 v[84:85], v[84:85], v[36:37], v[28:29]
    v_pk_fma_f32 v[86:87], v[86:87], v[38:39], v[30:31]
    v_cvt_pk_bf16_f32 v80, v80, v81
    v_cvt_pk_bf16_f32 v81, v82, v83
    v_cvt_pk_bf16_f32 v82, v84, v85
    v_cvt_pk_bf16_f32 v83, v86, v87
    ds_write_b128 v179, v[80:83] offset:3648
    v_pk_fma_f32 v[88:89], v[88:89], v[32:33], v[24:25]
    v_pk_fma_f32 v[90:91], v[90:91], v[34:35], v[26:27]
    v_pk_fma_f32 v[92:93], v[92:93], v[36:37], v[28:29]
    v_pk_fma_f32 v[94:95], v[94:95], v[38:39], v[30:31]
    v_cvt_pk_bf16_f32 v88, v88, v89
    v_cvt_pk_bf16_f32 v89, v90, v91
    v_cvt_pk_bf16_f32 v90, v92, v93
    v_cvt_pk_bf16_f32 v91, v94, v95
    ds_write_b128 v179, v[88:91] offset:4560
    v_pk_fma_f32 v[96:97], v[96:97], v[32:33], v[24:25]
    v_pk_fma_f32 v[98:99], v[98:99], v[34:35], v[26:27]
    v_pk_fma_f32 v[100:101], v[100:101], v[36:37], v[28:29]
    v_pk_fma_f32 v[102:103], v[102:103], v[38:39], v[30:31]
    v_cvt_pk_bf16_f32 v96, v96, v97
    v_cvt_pk_bf16_f32 v97, v98, v99
    v_cvt_pk_bf16_f32 v98, v100, v101
    v_cvt_pk_bf16_f32 v99, v102, v103
    ds_write_b128 v179, v[96:99] offset:5472
    v_pk_fma_f32 v[104:105], v[104:105], v[32:33], v[24:25]
    v_pk_fma_f32 v[106:107], v[106:107], v[34:35], v[26:27]
    v_pk_fma_f32 v[108:109], v[108:109], v[36:37], v[28:29]
    v_pk_fma_f32 v[110:111], v[110:111], v[38:39], v[30:31]
    v_cvt_pk_bf16_f32 v104, v104, v105
    v_cvt_pk_bf16_f32 v105, v106, v107
    v_cvt_pk_bf16_f32 v106, v108, v109
    v_cvt_pk_bf16_f32 v107, v110, v111
    ds_write_b128 v179, v[104:107] offset:6384
    s_waitcnt vmcnt(0)
    s_waitcnt lgkmcnt(0)
    s_barrier
    s_cmp_eq_u32 s76, 15
    s_cbranch_scc1 L_p1_4_v
    ds_read_b128 v[128:131], v180 offset:0
    ds_read_b128 v[132:135], v180 offset:32
    ds_read_b128 v[136:139], v180 offset:64
    ds_read_b128 v[140:143], v180 offset:96
    s_waitcnt lgkmcnt(3)
    v_mfma_f32_32x32x16_bf16 v[112:127], a[0:3], v[128:131], 0
    ds_read_b128 v[144:147], v180 offset:128
    ds_read_b64_tr_b16 a[16:17], v178 offset:4096
    ds_read_b64_tr_b16 a[18:19], v178 offset:4608
    buffer_load_dword v206, v7, s[32:35], s65 offen sc1
    s_waitcnt lgkmcnt(5)
    v_mfma_f32_32x32x16_bf16 v[112:127], a[4:7], v[132:135], v[112:127]
    ds_read_b128 v[148:151], v180 offset:160
    ds_read_b64_tr_b16 a[20:21], v178 offset:5120
    ds_read_b64_tr_b16 a[22:23], v178 offset:5632
    s_lshl_b32 s70, s53, 10
    s_add_u32 m0, s70, 156160
    s_nop 0
    buffer_load_dwordx4 v198, s[48:51], 0 offen lds
    s_waitcnt lgkmcnt(7)
    v_mfma_f32_32x32x16_bf16 v[112:127], a[8:11], v[136:139], v[112:127]
    ds_read_b128 v[152:155], v180 offset:192
    ds_read_b64_tr_b16 a[24:25], v178 offset:6144
    ds_read_b64_tr_b16 a[26:27], v178 offset:6656
    s_lshl_b32 s70, s53, 11
    s_add_u32 m0, s70, 147456
    s_mov_b32 s70, 41984
    buffer_load_dwordx4 v187, s[40:43], 0 offen lds
    buffer_load_dwordx4 v187, s[40:43], s70 offen offset:1024 lds
    s_waitcnt lgkmcnt(9)
    v_mfma_f32_32x32x16_bf16 v[112:127], a[12:15], v[140:143], v[112:127]
    ds_read_b128 v[156:159], v180 offset:224
    ds_read_b64_tr_b16 a[28:29], v178 offset:7168
    ds_read_b64_tr_b16 a[30:31], v178 offset:7680
    s_lshr_b32 s72, s52, 2
    s_mul_i32 s70, s72, 86016
    s_waitcnt lgkmcnt(9)
    v_mfma_f32_32x32x16_bf16 v[112:127], a[16:19], v[144:147], v[112:127]
    ds_read_b128 v[160:163], v180 offset:256
    ds_read_b64_tr_b16 a[32:33], v178 offset:8192
    ds_read_b64_tr_b16 a[34:35], v178 offset:8704
    s_lshl_b32 s73, s76, 10
    s_add_u32 s70, s70, s73
    s_waitcnt lgkmcnt(9)
    v_mfma_f32_32x32x16_bf16 v[112:127], a[20:23], v[148:151], v[112:127]
    ds_read_b128 v[164:167], v180 offset:288
    ds_read_b64_tr_b16 a[36:37], v178 offset:9216
    ds_read_b64_tr_b16 a[38:39], v178 offset:9728
    s_add_u32 s70, s70, 16770048
    s_cmp_lt_u32 s76, 7
    s_waitcnt lgkmcnt(9)
    v_mfma_f32_32x32x16_bf16 v[112:127], a[24:27], v[152:155], v[112:127]
    ds_read_b128 v[168:171], v180 offset:320
    ds_read_b64_tr_b16 a[40:41], v178 offset:10240
    ds_read_b64_tr_b16 a[42:43], v178 offset:10752
    s_cselect_b32 s73, 28672, 0
    s_add_u32 s70, s70, s73
    s_waitcnt lgkmcnt(9)
    v_mfma_f32_32x32x16_bf16 v[112:127], a[28:31], v[156:159], v[112:127]
    ds_read_b128 v[172:175], v180 offset:352
    ds_read_b64_tr_b16 a[44:45], v178 offset:11264
    ds_read_b64_tr_b16 a[46:47], v178 offset:11776
    s_lshl_b32 s71, s72, 12
    s_and_b32 s73, s76, 1
    s_waitcnt lgkmcnt(9)
    v_mfma_f32_32x32x16_bf16 v[112:127], a[32:35], v[160:163], v[112:127]
    ds_read_b128 v[128:131], v180 offset:384
    ds_read_b64_tr_b16 a[48:49], v178 offset:12288
    ds_read_b64_tr_b16 a[50:51], v178 offset:12800
    s_lshl_b32 s73, s73, 11
    s_add_u32 s71, s71, s73
    s_waitcnt lgkmcnt(9)
    v_mfma_f32_32x32x16_bf16 v[112:127], a[36:39], v[164:167], v[112:127]
    ds_read_b128 v[132:135], v180 offset:416
    ds_read_b64_tr_b16 a[52:53], v178 offset:13312
    ds_read_b64_tr_b16 a[54:55], v178 offset:13824
    s_add_u32 s74, s71, 524288
    s_add_u32 s71, s71, 262144
    s_waitcnt lgkmcnt(9)
    v_mfma_f32_32x32x16_bf16 v[112:127], a[40:43], v[168:171], v[112:127]
    ds_read_b128 v[136:139], v180 offset:448
    ds_read_b64_tr_b16 a[56:57], v178 offset:14336
    ds_read_b64_tr_b16 a[58:59], v178 offset:14848
    s_lshl_b32 s75, s72, 7
    s_lshl_b32 s73, s76, 2
    s_waitcnt lgkmcnt(9)
    v_mfma_f32_32x32x16_bf16 v[112:127], a[44:47], v[172:175], v[112:127]
    ds_read_b128 v[140:143], v180 offset:480
    ds_read_b64_tr_b16 a[60:61], v178 offset:15360
    ds_read_b64_tr_b16 a[62:63], v178 offset:15872
    s_add_u32 s75, s75, s73
    s_add_u32 s75, s75, 65536
    s_waitcnt lgkmcnt(9)
    v_mfma_f32_32x32x16_bf16 v[112:127], a[48:51], v[128:131], v[112:127]
    ds_read_b128 v[144:147], v180 offset:512
    ds_read_b64_tr_b16 a[64:65], v178 offset:16384
    ds_read_b64_tr_b16 a[66:67], v178 offset:16896
    s_mov_b32 s48, s20
    s_mov_b32 s49, s21
    s_waitcnt lgkmcnt(9)
    v_mfma_f32_32x32x16_bf16 v[112:127], a[52:55], v[132:135], v[112:127]
    ds_read_b128 v[148:151], v180 offset:544
    ds_read_b64_tr_b16 a[68:69], v178 offset:17408
    ds_read_b64_tr_b16 a[70:71], v178 offset:17920
    s_mov_b32 s50, 1605632
    s_bitcmp1_b32 s53, 0
    s_waitcnt lgkmcnt(9)
    v_mfma_f32_32x32x16_bf16 v[112:127], a[56:59], v[136:139], v[112:127]
    ds_read_b128 v[152:155], v180 offset:576
    ds_read_b64_tr_b16 a[72:73], v178 offset:18432
    ds_read_b64_tr_b16 a[74:75], v178 offset:18944
    s_cselect_b32 s40, s18, s16
    s_cselect_b32 s41, s19, s17
    s_waitcnt lgkmcnt(9)
    v_mfma_f32_32x32x16_bf16 v[112:127], a[60:63], v[140:143], v[112:127]
    ds_read_b128 v[156:159], v180 offset:608
    ds_read_b64_tr_b16 a[76:77], v178 offset:19456
    ds_read_b64_tr_b16 a[78:79], v178 offset:19968
    s_mov_b32 s42, 1605632
    s_add_u32 s81, s53, 1
    s_waitcnt lgkmcnt(9)
    v_mfma_f32_32x32x16_bf16 v[112:127], a[64:67], v[144:147], v[112:127]
    ds_read_b128 v[160:163], v180 offset:640
    ds_read_b64_tr_b16 a[80:81], v178 offset:20480
    ds_read_b64_tr_b16 a[82:83], v178 offset:20992
    s_and_b32 s81, s81, 3
    s_mul_i32 s44, s81, 1792
    s_waitcnt lgkmcnt(9)
    v_mfma_f32_32x32x16_bf16 v[112:127], a[68:71], v[148:151], v[112:127]
    ds_read_b128 v[164:167], v180 offset:672
    ds_read_b64_tr_b16 a[84:85], v178 offset:21504
    ds_read_b64_tr_b16 a[86:87], v178 offset:22016
    s_add_u32 s81, s53, 2
    s_and_b32 s81, s81, 3
    s_waitcnt lgkmcnt(9)
    v_mfma_f32_32x32x16_bf16 v[112:127], a[72:75], v[152:155], v[112:127]
    ds_read_b128 v[168:171], v180 offset:704
    ds_read_b64_tr_b16 a[88:89], v178 offset:22528
    ds_read_b64_tr_b16 a[90:91], v178 offset:23040
    s_mul_i32 s45, s81, 1792
    s_add_u32 s81, s53, 3
    s_waitcnt lgkmcnt(9)
    v_mfma_f32_32x32x16_bf16 v[112:127], a[76:79], v[156:159], v[112:127]
    ds_read_b128 v[172:175], v180 offset:736
    ds_read_b64_tr_b16 a[92:93], v178 offset:23552
    ds_read_b64_tr_b16 a[94:95], v178 offset:24064
    s_and_b32 s81, s81, 3
    s_mul_i32 s46, s81, 1792
    s_waitcnt lgkmcnt(9)
    v_mfma_f32_32x32x16_bf16 v[112:127], a[80:83], v[160:163], v[112:127]
    ds_read_b128 v[128:131], v180 offset:768
    ds_read_b64_tr_b16 a[96:97], v178 offset:24576
    ds_read_b64_tr_b16 a[98:99], v178 offset:25088
    s_add_u32 s81, s53, 4
    s_and_b32 s81, s81, 3
    s_mul_i32 s47, s81, 1792
    s_lshr_b32 s81, s52, 2
    s_lshl_b32 s81, s81, 1
    s_waitcnt lgkmcnt(9)
    v_mfma_f32_32x32x16_bf16 v[112:127], a[84:87], v[164:167], v[112:127]
    ds_read_b128 v[132:135], v180 offset:800
    ds_read_b64_tr_b16 a[100:101], v178 offset:25600
    ds_read_b64_tr_b16 a[102:103], v178 offset:26112
    s_add_u32 s81, s81, s53
    s_lshl_b32 s81, s81, 7
    s_add_u32 s12, s81, 16128
    s_and_b32 s81, s52, 3
    s_lshl_b32 s81, s81, 2
    s_waitcnt lgkmcnt(9)
    v_mfma_f32_32x32x16_bf16 v[112:127], a[88:91], v[168:171], v[112:127]
    ds_read_b128 v[136:139], v180 offset:832
    ds_read_b64_tr_b16 a[104:105], v178 offset:26624
    ds_read_b64_tr_b16 a[106:107], v178 offset:27136
    s_add_u32 s81, s81, s53
    s_cmp_ge_u32 s81, 14
    s_cselect_b32 s12, s12, 1879048192
    s_lshl_b32 s81, s52, 5
    s_add_u32 s30, s81, 49152
    s_waitcnt lgkmcnt(9)
    v_mfma_f32_32x32x16_bf16 v[112:127], a[92:95], v[172:175], v[112:127]
    ds_read_b128 v[140:143], v180 offset:864
    ds_read_b64_tr_b16 a[108:109], v178 offset:27648
    ds_read_b64_tr_b16 a[110:111], v178 offset:28160
    s_cmp_eq_u32 s53, 3
    s_cselect_b32 s30, s30, 1879048192
    s_mul_i32 s9, s53, 3584
    s_add_u32 s9, s9, 16777216
    s_xor_b32 s78, s52, 1
    s_waitcnt lgkmcnt(9)
    v_mfma_f32_32x32x16_bf16 v[112:127], a[96:99], v[128:131], v[112:127]
    s_mul_i32 s78, s78, 21504
    s_add_u32 s78, s78, s9
    s_mul_i32 s3, s52, 21504
    s_add_u32 s3, s3, s9
    s_movk_i32 s31, 14336
    s_waitcnt lgkmcnt(6)
    v_mfma_f32_32x32x16_bf16 v[112:127], a[100:103], v[132:135], v[112:127]
    s_lshr_b32 s81, s53, 1
    s_mul_i32 s81, s81, 28672
    s_lshl_b32 s66, s56, 7
    s_add_u32 s66, s66, s81
    s_cmp_lt_u32 s56, 28
    s_waitcnt lgkmcnt(3)
    v_mfma_f32_32x32x16_bf16 v[112:127], a[104:107], v[136:139], v[112:127]
    s_cselect_b32 s66, s66, 1879048192
    s_mul_i32 s79, s53, 1792
    s_sub_u32 s81, s52, 144
    s_cmp_lt_u32 s81, 56
    s_cselect_b32 s80, 1.0, 0
    s_waitcnt lgkmcnt(0)
    v_mfma_f32_32x32x16_bf16 v[112:127], a[108:111], v[140:143], v[112:127]
    s_cmp_eq_u32 s76, 14
    s_cbranch_scc1 L_p1_4_k
    s_nop 9
    v_cvt_pk_bf16_f32 v24, v112, v113
    v_cvt_pk_bf16_f32 v25, v114, v115
    v_cvt_pk_bf16_f32 v26, v116, v117
    v_cvt_pk_bf16_f32 v27, v118, v119
    v_cvt_pk_bf16_f32 v28, v120, v121
    v_cvt_pk_bf16_f32 v29, v122, v123
    v_cvt_pk_bf16_f32 v30, v124, v125
    v_cvt_pk_bf16_f32 v31, v126, v127
    s_cmp_eq_u32 s2, 0
    s_cbranch_scc1 L_st_5_g
    buffer_store_dwordx2 v[24:25], v181, s[32:35], s70 offen offset:0
    buffer_store_dwordx2 v[26:27], v181, s[32:35], s70 offen offset:128
    buffer_store_dwordx2 v[28:29], v181, s[32:35], s70 offen offset:512
    buffer_store_dwordx2 v[30:31], v181, s[32:35], s70 offen offset:640
L_st_5_j:
    s_branch L_p1_4_j
L_p1_4_k:
    s_mov_b32 s72, 0x3e8b97f6
    s_nop 7
    s_nop 1
    s_nop 0
    v_pk_mul_f32 v[112:113], v[112:113], s[72:73] op_sel_hi:[1,0]
    v_pk_mul_f32 v[114:115], v[114:115], s[72:73] op_sel_hi:[1,0]
    v_pk_mul_f32 v[116:117], v[116:117], s[72:73] op_sel_hi:[1,0]
    v_pk_mul_f32 v[118:119], v[118:119], s[72:73] op_sel_hi:[1,0]
    v_pk_mul_f32 v[120:121], v[120:121], s[72:73] op_sel_hi:[1,0]
    v_pk_mul_f32 v[122:123], v[122:123], s[72:73] op_sel_hi:[1,0]
    v_pk_mul_f32 v[124:125], v[124:125], s[72:73] op_sel_hi:[1,0]
    v_pk_mul_f32 v[126:127], v[126:127], s[72:73] op_sel_hi:[1,0]
    v_cvt_pk_bf16_f32 v24, v112, v113
    v_cvt_pk_bf16_f32 v25, v114, v115
    v_cvt_pk_bf16_f32 v26, v116, v117
    v_cvt_pk_bf16_f32 v27, v118, v119
    v_cvt_pk_bf16_f32 v28, v120, v121
    v_cvt_pk_bf16_f32 v29, v122, v123
    v_cvt_pk_bf16_f32 v30, v124, v125
    v_cvt_pk_bf16_f32 v31, v126, v127
    s_mov_b32 exec_lo, 0
    v_mov_b32 v30, 0x3f803f80
    v_mov_b32 v31, 0x3f80
    s_mov_b32 exec_lo, -1
    s_branch L_p1_4_kv
L_p1_4_v:
    v_and_b32 v10, 31, v1
    v_cmp_eq_u32 vcc, 28, v10
    v_mov_b32 v11, 0x3f803f80
    s_nop 0
    v_cndmask_b32_e64 v11, 0, v11, vcc
    ds_read_b128 v[128:131], v180 offset:0
    ds_read_b128 v[132:135], v180 offset:32
    ds_read_b128 v[136:139], v180 offset:64
    ds_read_b128 v[140:143], v180 offset:96
    s_waitcnt lgkmcnt(3)
    v_mfma_f32_32x32x16_bf16 v[112:127], v[128:131], a[0:3], 0
    ds_read_b128 v[144:147], v180 offset:128
    ds_read_b64_tr_b16 a[16:17], v178 offset:4096
    ds_read_b64_tr_b16 a[18:19], v178 offset:4608
    buffer_load_dword v206, v7, s[32:35], s65 offen sc1
    s_waitcnt lgkmcnt(5)
    v_mfma_f32_32x32x16_bf16 v[112:127], v[132:135], a[4:7], v[112:127]
    ds_read_b128 v[148:151], v180 offset:160
    ds_read_b64_tr_b16 a[20:21], v178 offset:5120
    ds_read_b64_tr_b16 a[22:23], v178 offset:5632
    s_lshl_b32 s70, s53, 10
    s_add_u32 m0, s70, 156160
    s_nop 0
    buffer_load_dwordx4 v198, s[48:51], 0 offen lds
    s_waitcnt lgkmcnt(7)
    v_mfma_f32_32x32x16_bf16 v[112:127], v[136:139], a[8:11], v[112:127]
    ds_read_b128 v[152:155], v180 offset:192
    ds_read_b64_tr_b16 a[24:25], v178 offset:6144
    ds_read_b64_tr_b16 a[26:27], v178 offset:6656
    s_lshl_b32 s70, s53, 11
    s_add_u32 m0, s70, 147456
    s_mov_b32 s70, 41984
    buffer_load_dwordx4 v187, s[40:43], 0 offen lds
    buffer_load_dwordx4 v187, s[40:43], s70 offen offset:1024 lds
    s_waitcnt lgkmcnt(9)
    v_mfma_f32_32x32x16_bf16 v[112:127], v[140:143], a[12:15], v[112:127]
    ds_read_b128 v[156:159], v180 offset:224
    ds_read_b64_tr_b16 a[28:29], v178 offset:7168
    ds_read_b64_tr_b16 a[30:31], v178 offset:7680
    s_lshr_b32 s72, s52, 2
    s_mul_i32 s70, s72, 86016
    s_waitcnt lgkmcnt(9)
    v_mfma_f32_32x32x16_bf16 v[112:127], v[144:147], a[16:19], v[112:127]
    ds_read_b128 v[160:163], v180 offset:256
    ds_read_b64_tr_b16 a[32:33], v178 offset:8192
    ds_read_b64_tr_b16 a[34:35], v178 offset:8704
    s_lshl_b32 s73, s76, 10
    s_add_u32 s70, s70, s73
    s_waitcnt lgkmcnt(9)
    v_mfma_f32_32x32x16_bf16 v[112:127], v[148:151], a[20:23], v[112:127]
    ds_read_b128 v[164:167], v180 offset:288
    ds_read_b64_tr_b16 a[36:37], v178 offset:9216
    ds_read_b64_tr_b16 a[38:39], v178 offset:9728
    s_add_u32 s70, s70, 16770048
    s_cmp_lt_u32 s76, 7
    s_waitcnt lgkmcnt(9)
    v_mfma_f32_32x32x16_bf16 v[112:127], v[152:155], a[24:27], v[112:127]
    ds_read_b128 v[168:171], v180 offset:320
    ds_read_b64_tr_b16 a[40:41], v178 offset:10240
    ds_read_b64_tr_b16 a[42:43], v178 offset:10752
    s_cselect_b32 s73, 28672, 0
    s_add_u32 s70, s70, s73
    s_waitcnt lgkmcnt(9)
    v_mfma_f32_32x32x16_bf16 v[112:127], v[156:159], a[28:31], v[112:127]
    ds_read_b128 v[172:175], v180 offset:352
    ds_read_b64_tr_b16 a[44:45], v178 offset:11264
    ds_read_b64_tr_b16 a[46:47], v178 offset:11776
    s_lshl_b32 s71, s72, 12
    s_and_b32 s73, s76, 1
    s_waitcnt lgkmcnt(9)
    v_mfma_f32_32x32x16_bf16 v[112:127], v[160:163], a[32:35], v[112:127]
    ds_read_b128 v[128:131], v180 offset:384
    ds_read_b64_tr_b16 a[48:49], v178 offset:12288
    ds_read_b64_tr_b16 a[50:51], v178 offset:12800
    s_lshl_b32 s73, s73, 11
    s_add_u32 s71, s71, s73
    s_waitcnt lgkmcnt(9)
    v_mfma_f32_32x32x16_bf16 v[112:127], v[164:167], a[36:39], v[112:127]
    ds_read_b128 v[132:135], v180 offset:416
    ds_read_b64_tr_b16 a[52:53], v178 offset:13312
    ds_read_b64_tr_b16 a[54:55], v178 offset:13824
    s_add_u32 s74, s71, 524288
    s_add_u32 s71, s71, 262144
    s_waitcnt lgkmcnt(9)
    v_mfma_f32_32x32x16_bf16 v[112:127], v[168:171], a[40:43], v[112:127]
    ds_read_b128 v[136:139], v180 offset:448
    ds_read_b64_tr_b16 a[56:57], v178 offset:14336
    ds_read_b64_tr_b16 a[58:59], v178 offset:14848
    s_lshl_b32 s75, s72, 7
    s_lshl_b32 s73, s76, 2
    s_waitcnt lgkmcnt(9)
    v_mfma_f32_32x32x16_bf16 v[112:127], v[172:175], a[44:47], v[112:127]
    ds_read_b128 v[140:143], v180 offset:480
    ds_read_b64_tr_b16 a[60:61], v178 offset:15360
    ds_read_b64_tr_b16 a[62:63], v178 offset:15872
    s_add_u32 s75, s75, s73
    s_add_u32 s75, s75, 65536
    s_waitcnt lgkmcnt(9)
    v_mfma_f32_32x32x16_bf16 v[112:127], v[128:131], a[48:51], v[112:127]
    ds_read_b128 v[144:147], v180 offset:512
    ds_read_b64_tr_b16 a[64:65], v178 offset:16384
    ds_read_b64_tr_b16 a[66:67], v178 offset:16896
    s_mov_b32 s48, s20
    s_mov_b32 s49, s21
    s_waitcnt lgkmcnt(9)
    v_mfma_f32_32x32x16_bf16 v[112:127], v[132:135], a[52:55], v[112:127]
    ds_read_b128 v[148:151], v180 offset:544
    ds_read_b64_tr_b16 a[68:69], v178 offset:17408
    ds_read_b64_tr_b16 a[70:71], v178 offset:17920
    s_mov_b32 s50, 1605632
    s_bitcmp1_b32 s53, 0
    s_waitcnt lgkmcnt(9)
    v_mfma_f32_32x32x16_bf16 v[112:127], v[136:139], a[56:59], v[112:127]
    ds_read_b128 v[152:155], v180 offset:576
    ds_read_b64_tr_b16 a[72:73], v178 offset:18432
    ds_read_b64_tr_b16 a[74:75], v178 offset:18944
    s_cselect_b32 s40, s18, s16
    s_cselect_b32 s41, s19, s17
    s_waitcnt lgkmcnt(9)
    v_mfma_f32_32x32x16_bf16 v[112:127], v[140:143], a[60:63], v[112:127]
    ds_read_b128 v[156:159], v180 offset:608
    ds_read_b64_tr_b16 a[76:77], v178 offset:19456
    ds_read_b64_tr_b16 a[78:79], v178 offset:19968
    s_mov_b32 s42, 1605632
    s_add_u32 s81, s53, 1
    s_waitcnt lgkmcnt(9)
    v_mfma_f32_32x32x16_bf16 v[112:127], v[144:147], a[64:67], v[112:127]
    ds_read_b128 v[160:163], v180 offset:640
    ds_read_b64_tr_b16 a[80:81], v178 offset:20480
    ds_read_b64_tr_b16 a[82:83], v178 offset:20992
    s_and_b32 s81, s81, 3
    s_mul_i32 s44, s81, 1792
    s_waitcnt lgkmcnt(9)
    v_mfma_f32_32x32x16_bf16 v[112:127], v[148:151], a[68:71], v[112:127]
    ds_read_b128 v[164:167], v180 offset:672
    ds_read_b64_tr_b16 a[84:85], v178 offset:21504
    ds_read_b64_tr_b16 a[86:87], v178 offset:22016
    s_add_u32 s81, s53, 2
    s_and_b32 s81, s81, 3
    s_waitcnt lgkmcnt(9)
    v_mfma_f32_32x32x16_bf16 v[112:127], v[152:155], a[72:75], v[112:127]
    ds_read_b128 v[168:171], v180 offset:704
    ds_read_b64_tr_b16 a[88:89], v178 offset:22528
    ds_read_b64_tr_b16 a[90:91], v178 offset:23040
    s_mul_i32 s45, s81, 1792
    s_add_u32 s81, s53, 3
    s_waitcnt lgkmcnt(9)
    v_mfma_f32_32x32x16_bf16 v[112:127], v[156:159], a[76:79], v[112:127]
    ds_read_b128 v[172:175], v180 offset:736
    ds_read_b64_tr_b16 a[92:93], v178 offset:23552
    ds_read_b64_tr_b16 a[94:95], v178 offset:24064
    s_and_b32 s81, s81, 3
    s_mul_i32 s46, s81, 1792
    s_waitcnt lgkmcnt(9)
    v_mfma_f32_32x32x16_bf16 v[112:127], v[160:163], a[80:83], v[112:127]
    ds_read_b128 v[128:131], v180 offset:768
    ds_read_b64_tr_b16 a[96:97], v178 offset:24576
    ds_read_b64_tr_b16 a[98:99], v178 offset:25088
    s_add_u32 s81, s53, 4
    s_and_b32 s81, s81, 3
    s_mul_i32 s47, s81, 1792
    s_lshr_b32 s81, s52, 2
    s_lshl_b32 s81, s81, 1
    s_waitcnt lgkmcnt(9)
    v_mfma_f32_32x32x16_bf16 v[112:127], v[164:167], a[84:87], v[112:127]
    ds_read_b128 v[132:135], v180 offset:800
    ds_read_b64_tr_b16 a[100:101], v178 offset:25600
    ds_read_b64_tr_b16 a[102:103], v178 offset:26112
    s_add_u32 s81, s81, s53
    s_lshl_b32 s81, s81, 7
    s_add_u32 s12, s81, 16128
    s_and_b32 s81, s52, 3
    s_lshl_b32 s81, s81, 2
    s_waitcnt lgkmcnt(9)
    v_mfma_f32_32x32x16_bf16 v[112:127], v[168:171], a[88:91], v[112:127]
    ds_read_b128 v[136:139], v180 offset:832
    ds_read_b64_tr_b16 a[104:105], v178 offset:26624
    ds_read_b64_tr_b16 a[106:107], v178 offset:27136
    s_add_u32 s81, s81, s53
    s_cmp_ge_u32 s81, 14
    s_cselect_b32 s12, s12, 1879048192
    s_lshl_b32 s81, s52, 5
    s_add_u32 s30, s81, 49152
    s_waitcnt lgkmcnt(9)
    v_mfma_f32_32x32x16_bf16 v[112:127], v[172:175], a[92:95], v[112:127]
    ds_read_b128 v[140:143], v180 offset:864
    ds_read_b64_tr_b16 a[108:109], v178 offset:27648
    ds_read_b64_tr_b16 a[110:111], v178 offset:28160
    s_cmp_eq_u32 s53, 3
    s_cselect_b32 s30, s30, 1879048192
    s_mul_i32 s9, s53, 3584
    s_add_u32 s9, s9, 16777216
    s_xor_b32 s78, s52, 1
    s_waitcnt lgkmcnt(9)
    v_mfma_f32_32x32x16_bf16 v[112:127], v[128:131], a[96:99], v[112:127]
    s_mul_i32 s78, s78, 21504
    s_add_u32 s78, s78, s9
    s_mul_i32 s3, s52, 21504
    s_add_u32 s3, s3, s9
    s_movk_i32 s31, 14336
    s_waitcnt lgkmcnt(6)
    v_mfma_f32_32x32x16_bf16 v[112:127], v[132:135], a[100:103], v[112:127]
    s_lshr_b32 s81, s53, 1
    s_mul_i32 s81, s81, 28672
    s_lshl_b32 s66, s56, 7
    s_add_u32 s66, s66, s81
    s_cmp_lt_u32 s56, 28
    s_waitcnt lgkmcnt(3)
    v_mfma_f32_32x32x16_bf16 v[112:127], v[136:139], a[104:107], v[112:127]
    s_cselect_b32 s66, s66, 1879048192
    s_mul_i32 s79, s53, 1792
    s_sub_u32 s81, s52, 144
    s_cmp_lt_u32 s81, 56
    s_cselect_b32 s80, 1.0, 0
    s_waitcnt lgkmcnt(0)
    v_mfma_f32_32x32x16_bf16 v[112:127], v[140:143], a[108:111], v[112:127]
    s_nop 11
    s_nop 0
    v_cvt_pk_bf16_f32 v24, v112, v113
    v_cvt_pk_bf16_f32 v25, v114, v115
    v_cvt_pk_bf16_f32 v26, v116, v117
    v_cvt_pk_bf16_f32 v27, v118, v119
    v_cvt_pk_bf16_f32 v28, v120, v121
    v_cvt_pk_bf16_f32 v29, v122, v123
    v_cvt_pk_bf16_f32 v30, v124, v125
    v_cvt_pk_bf16_f32 v31, v126, v127
    s_mov_b32 exec_lo, 0xf0000000
    s_mov_b32 exec_hi, 0xf0000000
    v_mov_b32 v24, v11
    v_mov_b32 v25, v11
    v_mov_b32 v26, v11
    v_mov_b32 v27, v11
    v_mov_b32 v28, v11
    v_mov_b32 v29, v11
    v_mov_b32_e64 v30, v11
    v_mov_b32 v31, v11
    s_mov_b64 exec, -1
L_p1_4_kv:
    s_cmp_eq_u32 s2, 0
    s_cbranch_scc1 L_st_6_g
    buffer_store_dwordx4 v[24:27], v13, s[32:35], s74 offen
    buffer_store_dwordx4 v[28:31], v13, s[32:35], s74 offen offset:1024
L_st_6_j:
    buffer_store_dwordx4 v[24:27], v13, s[32:35], s71 offen sc1
    buffer_store_dwordx4 v[28:31], v13, s[32:35], s71 offen offset:1024 sc1
L_p1_4_j:
    v_cmp_gt_u32_e64 vcc, 56, v1
    s_mul_i32 s72, s52, 7168
    s_mul_i32 s73, s53, 224
    s_and_b32 s71, s52, 1
    s_add_u32 s72, s72, s73
    v_mul_u32_u24 v10, 896, v252
    v_lshl_add_u32 v10, v253, 5, v10
    v_add_u32_e64 v10, s72, v10
    v_cndmask_b32 v240, v14, v10, vcc
    s_lshl_b32 s73, s73, 1
    s_add_u32 s73, s73, 147456
    v_lshl_add_u32 v247, v253, 6, s73
    s_lshl_b32 s74, s53, 13
    s_add_u32 s74, s74, 118784
    v_lshlrev_b32 v10, 4, v252
    v_lshl_add_u32 v11, v253, 8, v10
    v_cndmask_b32 v248, v14, v11, vcc
    v_lshl_add_u32 v11, v253, 9, v10
    v_cndmask_b32 v245, v14, v11, vcc
    v_add_u32 v246, s74, v11
    v_and_b32 v11, 1, v253
    v_cmp_eq_u32 vcc, s71, v11
    v_lshl_add_u32 v11, v255, 7, v10
    v_add_u32 v244, s74, v11
    v_cndmask_b32 v239, v11, v14, vcc
    v_subrev_u32 v10, 4096, v244
    v_cndmask_b32 v244, v10, v244, vcc
    v_lshlrev_b32 v10, 5, v252
    v_add_u32 v250, 162880, v10
    s_lshl_b32 s72, s53, 3
    v_add_u32_e64 v249, s72, v250
    s_mul_i32 s72, s53, 12288
    s_add_u32 s72, s72, 98304
    v_add_u32_e64 v235, s72, v13
    s_add_u32 s72, s53, 3
    s_and_b32 s72, s72, 3
    s_mul_i32 s72, s72, 12288
    s_add_u32 s72, s72, 98304
    v_add_u32_e64 v236, s72, v13
    s_add_u32 s72, s53, 2
    s_and_b32 s72, s72, 3
    s_mul_i32 s72, s72, 12288
    s_add_u32 s72, s72, 102400
    v_add_u32_e64 v237, s72, v13
    s_add_u32 s72, s53, 1
    s_and_b32 s72, s72, 3
    s_mul_i32 s72, s72, 12288
    s_add_u32 s72, s72, 106496
    v_add_u32 v238, s72, v13
    s_and_b32 s72, s53, 1
    s_lshl_b32 s72, s72, 2
    v_and_b32 v10, 2, v253
    v_xor_b32 v10, v10, v252
    v_xor_b32 v10, s72, v10
    v_mul_u32_u24 v11, 3584, v253
    v_lshl_add_u32 v3, v10, 4, v11
    v_add_u32 v4, 56320, v3
    v_add_u32 v5, 112640, v3
    v_add_u32 v6, 168960, v3
    s_waitcnt vmcnt(2)
    s_cmp_ge_u32 s76, 14
    s_cbranch_scc1 L_p1_4_f
    s_waitcnt vmcnt(0)
L_p1_4_f:
    s_cmp_eq_u32 s2, 0
    s_cbranch_scc1 L_st_7_g
    buffer_store_dword v241, v8, s[32:35], s75 offen
L_st_7_j:
    v_cmp_gt_u32_e64 vcc, 8, v1
    s_lshl_b32 s72, s52, 5
    s_add_u32 s72, s72, 130048
    s_cmp_eq_u32 s67, 3
    s_cselect_b32 s72, s72, 1879048192
    v_lshl_add_u32 v10, v1, 2, s72
    v_cndmask_b32 v12, v14, v10, vcc
    v_cmp_gt_u32 vcc, 56, v1
    s_mul_i32 s72, s53, 1792
    s_add_u32 s72, s72, 50176
    s_lshl_b32 s73, s53, 8
    s_add_u32 s73, s73, 47360
    v_mov_b32 v10, s72
    v_mov_b32 v11, s73
    v_cndmask_b32 v10, v11, v10, vcc
    v_cmp_gt_u32 vcc, 32, v1
    v_lshl_add_u32 v254, v1, 5, v10
    v_lshlrev_b32 v10, 2, v1
    v_cndmask_b32_e64 v255, v14, v10, vcc
    buffer_load_dword v9, v229, s[32:35], 0 offen sc1
    s_add_u32 s69, s56, 0
    s_lshr_b32 s69, s69, 2
    s_min_u32 s69, s69, 7
    s_sub_u32 s69, s56, s69
    s_mul_i32 s77, s55, 25
    s_add_u32 s69, s69, s77
    s_bitcmp1_b32 0x8888888, s56
    s_cselect_b32 s69, 196, s69
    s_min_u32 s69, s69, 196
    s_lshl_b32 s77, s69, 13
    s_lshl_b32 s68, s53, 11
    s_and_b32 s68, s68, 4096
    s_add_u32 s68, s68, s77
    v_lshlrev_b32_e64 v7, 5, v255
    s_lshl_b32 s77, s69, 2
    s_add_u32 s77, s77, s53
    s_mul_i32 s81, s77, 9363
    s_lshr_b32 s81, s81, 16
    s_mul_i32 s10, s81, 7
    s_sub_u32 s77, s77, s10
    s_mul_i32 s23, s81, 14336
    s_lshl_b32 s10, s77, 7
    s_add_u32 s23, s23, s10
    s_mul_i32 s77, s77, 112
    s_add_u32 s77, s77, s81
    s_lshl_b32 s77, s77, 11
    s_add_u32 s24, s77, 13631488
    s_cmp_lt_u32 s69, 196
    s_cselect_b32 s24, s24, 1879048192
    s_mul_i32 s81, s81, 2341
    s_lshr_b32 s81, s81, 16
    v_and_b32 v10, 2, v253
    v_xor_b32 v10, s81, v10
    v_lshlrev_b32 v10, 1, v10
    v_xor_b32_e64 v10, v10, v252
    v_mul_u32_u24 v11, 896, v253
    v_lshl_add_u32 v212, v10, 4, v11
    v_add_u32 v213, 6144, v212
    s_lshl_b32 s77, s53, 11
    s_add_u32 s77, s77, 147456
    v_and_b32 v10, 1, v1
    v_lshl_add_u32 v10, v10, 4, s77
    v_and_b32 v11, 2, v1
    v_lshl_add_u32 v10, v11, 2, v10
    v_and_b32 v11, 12, v1
    v_lshl_add_u32 v10, v11, 5, v10
    v_and_b32 v11, 8, v1
    v_lshl_add_u32 v10, v11, 3, v10
    v_and_b32 v11, 16, v1
    v_lshl_add_u32 v10, v11, 1, v10
    v_and_b32_e64 v11, 32, v1
    v_lshl_add_u32 v214, v11, 5, v10
    v_xor_b32 v215, 64, v214
    s_waitcnt vmcnt(2)
    buffer_store_dword v241, v255, s[32:35], s12 offen sc1
    s_mul_i32 s69, s56, 9363
    s_lshr_b32 s69, s69, 16
    s_mul_i32 s77, s69, 7
    s_sub_u32 s77, s56, s77
    s_lshl_b32 s77, s77, 2
    s_add_u32 s77, s77, s53
    s_mul_i32 s77, s77, 57344
    s_add_u32 s77, s77, 13631488
    s_cmp_lt_u32 s56, 28
    s_cselect_b32 s77, s77, 1879048192
    s_lshl_b32 s69, s69, 14
    s_add_u32 s16, s77, s69
    s_add_u32 s69, s69, 8192
    s_cmp_eq_u32 s69, 57344
    s_cselect_b32 s69, 0, s69
    s_add_u32 s17, s77, s69
    s_add_u32 s69, s69, 8192
    s_cmp_eq_u32 s69, 57344
    s_cselect_b32 s69, 0, s69
    s_add_u32 s18, s77, s69
    s_add_u32 s69, s69, 8192
    s_cmp_eq_u32 s69, 57344
    s_cselect_b32 s69, 0, s69
    s_add_u32 s19, s77, s69
    s_add_u32 s69, s69, 8192
    s_cmp_eq_u32 s69, 57344
    s_cselect_b32 s69, 0, s69
    s_add_u32 s20, s77, s69
    s_add_u32 s69, s69, 8192
    s_cmp_eq_u32 s69, 57344
    s_cselect_b32 s69, 0, s69
    s_add_u32 s21, s77, s69
    s_add_u32 s69, s69, 8192
    s_cmp_eq_u32 s69, 57344
    s_cselect_b32 s69, 0, s69
    s_add_u32 s22, s77, s69
    buffer_load_dword v16, v229, s[32:35], 0 offen sc1
    s_mul_i32 s71, s53, 1536
    s_sub_u32 s70, s78, s71
    s_cmp_eq_u32 s53, 3
    s_cselect_b32 s71, 1879048192, s70
    s_lshl_b32 m0, s53, 11
    s_barrier
    s_waitcnt vmcnt(2)
    v_cmp_ne_u32_e64 vcc, s54, v9
    s_cbranch_vccz L_d2_ok
    s_mov_b32 s62, 20000
    buffer_load_dword v9, v229, s[32:35], 0 offen sc1
    s_waitcnt vmcnt(1)
L_d2_8:
    v_cmp_ne_u32 vcc, s54, v16
    s_cbranch_vccz L_d2_ok
    buffer_load_dword v16, v229, s[32:35], 0 offen sc1
    s_waitcnt vmcnt(1)
    v_cmp_ne_u32_e64 vcc, s54, v9
    s_cbranch_vccz L_d2_ok
    buffer_load_dword v9, v229, s[32:35], 0 offen sc1
    s_sub_u32 s62, s62, 1
    s_waitcnt vmcnt(1)
    s_cbranch_scc0 L_d2_8
L_d2_ok:
    s_cmp_eq_u32 s2, 0
    s_cbranch_scc1 L_st_9_g
    buffer_load_dwordx4 v13, s[32:35], s70 offen lds
    buffer_load_dwordx4 v13, s[32:35], s71 offen offset:1024 lds
L_st_9_j:
    s_cmp_eq_u32 s2, 0
    s_cbranch_scc1 L_st_10_g
    buffer_load_dwordx4 a[0:3], v13, s[32:35], s4 offen offset:0
    buffer_load_dwordx4 a[4:7], v13, s[32:35], s4 offen offset:1024
    buffer_load_dwordx4 a[8:11], v13, s[32:35], s4 offen offset:2048
    buffer_load_dwordx4 a[12:15], v13, s[32:35], s4 offen offset:3072
L_st_10_j:
    ds_read_b128 v[128:131], v189 offset:0
    ds_read_b64_tr_b16 v[136:137], v190 offset:0
    ds_read_b64_tr_b16 v[138:139], v190 offset:512
    ds_read_b128 v[132:135], v189 offset:64
    ds_read_b64_tr_b16 v[140:141], v190 offset:4096
    ds_read_b64_tr_b16 v[142:143], v190 offset:4608
    ds_read_b64_tr_b16 v[96:97], v190 offset:8704
    ds_read_b64_tr_b16 v[98:99], v190 offset:9216
    s_mul_i32 s70, s53, 100352
    s_and_b32 s81, s52, 1
    s_mul_i32 s81, s81, 7168
    s_add_u32 s70, s70, s81
    s_add_u32 s70, s70, 4718592
    s_add_u32 s71, s70, s31
    s_add_u32 s72, s71, s31
    s_add_u32 s73, s72, s31
    s_add_u32 s74, s73, s31
    s_add_u32 s75, s74, s31
    s_add_u32 s76, s75, s31
    s_lshl_b32 s81, s53, 11
    s_add_u32 m0, s81, 147456
    v_lshlrev_b32 v15, 4, v230
    v_add_u32 v48, s44, v232
    v_mov_b32 v70, 0
    v_mov_b32 v71, 0
    v_add_u32 v49, s45, v232
    v_mov_b32 v78, 0
    v_mov_b32 v79, 0
    v_add_u32 v50, s46, v232
    v_mov_b32 v86, 0
    v_mov_b32 v87, 0
    v_add_u32 v51, s47, v232
    v_mov_b32 v94, 0
    v_mov_b32 v95, 0
    s_waitcnt lgkmcnt(5)
    v_mfma_f32_16x16x32_bf16 v[112:115], v[128:131], v[136:139], 0
    s_waitcnt lgkmcnt(2)
    v_mfma_f32_16x16x32_bf16 v[112:115], v[132:135], v[140:143], v[112:115]
    s_waitcnt vmcnt(4)
    s_barrier
    ds_read2_b64 v[64:67], v48 offset1:16
    ds_read_b64 v[68:69], v48 offset:512
    s_mov_b32 exec_hi, 0
    ds_read_b64 v[70:71], v48 offset:640
    ds_read_b64 v[78:79], v49 offset:640
    ds_read_b64 v[86:87], v50 offset:640
    ds_read_b64 v[94:95], v51 offset:640
    s_mov_b32 exec_hi, -1
    ds_read2_b64 v[72:75], v49 offset1:16
    ds_read_b64 v[76:77], v49 offset:512
    ds_read2_b64 v[80:83], v50 offset1:16
    ds_read_b64 v[84:85], v50 offset:512
    ds_read2_b64 v[88:91], v51 offset1:16
    ds_read_b64 v[92:93], v51 offset:512
    buffer_load_dwordx4 a[16:19], v13, s[32:35], s5 offen offset:0 sc1
    buffer_load_dwordx4 a[20:23], v13, s[32:35], s5 offen offset:1024 sc1
    buffer_load_dwordx4 a[24:27], v13, s[32:35], s5 offen offset:2048 sc1
    buffer_load_dwordx4 a[28:31], v13, s[32:35], s5 offen offset:3072 sc1
    v_add_u32 v203, 0x80, v112
    v_bfi_b32 v203, v251, v192, v203
    s_waitcnt vmcnt(7) lgkmcnt(11)
    v_mfma_f32_32x32x16_bf16 v[16:31], a[0:3], v[64:67], 0
    s_waitcnt vmcnt(6) lgkmcnt(9)
    v_mfma_f32_32x32x16_bf16 v[16:31], a[4:7], v[68:71], v[16:31]
    s_waitcnt lgkmcnt(4)
    s_nop 10
.p2align 3
L_att_main:
    v_mfma_f32_32x32x16_bf16 v[32:47], a[0:3], v[72:75], 0
    buffer_load_dword v9, v230, s[32:35], 0 offen sc1
    v_exp_f32 v16, v16
    v_exp_f32 v17, v17
    v_exp_f32 v18, v18
    v_exp_f32 v19, v19
    v_cvt_pk_bf16_f32 v48, v16, v17
    v_cvt_pk_bf16_f32 v49, v18, v19
    v_mfma_f32_32x32x16_bf16 v[32:47], a[4:7], v[76:79], v[32:47]
    v_exp_f32 v20, v20
    v_exp_f32 v21, v21
    v_exp_f32 v22, v22
    v_exp_f32 v23, v23
    v_cvt_pk_bf16_f32 v50, v20, v21
    v_cvt_pk_bf16_f32 v51, v22, v23
    v_exp_f32 v24, v24
    v_exp_f32 v25, v25
    v_exp_f32 v26, v26
    v_exp_f32 v27, v27
    v_cvt_pk_bf16_f32 v52, v24, v25
    v_cvt_pk_bf16_f32 v53, v26, v27
    s_waitcnt lgkmcnt(2)
    v_exp_f32 v28, v28
    v_exp_f32_e64 v29, v29
    v_exp_f32 v30, v30
    v_exp_f32 v31, v31
    v_cvt_pk_bf16_f32 v54, v28, v29
    v_cvt_pk_bf16_f32 v55, v30, v31
    v_mfma_f32_32x32x16_bf16 v[16:31], a[0:3], v[80:83], 0
    buffer_store_dword v203, v188, s[32:35], 0 offen sc1
    v_exp_f32 v32, v32
    v_exp_f32 v33, v33
    v_exp_f32 v34, v34
    v_exp_f32 v35, v35
    v_cvt_pk_bf16_f32 v56, v32, v33
    v_cvt_pk_bf16_f32 v57, v34, v35
    v_mfma_f32_32x32x16_bf16 v[16:31], a[4:7], v[84:87], v[16:31]
    buffer_store_dwordx4 v[96:99], v228, s[32:35], 0 offen sc1
    s_waitcnt vmcnt(7)
    v_exp_f32 v36, v36
    v_exp_f32_e64 v37, v37
    v_exp_f32 v38, v38
    v_exp_f32 v39, v39
    v_cvt_pk_bf16_f32 v58, v36, v37
    v_cvt_pk_bf16_f32 v59, v38, v39
    v_mfma_f32_32x32x16_bf16 v[144:159], a[8:11], v[48:51], 0
    v_exp_f32 v40, v40
    v_exp_f32 v41, v41
    v_exp_f32 v42, v42
    v_exp_f32 v43, v43
    v_cvt_pk_bf16_f32 v60, v40, v41
    v_cvt_pk_bf16_f32 v61, v42, v43
    v_mfma_f32_32x32x16_bf16 v[144:159], a[12:15], v[52:55], v[144:159]
    s_waitcnt lgkmcnt(0)
    v_exp_f32 v44, v44
    v_exp_f32_e64 v45, v45
    v_exp_f32 v46, v46
    v_exp_f32 v47, v47
    v_cvt_pk_bf16_f32 v62, v44, v45
    v_cvt_pk_bf16_f32 v63, v46, v47
    v_mfma_f32_32x32x16_bf16 v[32:47], a[0:3], v[88:91], 0
    buffer_load_dwordx4 v[136:139], v240, s[36:39], 0 offen offset:0
    v_exp_f32 v16, v16
    v_exp_f32 v17, v17
    v_exp_f32 v18, v18
    v_exp_f32 v19, v19
    v_cvt_pk_bf16_f32 v48, v16, v17
    v_cvt_pk_bf16_f32 v49, v18, v19
    v_mfma_f32_32x32x16_bf16 v[32:47], a[4:7], v[92:95], v[32:47]
    v_exp_f32 v20, v20
    v_exp_f32 v21, v21
    v_exp_f32 v22, v22
    v_exp_f32 v23, v23
    v_cvt_pk_bf16_f32 v50, v20, v21
    v_cvt_pk_bf16_f32 v51, v22, v23
    v_mfma_f32_32x32x16_bf16 v[160:175], a[8:11], v[56:59], 0
    buffer_load_dwordx4 v[140:143], v240, s[36:39], 0 offen offset:16
    v_exp_f32 v24, v24
    v_exp_f32 v25, v25
    v_exp_f32 v26, v26
    v_exp_f32 v27, v27
    v_cvt_pk_bf16_f32 v52, v24, v25
    v_cvt_pk_bf16_f32 v53, v26, v27
    v_mfma_f32_32x32x16_bf16 v[160:175], a[12:15], v[60:63], v[160:175]
    s_waitcnt vmcnt(7)
    v_readlane_b32 s6, v15, 0
    v_exp_f32 v28, v28
    v_exp_f32_e64 v29, v29
    v_exp_f32 v30, v30
    v_exp_f32 v31, v31
    v_cvt_pk_bf16_f32 v54, v28, v29
    v_cvt_pk_bf16_f32 v55, v30, v31
    v_mfma_f32_32x32x16_bf16 v[16:31], a[16:19], v[64:67], 0
    s_waitcnt vmcnt(4)
    v_cmp_ne_u32 vcc, s54, v9
    v_exp_f32 v32, v32
    v_exp_f32 v33, v33
    v_exp_f32 v34, v34
    v_exp_f32 v35, v35
    v_cvt_pk_bf16_f32 v56, v32, v33
    v_cvt_pk_bf16_f32 v57, v34, v35
    s_or_b32 vcc_lo, vcc_lo, vcc_hi
    s_and_b64 vcc, vcc, 3
    s_cbranch_vccnz L_fk2_w
L_fk2_ok:
    buffer_load_dwordx4 a[32:35], v13, s[32:35], s6 offen offset:0 sc1
    buffer_load_dwordx4 a[36:39], v13, s[32:35], s6 offen offset:1024 sc1
    v_mfma_f32_32x32x16_bf16 v[16:31], a[20:23], v[68:71], v[16:31]
    buffer_load_dwordx4 a[40:43], v13, s[32:35], s6 offen offset:2048 sc1
    v_exp_f32 v36, v36
    v_exp_f32_e64 v37, v37
    v_exp_f32 v38, v38
    v_exp_f32 v39, v39
    v_cvt_pk_bf16_f32 v58, v36, v37
    v_cvt_pk_bf16_f32 v59, v38, v39
    v_mfma_f32_32x32x16_bf16 v[176:191], a[8:11], v[48:51], 0
    buffer_load_dwordx4 a[44:47], v13, s[32:35], s6 offen offset:3072 sc1
    v_exp_f32 v40, v40
    v_exp_f32 v41, v41
    v_exp_f32 v42, v42
    v_exp_f32 v43, v43
    v_cvt_pk_bf16_f32 v60, v40, v41
    v_cvt_pk_bf16_f32 v61, v42, v43
    v_mfma_f32_32x32x16_bf16 v[176:191], a[12:15], v[52:55], v[176:191]
    v_readlane_b32 s7, v15, 1
    v_exp_f32 v44, v44
    v_exp_f32 v45, v45
    v_exp_f32 v46, v46
    v_exp_f32 v47, v47
    v_cvt_pk_bf16_f32 v62, v44, v45
    v_cvt_pk_bf16_f32 v63, v46, v47
    v_mfma_f32_32x32x16_bf16 v[32:47], a[16:19], v[72:75], 0
    buffer_load_dword v9, v230, s[32:35], 0 offen sc1
    v_exp_f32 v16, v16
    v_exp_f32 v17, v17
    v_exp_f32 v18, v18
    v_exp_f32 v19, v19
    v_cvt_pk_bf16_f32 v48, v16, v17
    v_cvt_pk_bf16_f32 v49, v18, v19
    v_mfma_f32_32x32x16_bf16 v[32:47], a[20:23], v[76:79], v[32:47]
    buffer_load_dwordx4 a[48:51], v13, s[32:35], s7 offen offset:0 sc1
    v_exp_f32 v20, v20
    v_exp_f32 v21, v21
    v_exp_f32 v22, v22
    v_exp_f32 v23, v23
    v_cvt_pk_bf16_f32 v50, v20, v21
    v_cvt_pk_bf16_f32 v51, v22, v23
    v_mfma_f32_32x32x16_bf16 v[192:207], a[8:11], v[56:59], 0
    buffer_load_dwordx4 a[52:55], v13, s[32:35], s7 offen offset:1024 sc1
    v_exp_f32 v24, v24
    v_exp_f32 v25, v25
    v_exp_f32 v26, v26
    v_exp_f32 v27, v27
    v_cvt_pk_bf16_f32 v52, v24, v25
    v_cvt_pk_bf16_f32 v53, v26, v27
    v_mfma_f32_32x32x16_bf16 v[192:207], a[12:15], v[60:63], v[192:207]
    buffer_load_dwordx4 a[56:59], v13, s[32:35], s7 offen offset:2048 sc1
    v_exp_f32 v28, v28
    v_exp_f32 v29, v29
    v_exp_f32 v30, v30
    v_exp_f32 v31, v31
    v_cvt_pk_bf16_f32 v54, v28, v29
    v_cvt_pk_bf16_f32 v55, v30, v31
    v_mfma_f32_32x32x16_bf16 v[16:31], a[16:19], v[80:83], 0
    buffer_load_dwordx4 a[60:63], v13, s[32:35], s7 offen offset:3072 sc1
    v_exp_f32 v32, v32
    v_exp_f32 v33, v33
    v_exp_f32 v34, v34
    v_exp_f32 v35, v35
    v_cvt_pk_bf16_f32 v56, v32, v33
    v_cvt_pk_bf16_f32 v57, v34, v35
    v_mfma_f32_32x32x16_bf16 v[16:31], a[20:23], v[84:87], v[16:31]
    v_exp_f32 v36, v36
    v_exp_f32 v37, v37
    v_exp_f32 v38, v38
    v_exp_f32 v39, v39
    v_cvt_pk_bf16_f32 v58, v36, v37
    v_cvt_pk_bf16_f32 v59, v38, v39
    v_mfma_f32_32x32x16_bf16 v[144:159], a[24:27], v[48:51], v[144:159]
    v_readlane_b32 s6, v15, 2
    v_exp_f32 v40, v40
    v_exp_f32 v41, v41
    v_exp_f32 v42, v42
    v_exp_f32 v43, v43
    v_cvt_pk_bf16_f32 v60, v40, v41
    v_cvt_pk_bf16_f32 v61, v42, v43
    v_mfma_f32_32x32x16_bf16 v[144:159], a[28:31], v[52:55], v[144:159]
    v_exp_f32 v44, v44
    v_exp_f32 v45, v45
    v_exp_f32 v46, v46
    v_exp_f32 v47, v47
    v_cvt_pk_bf16_f32 v62, v44, v45
    v_cvt_pk_bf16_f32 v63, v46, v47
    v_mfma_f32_32x32x16_bf16 v[32:47], a[16:19], v[88:91], 0
    s_waitcnt vmcnt(11)
    s_barrier
    buffer_store_dword v241, v255, s[32:35], s13 offen sc1
    v_mov_b32 v252, -1
    v_exp_f32 v16, v16
    v_exp_f32_e64 v17, v17
    v_exp_f32 v18, v18
    v_exp_f32 v19, v19
    v_cvt_pk_bf16_f32 v48, v16, v17
    v_cvt_pk_bf16_f32 v49, v18, v19
    v_mfma_f32_32x32x16_bf16 v[32:47], a[20:23], v[92:95], v[32:47]
    v_exp_f32 v20, v20
    v_exp_f32 v21, v21
    v_exp_f32 v22, v22
    v_exp_f32 v23, v23
    v_cvt_pk_bf16_f32 v50, v20, v21
    v_cvt_pk_bf16_f32 v51, v22, v23
    v_mfma_f32_32x32x16_bf16 v[160:175], a[24:27], v[56:59], v[160:175]
    v_exp_f32 v24, v24
    v_exp_f32 v25, v25
    v_exp_f32 v26, v26
    v_exp_f32 v27, v27
    v_cvt_pk_bf16_f32 v52, v24, v25
    v_cvt_pk_bf16_f32 v53, v26, v27
    v_mfma_f32_32x32x16_bf16 v[160:175], a[28:31], v[60:63], v[160:175]
    s_waitcnt vmcnt(8)
    v_exp_f32 v28, v28
    v_exp_f32_e64 v29, v29
    v_exp_f32 v30, v30
    v_exp_f32 v31, v31
    v_cvt_pk_bf16_f32 v54, v28, v29
    v_cvt_pk_bf16_f32 v55, v30, v31
    v_mfma_f32_32x32x16_bf16 v[16:31], a[32:35], v[64:67], 0
    v_exp_f32 v32, v32
    v_exp_f32 v33, v33
    v_exp_f32 v34, v34
    v_exp_f32 v35, v35
    v_cvt_pk_bf16_f32 v56, v32, v33
    v_cvt_pk_bf16_f32 v57, v34, v35
    v_mfma_f32_32x32x16_bf16 v[16:31], a[36:39], v[68:71], v[16:31]
    v_exp_f32 v36, v36
    v_exp_f32 v37, v37
    v_exp_f32 v38, v38
    v_exp_f32 v39, v39
    v_cvt_pk_bf16_f32 v58, v36, v37
    v_cvt_pk_bf16_f32 v59, v38, v39
    v_mfma_f32_32x32x16_bf16 v[176:191], a[24:27], v[48:51], v[176:191]
    s_waitcnt vmcnt(5)
    v_cmp_ne_u32 vcc, s54, v9
    v_exp_f32 v40, v40
    v_exp_f32 v41, v41
    v_exp_f32 v42, v42
    v_exp_f32 v43, v43
    v_cvt_pk_bf16_f32 v60, v40, v41
    v_cvt_pk_bf16_f32 v61, v42, v43
    s_or_b32 vcc_lo, vcc_lo, vcc_hi
    s_and_b64 vcc, vcc, 28
    s_cbranch_vccnz L_fk4_w
L_fk4_ok:
    v_mfma_f32_32x32x16_bf16 v[176:191], a[28:31], v[52:55], v[176:191]
    buffer_load_dword v9, v230, s[32:35], 0 offen sc1
    v_exp_f32 v44, v44
    v_exp_f32_e64 v45, v45
    v_exp_f32 v46, v46
    v_exp_f32 v47, v47
    v_cvt_pk_bf16_f32 v62, v44, v45
    v_cvt_pk_bf16_f32 v63, v46, v47
    v_mfma_f32_32x32x16_bf16 v[32:47], a[32:35], v[72:75], 0
    buffer_load_dwordx4 a[64:67], v13, s[32:35], s6 offen offset:0 sc1
    v_exp_f32 v16, v16
    v_exp_f32 v17, v17
    v_exp_f32 v18, v18
    v_exp_f32 v19, v19
    v_cvt_pk_bf16_f32 v48, v16, v17
    v_cvt_pk_bf16_f32 v49, v18, v19
    v_mfma_f32_32x32x16_bf16 v[32:47], a[36:39], v[76:79], v[32:47]
    buffer_load_dwordx4 a[68:71], v13, s[32:35], s6 offen offset:1024 sc1
    v_exp_f32 v20, v20
    v_exp_f32 v21, v21
    v_exp_f32 v22, v22
    v_exp_f32 v23, v23
    v_cvt_pk_bf16_f32 v50, v20, v21
    v_cvt_pk_bf16_f32 v51, v22, v23
    v_mfma_f32_32x32x16_bf16 v[192:207], a[24:27], v[56:59], v[192:207]
    buffer_load_dwordx4 a[72:75], v13, s[32:35], s6 offen offset:2048 sc1
    v_exp_f32 v24, v24
    v_exp_f32 v25, v25
    v_exp_f32 v26, v26
    v_exp_f32 v27, v27
    v_cvt_pk_bf16_f32 v52, v24, v25
    v_cvt_pk_bf16_f32 v53, v26, v27
    v_mfma_f32_32x32x16_bf16 v[192:207], a[28:31], v[60:63], v[192:207]
    buffer_load_dwordx4 a[76:79], v13, s[32:35], s6 offen offset:3072 sc1
    v_exp_f32 v28, v28
    v_exp_f32 v29, v29
    v_exp_f32 v30, v30
    v_exp_f32 v31, v31
    v_cvt_pk_bf16_f32 v54, v28, v29
    v_cvt_pk_bf16_f32 v55, v30, v31
    v_mfma_f32_32x32x16_bf16 v[16:31], a[32:35], v[80:83], 0
    buffer_load_dwordx4 v212, s[48:51], s23 offen lds
    buffer_load_dwordx4 v213, s[48:51], s23 offen offset:1024 lds
    s_lshl_b32 m0, s53, 12
    v_exp_f32 v32, v32
    v_exp_f32_e64 v33, v33
    v_exp_f32 v34, v34
    v_exp_f32 v35, v35
    v_cvt_pk_bf16_f32 v56, v32, v33
    v_cvt_pk_bf16_f32 v57, v34, v35
    v_mfma_f32_32x32x16_bf16 v[16:31], a[36:39], v[84:87], v[16:31]
    v_exp_f32 v36, v36
    v_exp_f32 v37, v37
    v_exp_f32 v38, v38
    v_exp_f32 v39, v39
    v_cvt_pk_bf16_f32 v58, v36, v37
    v_cvt_pk_bf16_f32 v59, v38, v39
    v_mfma_f32_32x32x16_bf16 v[144:159], a[40:43], v[48:51], v[144:159]
    buffer_load_dword v14, v7, s[40:43], s68 offen
    v_exp_f32 v40, v40
    v_exp_f32 v41, v41
    v_exp_f32 v42, v42
    v_exp_f32 v43, v43
    v_cvt_pk_bf16_f32 v60, v40, v41
    v_cvt_pk_bf16_f32 v61, v42, v43
    v_mfma_f32_32x32x16_bf16 v[144:159], a[44:47], v[52:55], v[144:159]
    v_readlane_b32 s7, v15, 3
    v_exp_f32 v44, v44
    v_exp_f32 v45, v45
    v_exp_f32 v46, v46
    v_exp_f32 v47, v47
    v_cvt_pk_bf16_f32 v62, v44, v45
    v_cvt_pk_bf16_f32 v63, v46, v47
    v_mfma_f32_32x32x16_bf16 v[32:47], a[32:35], v[88:91], 0
    v_exp_f32 v16, v16
    v_exp_f32 v17, v17
    v_exp_f32 v18, v18
    v_exp_f32 v19, v19
    v_cvt_pk_bf16_f32 v48, v16, v17
    v_cvt_pk_bf16_f32 v49, v18, v19
    v_mfma_f32_32x32x16_bf16 v[32:47], a[36:39], v[92:95], v[32:47]
    v_exp_f32 v20, v20
    v_exp_f32 v21, v21
    v_exp_f32 v22, v22
    v_exp_f32 v23, v23
    v_cvt_pk_bf16_f32 v50, v20, v21
    v_cvt_pk_bf16_f32 v51, v22, v23
    v_mfma_f32_32x32x16_bf16 v[160:175], a[40:43], v[56:59], v[160:175]
    v_exp_f32 v24, v24
    v_exp_f32 v25, v25
    v_exp_f32 v26, v26
    v_exp_f32 v27, v27
    v_cvt_pk_bf16_f32 v52, v24, v25
    v_cvt_pk_bf16_f32 v53, v26, v27
    v_mfma_f32_32x32x16_bf16 v[160:175], a[44:47], v[60:63], v[160:175]
    s_waitcnt vmcnt(11)
    v_exp_f32 v28, v28
    v_exp_f32_e64 v29, v29
    v_exp_f32 v30, v30
    v_exp_f32 v31, v31
    v_cvt_pk_bf16_f32 v54, v28, v29
    v_cvt_pk_bf16_f32 v55, v30, v31
    v_mfma_f32_32x32x16_bf16 v[16:31], a[48:51], v[64:67], 0
    v_exp_f32 v32, v32
    v_exp_f32 v33, v33
    v_exp_f32 v34, v34
    v_exp_f32 v35, v35
    v_cvt_pk_bf16_f32 v56, v32, v33
    v_cvt_pk_bf16_f32 v57, v34, v35
    v_mfma_f32_32x32x16_bf16 v[16:31], a[52:55], v[68:71], v[16:31]
    v_exp_f32 v36, v36
    v_exp_f32 v37, v37
    v_exp_f32 v38, v38
    v_exp_f32 v39, v39
    v_cvt_pk_bf16_f32 v58, v36, v37
    v_cvt_pk_bf16_f32 v59, v38, v39
    v_mfma_f32_32x32x16_bf16 v[176:191], a[40:43], v[48:51], v[176:191]
    v_exp_f32 v40, v40
    v_exp_f32 v41, v41
    v_exp_f32 v42, v42
    v_exp_f32 v43, v43
    v_cvt_pk_bf16_f32 v60, v40, v41
    v_cvt_pk_bf16_f32 v61, v42, v43
    v_mfma_f32_32x32x16_bf16 v[176:191], a[44:47], v[52:55], v[176:191]
    buffer_load_dwordx4 a[80:83], v13, s[32:35], s7 offen offset:0 sc1
    v_exp_f32 v44, v44
    v_exp_f32 v45, v45
    v_exp_f32 v46, v46
    v_exp_f32 v47, v47
    v_cvt_pk_bf16_f32 v62, v44, v45
    v_cvt_pk_bf16_f32 v63, v46, v47
    v_mfma_f32_32x32x16_bf16 v[32:47], a[48:51], v[72:75], 0
    buffer_load_dwordx4 a[84:87], v13, s[32:35], s7 offen offset:1024 sc1
    v_exp_f32 v16, v16
    v_exp_f32 v17, v17
    v_exp_f32 v18, v18
    v_exp_f32 v19, v19
    v_cvt_pk_bf16_f32 v48, v16, v17
    v_cvt_pk_bf16_f32 v49, v18, v19
    v_mfma_f32_32x32x16_bf16 v[32:47], a[52:55], v[76:79], v[32:47]
    buffer_load_dwordx4 a[88:91], v13, s[32:35], s7 offen offset:2048 sc1
    v_exp_f32 v20, v20
    v_exp_f32 v21, v21
    v_exp_f32 v22, v22
    v_exp_f32 v23, v23
    v_cvt_pk_bf16_f32 v50, v20, v21
    v_cvt_pk_bf16_f32 v51, v22, v23
    v_mfma_f32_32x32x16_bf16 v[192:207], a[40:43], v[56:59], v[192:207]
    v_exp_f32 v24, v24
    v_exp_f32 v25, v25
    v_exp_f32 v26, v26
    v_exp_f32 v27, v27
    v_cvt_pk_bf16_f32 v52, v24, v25
    v_cvt_pk_bf16_f32 v53, v26, v27
    v_mfma_f32_32x32x16_bf16 v[192:207], a[44:47], v[60:63], v[192:207]
    buffer_load_dwordx4 a[92:95], v13, s[32:35], s7 offen offset:3072 sc1
    v_exp_f32 v28, v28
    v_exp_f32 v29, v29
    v_exp_f32 v30, v30
    v_exp_f32 v31, v31
    v_cvt_pk_bf16_f32 v54, v28, v29
    v_cvt_pk_bf16_f32 v55, v30, v31
    v_mfma_f32_32x32x16_bf16 v[16:31], a[48:51], v[80:83], 0
    v_readlane_b32 s6, v15, 4
    v_exp_f32 v32, v32
    v_exp_f32 v33, v33
    v_exp_f32 v34, v34
    v_exp_f32 v35, v35
    v_cvt_pk_bf16_f32 v56, v32, v33
    v_cvt_pk_bf16_f32 v57, v34, v35
    v_mfma_f32_32x32x16_bf16 v[16:31], a[52:55], v[84:87], v[16:31]
    s_waitcnt vmcnt(13)
    v_exp_f32 v36, v36
    v_exp_f32_e64 v37, v37
    v_exp_f32 v38, v38
    v_exp_f32 v39, v39
    v_cvt_pk_bf16_f32 v58, v36, v37
    v_cvt_pk_bf16_f32 v59, v38, v39
    v_mfma_f32_32x32x16_bf16 v[144:159], a[56:59], v[48:51], v[144:159]
    buffer_load_dwordx4 a[96:99], v13, s[32:35], s6 offen offset:0 sc1
    v_exp_f32 v40, v40
    v_exp_f32 v41, v41
    v_exp_f32 v42, v42
    v_exp_f32 v43, v43
    v_cvt_pk_bf16_f32 v60, v40, v41
    v_cvt_pk_bf16_f32 v61, v42, v43
    v_mfma_f32_32x32x16_bf16 v[144:159], a[60:63], v[52:55], v[144:159]
    buffer_load_dwordx4 a[100:103], v13, s[32:35], s6 offen offset:1024 sc1
    v_exp_f32 v44, v44
    v_exp_f32 v45, v45
    v_exp_f32 v46, v46
    v_exp_f32 v47, v47
    v_cvt_pk_bf16_f32 v62, v44, v45
    v_cvt_pk_bf16_f32 v63, v46, v47
    v_mfma_f32_32x32x16_bf16 v[32:47], a[48:51], v[88:91], 0
    buffer_load_dword v232, v231, s[32:35], 0 offen sc1
    v_exp_f32 v16, v16
    v_exp_f32 v17, v17
    v_exp_f32 v18, v18
    v_exp_f32 v19, v19
    v_cvt_pk_bf16_f32 v48, v16, v17
    v_cvt_pk_bf16_f32 v49, v18, v19
    v_mfma_f32_32x32x16_bf16 v[32:47], a[52:55], v[92:95], v[32:47]
    v_exp_f32 v20, v20
    v_exp_f32 v21, v21
    v_exp_f32 v22, v22
    v_exp_f32 v23, v23
    v_cvt_pk_bf16_f32 v50, v20, v21
    v_cvt_pk_bf16_f32 v51, v22, v23
    v_mfma_f32_32x32x16_bf16 v[160:175], a[56:59], v[56:59], v[160:175]
    v_exp_f32 v24, v24
    v_exp_f32 v25, v25
    v_exp_f32 v26, v26
    v_exp_f32 v27, v27
    v_cvt_pk_bf16_f32 v52, v24, v25
    v_cvt_pk_bf16_f32 v53, v26, v27
    v_mfma_f32_32x32x16_bf16 v[160:175], a[60:63], v[60:63], v[160:175]
    s_waitcnt vmcnt(10)
    v_exp_f32 v28, v28
    v_exp_f32_e64 v29, v29
    v_exp_f32 v30, v30
    v_exp_f32 v31, v31
    v_cvt_pk_bf16_f32 v54, v28, v29
    v_cvt_pk_bf16_f32 v55, v30, v31
    v_mfma_f32_32x32x16_bf16 v[16:31], a[64:67], v[64:67], 0
    buffer_load_dwordx4 v3, s[40:43], s66 offen offset:0 lds
    v_exp_f32 v32, v32
    v_exp_f32 v33, v33
    v_exp_f32 v34, v34
    v_exp_f32 v35, v35
    v_cvt_pk_bf16_f32 v56, v32, v33
    v_cvt_pk_bf16_f32 v57, v34, v35
    v_mfma_f32_32x32x16_bf16 v[16:31], a[68:71], v[68:71], v[16:31]
    buffer_load_dwordx4 v4, s[40:43], s66 offen offset:1024 lds
    v_exp_f32 v36, v36
    v_exp_f32 v37, v37
    v_exp_f32 v38, v38
    v_exp_f32 v39, v39
    v_cvt_pk_bf16_f32 v58, v36, v37
    v_cvt_pk_bf16_f32 v59, v38, v39
    v_mfma_f32_32x32x16_bf16 v[176:191], a[56:59], v[48:51], v[176:191]
    buffer_load_dwordx4 a[104:107], v13, s[32:35], s6 offen offset:2048 sc1
    v_exp_f32 v40, v40
    v_exp_f32 v41, v41
    v_exp_f32 v42, v42
    v_exp_f32 v43, v43
    v_cvt_pk_bf16_f32 v60, v40, v41
    v_cvt_pk_bf16_f32 v61, v42, v43
    v_mfma_f32_32x32x16_bf16 v[176:191], a[60:63], v[52:55], v[176:191]
    buffer_load_dwordx4 a[108:111], v13, s[32:35], s6 offen offset:3072 sc1
    v_exp_f32 v44, v44
    v_exp_f32 v45, v45
    v_exp_f32 v46, v46
    v_exp_f32 v47, v47
    v_cvt_pk_bf16_f32 v62, v44, v45
    v_cvt_pk_bf16_f32 v63, v46, v47
    v_mfma_f32_32x32x16_bf16 v[32:47], a[64:67], v[72:75], 0
    s_waitcnt vmcnt(12)
    ds_read_b64_tr_b16 v[216:217], v214 offset:0
    v_exp_f32 v16, v16
    v_exp_f32_e64 v17, v17
    v_exp_f32 v18, v18
    v_exp_f32 v19, v19
    v_cvt_pk_bf16_f32 v48, v16, v17
    v_cvt_pk_bf16_f32 v49, v18, v19
    v_mfma_f32_32x32x16_bf16 v[32:47], a[68:71], v[76:79], v[32:47]
    buffer_load_dword v10, v233, s[32:35], 0 offen sc1
    v_exp_f32 v20, v20
    v_exp_f32 v21, v21
    v_exp_f32 v22, v22
    v_exp_f32 v23, v23
    v_cvt_pk_bf16_f32 v50, v20, v21
    v_cvt_pk_bf16_f32 v51, v22, v23
    v_mfma_f32_32x32x16_bf16 v[192:207], a[56:59], v[56:59], v[192:207]
    ds_read_b64_tr_b16 v[218:219], v214 offset:512
    v_exp_f32 v24, v24
    v_exp_f32 v25, v25
    v_exp_f32 v26, v26
    v_exp_f32 v27, v27
    v_cvt_pk_bf16_f32 v52, v24, v25
    v_cvt_pk_bf16_f32 v53, v26, v27
    v_mfma_f32_32x32x16_bf16 v[192:207], a[60:63], v[60:63], v[192:207]
    buffer_load_dwordx4 v5, s[40:43], s66 offen offset:2048 lds
    v_exp_f32 v28, v28
    v_exp_f32 v29, v29
    v_exp_f32 v30, v30
    v_exp_f32 v31, v31
    v_cvt_pk_bf16_f32 v54, v28, v29
    v_cvt_pk_bf16_f32 v55, v30, v31
    v_mfma_f32_32x32x16_bf16 v[16:31], a[64:67], v[80:83], 0
    ds_read_b64_tr_b16 v[220:221], v215 offset:0
    v_exp_f32 v32, v32
    v_exp_f32 v33, v33
    v_exp_f32 v34, v34
    v_exp_f32 v35, v35
    v_cvt_pk_bf16_f32 v56, v32, v33
    v_cvt_pk_bf16_f32 v57, v34, v35
    v_mfma_f32_32x32x16_bf16 v[16:31], a[68:71], v[84:87], v[16:31]
    ds_read_b64_tr_b16 v[222:223], v215 offset:512
    v_exp_f32 v36, v36
    v_exp_f32 v37, v37
    v_exp_f32 v38, v38
    v_exp_f32 v39, v39
    v_cvt_pk_bf16_f32 v58, v36, v37
    v_cvt_pk_bf16_f32 v59, v38, v39
    v_mfma_f32_32x32x16_bf16 v[144:159], a[72:75], v[48:51], v[144:159]
    s_waitcnt lgkmcnt(2)
    buffer_store_dwordx4 v[216:219], v13, s[32:35], s24 offen offset:0 sc1
    v_exp_f32 v40, v40
    v_exp_f32_e64 v41, v41
    v_exp_f32 v42, v42
    v_exp_f32 v43, v43
    v_cvt_pk_bf16_f32 v60, v40, v41
    v_cvt_pk_bf16_f32 v61, v42, v43
    v_mfma_f32_32x32x16_bf16 v[144:159], a[76:79], v[52:55], v[144:159]
    buffer_load_dwordx4 v6, s[40:43], s66 offen offset:3072 lds
    v_exp_f32 v44, v44
    v_exp_f32 v45, v45
    v_exp_f32 v46, v46
    v_exp_f32 v47, v47
    v_cvt_pk_bf16_f32 v62, v44, v45
    v_cvt_pk_bf16_f32 v63, v46, v47
    v_mfma_f32_32x32x16_bf16 v[32:47], a[64:67], v[88:91], 0
    s_waitcnt lgkmcnt(0)
    buffer_store_dwordx4 v[220:223], v13, s[32:35], s24 offen offset:1024 sc1
    v_exp_f32 v16, v16
    v_exp_f32_e64 v17, v17
    v_exp_f32 v18, v18
    v_exp_f32 v19, v19
    v_cvt_pk_bf16_f32 v48, v16, v17
    v_cvt_pk_bf16_f32 v49, v18, v19
    v_mfma_f32_32x32x16_bf16 v[32:47], a[68:71], v[92:95], v[32:47]
    v_readlane_b32 s7, v15, 5
    v_exp_f32 v20, v20
    v_exp_f32 v21, v21
    v_exp_f32 v22, v22
    v_exp_f32 v23, v23
    v_cvt_pk_bf16_f32 v50, v20, v21
    v_cvt_pk_bf16_f32 v51, v22, v23
    v_mfma_f32_32x32x16_bf16 v[160:175], a[72:75], v[56:59], v[160:175]
    s_add_u32 m0, m0, 16384
    s_add_u32 s66, s66, 229376
    v_exp_f32 v24, v24
    v_exp_f32 v25, v25
    v_exp_f32 v26, v26
    v_exp_f32 v27, v27
    v_cvt_pk_bf16_f32 v52, v24, v25
    v_cvt_pk_bf16_f32 v53, v26, v27
    v_mfma_f32_32x32x16_bf16 v[160:175], a[76:79], v[60:63], v[160:175]
    s_waitcnt vmcnt(12)
    v_exp_f32 v28, v28
    v_exp_f32_e64 v29, v29
    v_exp_f32 v30, v30
    v_exp_f32 v31, v31
    v_cvt_pk_bf16_f32 v54, v28, v29
    v_cvt_pk_bf16_f32 v55, v30, v31
    v_mfma_f32_32x32x16_bf16 v[16:31], a[80:83], v[64:67], 0
    v_cmp_ne_u32 vcc, s54, v9
    v_exp_f32 v32, v32
    v_exp_f32_e64 v33, v33
    v_exp_f32 v34, v34
    v_exp_f32 v35, v35
    v_cvt_pk_bf16_f32 v56, v32, v33
    v_cvt_pk_bf16_f32 v57, v34, v35
    s_or_b32 vcc_lo, vcc_lo, vcc_hi
    s_and_b64 vcc, vcc, 16352
    s_cbranch_vccnz L_fk7_w
L_fk7_ok:
    v_mfma_f32_32x32x16_bf16 v[16:31], a[84:87], v[68:71], v[16:31]
    s_waitcnt vmcnt(9)
    v_cmp_ne_u32 vcc, s54, v232
    v_exp_f32 v36, v36
    v_exp_f32 v37, v37
    v_exp_f32 v38, v38
    v_exp_f32 v39, v39
    v_cvt_pk_bf16_f32 v58, v36, v37
    v_cvt_pk_bf16_f32 v59, v38, v39
    s_cbranch_vccnz L_wofl_w
L_wofl_ok:
    v_mfma_f32_32x32x16_bf16 v[176:191], a[72:75], v[48:51], v[176:191]
    buffer_load_dwordx4 a[112:115], v13, s[32:35], s7 offen offset:0 sc1
    v_exp_f32 v40, v40
    v_exp_f32_e64 v41, v41
    v_exp_f32 v42, v42
    v_exp_f32 v43, v43
    v_cvt_pk_bf16_f32 v60, v40, v41
    v_cvt_pk_bf16_f32 v61, v42, v43
    v_mfma_f32_32x32x16_bf16 v[176:191], a[76:79], v[52:55], v[176:191]
    buffer_load_dwordx4 a[116:119], v13, s[32:35], s7 offen offset:1024 sc1
    v_exp_f32 v44, v44
    v_exp_f32 v45, v45
    v_exp_f32 v46, v46
    v_exp_f32 v47, v47
    v_cvt_pk_bf16_f32 v62, v44, v45
    v_cvt_pk_bf16_f32 v63, v46, v47
    v_mfma_f32_32x32x16_bf16 v[32:47], a[80:83], v[72:75], 0
    buffer_load_dwordx4 v3, s[40:43], s66 offen offset:0 lds
    v_exp_f32 v16, v16
    v_exp_f32 v17, v17
    v_exp_f32 v18, v18
    v_exp_f32 v19, v19
    v_cvt_pk_bf16_f32 v48, v16, v17
    v_cvt_pk_bf16_f32 v49, v18, v19
    v_mfma_f32_32x32x16_bf16 v[32:47], a[84:87], v[76:79], v[32:47]
    buffer_load_dwordx4 a[120:123], v13, s[32:35], s7 offen offset:2048 sc1
    v_exp_f32 v20, v20
    v_exp_f32 v21, v21
    v_exp_f32 v22, v22
    v_exp_f32 v23, v23
    v_cvt_pk_bf16_f32 v50, v20, v21
    v_cvt_pk_bf16_f32 v51, v22, v23
    v_mfma_f32_32x32x16_bf16 v[192:207], a[72:75], v[56:59], v[192:207]
    v_exp_f32 v24, v24
    v_exp_f32 v25, v25
    v_exp_f32 v26, v26
    v_exp_f32 v27, v27
    v_cvt_pk_bf16_f32 v52, v24, v25
    v_cvt_pk_bf16_f32 v53, v26, v27
    v_mfma_f32_32x32x16_bf16 v[192:207], a[76:79], v[60:63], v[192:207]
    buffer_load_dwordx4 a[124:127], v13, s[32:35], s7 offen offset:3072 sc1
    v_exp_f32 v28, v28
    v_exp_f32 v29, v29
    v_exp_f32 v30, v30
    v_exp_f32 v31, v31
    v_cvt_pk_bf16_f32 v54, v28, v29
    v_cvt_pk_bf16_f32 v55, v30, v31
    v_mfma_f32_32x32x16_bf16 v[16:31], a[80:83], v[80:83], 0
    s_cmp_eq_u32 s2, 0
    s_cbranch_scc1 L_st_11_g
    buffer_store_dwordx4 v[252:255], v245, s[32:35], s78 offen offset:0
    buffer_store_dwordx4 v[252:255], v245, s[32:35], s78 offen offset:128
L_st_11_j:
    v_exp_f32 v32, v32
    v_exp_f32 v33, v33
    v_exp_f32 v34, v34
    v_exp_f32 v35, v35
    v_cvt_pk_bf16_f32 v56, v32, v33
    v_cvt_pk_bf16_f32 v57, v34, v35
    v_mfma_f32_32x32x16_bf16 v[16:31], a[84:87], v[84:87], v[16:31]
    buffer_load_dwordx4 v4, s[40:43], s66 offen offset:1024 lds
    v_exp_f32 v36, v36
    v_exp_f32 v37, v37
    v_exp_f32 v38, v38
    v_exp_f32 v39, v39
    v_cvt_pk_bf16_f32 v58, v36, v37
    v_cvt_pk_bf16_f32 v59, v38, v39
    v_mfma_f32_32x32x16_bf16 v[144:159], a[88:91], v[48:51], v[144:159]
    s_cmp_eq_u32 s2, 0
    s_cbranch_scc1 L_st_12_g
    buffer_store_dwordx4 v[252:255], v245, s[32:35], s78 offen offset:256
    buffer_store_dwordx4 v[252:255], v245, s[32:35], s78 offen offset:384
L_st_12_j:
    v_exp_f32 v40, v40
    v_exp_f32 v41, v41
    v_exp_f32 v42, v42
    v_exp_f32 v43, v43
    v_cvt_pk_bf16_f32 v60, v40, v41
    v_cvt_pk_bf16_f32 v61, v42, v43
    v_mfma_f32_32x32x16_bf16 v[144:159], a[92:95], v[52:55], v[144:159]
    v_readlane_b32 s6, v15, 6
    v_exp_f32 v44, v44
    v_exp_f32 v45, v45
    v_exp_f32 v46, v46
    v_exp_f32 v47, v47
    v_cvt_pk_bf16_f32 v62, v44, v45
    v_cvt_pk_bf16_f32 v63, v46, v47
    v_mfma_f32_32x32x16_bf16 v[32:47], a[80:83], v[88:91], 0
    v_exp_f32 v16, v16
    v_exp_f32 v17, v17
    v_exp_f32 v18, v18
    v_exp_f32 v19, v19
    v_cvt_pk_bf16_f32 v48, v16, v17
    v_cvt_pk_bf16_f32 v49, v18, v19
    v_mfma_f32_32x32x16_bf16 v[32:47], a[84:87], v[92:95], v[32:47]
    v_exp_f32 v20, v20
    v_exp_f32 v21, v21
    v_exp_f32 v22, v22
    v_exp_f32 v23, v23
    v_cvt_pk_bf16_f32 v50, v20, v21
    v_cvt_pk_bf16_f32 v51, v22, v23
    v_mfma_f32_32x32x16_bf16 v[160:175], a[88:91], v[56:59], v[160:175]
    s_waitcnt vmcnt(14)
    s_cmp_eq_u32 s67, 3
    s_cbranch_scc0 L_skip_nc2_13
    v_xor_b32 v10, v10, v234
    v_and_b32 v11, 0xff, v10
    v_cmp_ne_u32 vcc, 0, v11
    s_cbranch_vccnz L_nc2_w
L_nc2_ok:
    v_add_f32_dpp v10, v10, v10 row_ror:8 row_mask:0xf bank_mask:0xf
    v_mov_b32 v11, v10
    s_nop 1
    v_permlane16_swap_b32 v10, v11
    v_add_f32 v10, v10, v11
    v_mov_b32 v11, v10
    s_nop 1
    v_permlane32_swap_b32 v10, v11
    v_add_f32 v10, v10, v11
    v_cvt_pk_bf16_f32 v10, 0, v10
    v_add_f32 v10, s80, v10
    v_cvt_pk_bf16_f32 v10, 0, v10
L_skip_nc2_13:
    buffer_store_dword v10, v12, s[32:35], 0 offen sc1
    v_exp_f32 v24, v24
    v_exp_f32_e64 v25, v25
    v_exp_f32 v26, v26
    v_exp_f32 v27, v27
    v_cvt_pk_bf16_f32 v52, v24, v25
    v_cvt_pk_bf16_f32 v53, v26, v27
    v_mfma_f32_32x32x16_bf16 v[160:175], a[92:95], v[60:63], v[160:175]
    buffer_load_dwordx4 v5, s[40:43], s66 offen offset:2048 lds
    v_exp_f32 v28, v28
    v_exp_f32 v29, v29
    v_exp_f32 v30, v30
    v_exp_f32 v31, v31
    v_cvt_pk_bf16_f32 v54, v28, v29
    v_cvt_pk_bf16_f32 v55, v30, v31
    v_mfma_f32_32x32x16_bf16 v[16:31], a[96:99], v[64:67], 0
    s_getpc_b64 s[10:11]
L_pc2:
    s_lshl_b32 s81, s56, 10
    v_lshl_add_u32 v229, v0, 2, s81
    v_min_u32 v229, L_code_end-L_pc2-4, v229
    v_exp_f32 v32, v32
    v_exp_f32 v33, v33
    v_exp_f32 v34, v34
    v_exp_f32 v35, v35
    v_cvt_pk_bf16_f32 v56, v32, v33
    v_cvt_pk_bf16_f32 v57, v34, v35
    v_mfma_f32_32x32x16_bf16 v[16:31], a[100:103], v[68:71], v[16:31]
    buffer_load_dwordx4 v6, s[40:43], s66 offen offset:3072 lds
    v_exp_f32 v36, v36
    v_exp_f32 v37, v37
    v_exp_f32 v38, v38
    v_exp_f32 v39, v39
    v_cvt_pk_bf16_f32 v58, v36, v37
    v_cvt_pk_bf16_f32 v59, v38, v39
    v_mfma_f32_32x32x16_bf16 v[176:191], a[88:91], v[48:51], v[176:191]
    buffer_load_dwordx4 a[0:3], v13, s[32:35], s6 offen offset:0 sc1
    v_exp_f32 v40, v40
    v_exp_f32 v41, v41
    v_exp_f32 v42, v42
    v_exp_f32 v43, v43
    v_cvt_pk_bf16_f32 v60, v40, v41
    v_cvt_pk_bf16_f32 v61, v42, v43
    v_mfma_f32_32x32x16_bf16 v[176:191], a[92:95], v[52:55], v[176:191]
    buffer_load_dwordx4 a[4:7], v13, s[32:35], s6 offen offset:1024 sc1
    v_exp_f32 v44, v44
    v_exp_f32 v45, v45
    v_exp_f32 v46, v46
    v_exp_f32 v47, v47
    v_cvt_pk_bf16_f32 v62, v44, v45
    v_cvt_pk_bf16_f32 v63, v46, v47
    v_mfma_f32_32x32x16_bf16 v[32:47], a[96:99], v[72:75], 0
    s_add_u32 m0, m0, 16384
    s_add_u32 s66, s66, 229376
    v_exp_f32 v16, v16
    v_exp_f32 v17, v17
    v_exp_f32 v18, v18
    v_exp_f32 v19, v19
    v_cvt_pk_bf16_f32 v48, v16, v17
    v_cvt_pk_bf16_f32 v49, v18, v19
    v_mfma_f32_32x32x16_bf16 v[32:47], a[100:103], v[76:79], v[32:47]
    buffer_load_dwordx4 a[8:11], v13, s[32:35], s6 offen offset:2048 sc1
    v_exp_f32 v20, v20
    v_exp_f32 v21, v21
    v_exp_f32 v22, v22
    v_exp_f32 v23, v23
    v_cvt_pk_bf16_f32 v50, v20, v21
    v_cvt_pk_bf16_f32 v51, v22, v23
    v_mfma_f32_32x32x16_bf16 v[192:207], a[88:91], v[56:59], v[192:207]
    global_load_dword v14, v229, s[10:11]
    v_exp_f32 v24, v24
    v_exp_f32 v25, v25
    v_exp_f32 v26, v26
    v_exp_f32 v27, v27
    v_cvt_pk_bf16_f32 v52, v24, v25
    v_cvt_pk_bf16_f32 v53, v26, v27
    v_mfma_f32_32x32x16_bf16 v[192:207], a[92:95], v[60:63], v[192:207]
    buffer_load_dwordx4 a[12:15], v13, s[32:35], s6 offen offset:3072 sc1
    v_exp_f32 v28, v28
    v_exp_f32 v29, v29
    v_exp_f32 v30, v30
    v_exp_f32 v31, v31
    v_cvt_pk_bf16_f32 v54, v28, v29
    v_cvt_pk_bf16_f32 v55, v30, v31
    v_mfma_f32_32x32x16_bf16 v[16:31], a[96:99], v[80:83], 0
    buffer_load_dwordx4 v3, s[40:43], s66 offen offset:0 lds
    v_exp_f32 v32, v32
    v_exp_f32 v33, v33
    v_exp_f32 v34, v34
    v_exp_f32 v35, v35
    v_cvt_pk_bf16_f32 v56, v32, v33
    v_cvt_pk_bf16_f32 v57, v34, v35
    v_mfma_f32_32x32x16_bf16 v[16:31], a[100:103], v[84:87], v[16:31]
    buffer_load_dwordx4 v4, s[40:43], s66 offen offset:1024 lds
    v_exp_f32 v36, v36
    v_exp_f32 v37, v37
    v_exp_f32 v38, v38
    v_exp_f32 v39, v39
    v_cvt_pk_bf16_f32 v58, v36, v37
    v_cvt_pk_bf16_f32 v59, v38, v39
    v_mfma_f32_32x32x16_bf16 v[144:159], a[104:107], v[48:51], v[144:159]
    v_readlane_b32 s7, v15, 7
    v_exp_f32 v40, v40
    v_exp_f32 v41, v41
    v_exp_f32 v42, v42
    v_exp_f32 v43, v43
    v_cvt_pk_bf16_f32 v60, v40, v41
    v_cvt_pk_bf16_f32 v61, v42, v43
    v_mfma_f32_32x32x16_bf16 v[144:159], a[108:111], v[52:55], v[144:159]
    buffer_load_dwordx4 v5, s[40:43], s66 offen offset:2048 lds
    v_exp_f32 v44, v44
    v_exp_f32 v45, v45
    v_exp_f32 v46, v46
    v_exp_f32 v47, v47
    v_cvt_pk_bf16_f32 v62, v44, v45
    v_cvt_pk_bf16_f32 v63, v46, v47
    v_mfma_f32_32x32x16_bf16 v[32:47], a[96:99], v[88:91], 0
    buffer_load_dwordx4 a[16:19], v13, s[32:35], s7 offen offset:0 sc1
    v_exp_f32 v16, v16
    v_exp_f32 v17, v17
    v_exp_f32 v18, v18
    v_exp_f32 v19, v19
    v_cvt_pk_bf16_f32 v48, v16, v17
    v_cvt_pk_bf16_f32 v49, v18, v19
    v_mfma_f32_32x32x16_bf16 v[32:47], a[100:103], v[92:95], v[32:47]
    v_exp_f32 v20, v20
    v_exp_f32 v21, v21
    v_exp_f32 v22, v22
    v_exp_f32 v23, v23
    v_cvt_pk_bf16_f32 v50, v20, v21
    v_cvt_pk_bf16_f32 v51, v22, v23
    v_mfma_f32_32x32x16_bf16 v[160:175], a[104:107], v[56:59], v[160:175]
    buffer_load_dwordx4 a[20:23], v13, s[32:35], s7 offen offset:1024 sc1
    v_exp_f32 v24, v24
    v_exp_f32 v25, v25
    v_exp_f32 v26, v26
    v_exp_f32 v27, v27
    v_cvt_pk_bf16_f32 v52, v24, v25
    v_cvt_pk_bf16_f32 v53, v26, v27
    v_mfma_f32_32x32x16_bf16 v[160:175], a[108:111], v[60:63], v[160:175]
    s_waitcnt vmcnt(18)
    v_exp_f32 v28, v28
    v_exp_f32_e64 v29, v29
    v_exp_f32 v30, v30
    v_exp_f32 v31, v31
    v_cvt_pk_bf16_f32 v54, v28, v29
    v_cvt_pk_bf16_f32 v55, v30, v31
    v_mfma_f32_32x32x16_bf16 v[16:31], a[112:115], v[64:67], 0
    buffer_load_dwordx4 a[24:27], v13, s[32:35], s7 offen offset:2048 sc1
    v_exp_f32 v32, v32
    v_exp_f32 v33, v33
    v_exp_f32 v34, v34
    v_exp_f32 v35, v35
    v_cvt_pk_bf16_f32 v56, v32, v33
    v_cvt_pk_bf16_f32 v57, v34, v35
    v_mfma_f32_32x32x16_bf16 v[16:31], a[116:119], v[68:71], v[16:31]
    buffer_load_dwordx4 a[28:31], v13, s[32:35], s7 offen offset:3072 sc1
    v_exp_f32 v36, v36
    v_exp_f32 v37, v37
    v_exp_f32 v38, v38
    v_exp_f32 v39, v39
    v_cvt_pk_bf16_f32 v58, v36, v37
    v_cvt_pk_bf16_f32 v59, v38, v39
    v_mfma_f32_32x32x16_bf16 v[176:191], a[104:107], v[48:51], v[176:191]
    buffer_load_dwordx4 v6, s[40:43], s66 offen offset:3072 lds
    v_exp_f32 v40, v40
    v_exp_f32 v41, v41
    v_exp_f32 v42, v42
    v_exp_f32 v43, v43
    v_cvt_pk_bf16_f32 v60, v40, v41
    v_cvt_pk_bf16_f32 v61, v42, v43
    v_mfma_f32_32x32x16_bf16 v[176:191], a[108:111], v[52:55], v[176:191]
    v_readlane_b32 s6, v15, 8
    v_exp_f32 v44, v44
    v_exp_f32 v45, v45
    v_exp_f32 v46, v46
    v_exp_f32 v47, v47
    v_cvt_pk_bf16_f32 v62, v44, v45
    v_cvt_pk_bf16_f32 v63, v46, v47
    v_mfma_f32_32x32x16_bf16 v[32:47], a[112:115], v[72:75], 0
    buffer_load_dwordx4 a[32:35], v13, s[32:35], s6 offen offset:0 sc1
    v_exp_f32 v16, v16
    v_exp_f32 v17, v17
    v_exp_f32 v18, v18
    v_exp_f32 v19, v19
    v_cvt_pk_bf16_f32 v48, v16, v17
    v_cvt_pk_bf16_f32 v49, v18, v19
    v_mfma_f32_32x32x16_bf16 v[32:47], a[116:119], v[76:79], v[32:47]
    buffer_load_dwordx4 a[36:39], v13, s[32:35], s6 offen offset:1024 sc1
    v_exp_f32 v20, v20
    v_exp_f32 v21, v21
    v_exp_f32 v22, v22
    v_exp_f32 v23, v23
    v_cvt_pk_bf16_f32 v50, v20, v21
    v_cvt_pk_bf16_f32 v51, v22, v23
    v_mfma_f32_32x32x16_bf16 v[192:207], a[104:107], v[56:59], v[192:207]
    buffer_load_dwordx4 a[40:43], v13, s[32:35], s6 offen offset:2048 sc1
    v_exp_f32 v24, v24
    v_exp_f32 v25, v25
    v_exp_f32 v26, v26
    v_exp_f32 v27, v27
    v_cvt_pk_bf16_f32 v52, v24, v25
    v_cvt_pk_bf16_f32 v53, v26, v27
    v_mfma_f32_32x32x16_bf16 v[192:207], a[108:111], v[60:63], v[192:207]
    s_add_u32 m0, m0, 16384
    s_add_u32 s66, s66, 229376
    v_exp_f32 v28, v28
    v_exp_f32 v29, v29
    v_exp_f32 v30, v30
    v_exp_f32 v31, v31
    v_cvt_pk_bf16_f32 v54, v28, v29
    v_cvt_pk_bf16_f32 v55, v30, v31
    v_mfma_f32_32x32x16_bf16 v[16:31], a[112:115], v[80:83], 0
    s_waitcnt vmcnt(19)
    s_barrier
    v_exp_f32 v32, v32
    v_exp_f32 v33, v33
    v_exp_f32 v34, v34
    v_exp_f32 v35, v35
    v_cvt_pk_bf16_f32 v56, v32, v33
    v_cvt_pk_bf16_f32 v57, v34, v35
    v_mfma_f32_32x32x16_bf16 v[16:31], a[116:119], v[84:87], v[16:31]
    buffer_load_dwordx4 a[44:47], v13, s[32:35], s6 offen offset:3072 sc1
    v_exp_f32 v36, v36
    v_exp_f32 v37, v37
    v_exp_f32 v38, v38
    v_exp_f32 v39, v39
    v_cvt_pk_bf16_f32 v58, v36, v37
    v_cvt_pk_bf16_f32 v59, v38, v39
    v_mfma_f32_32x32x16_bf16 v[144:159], a[120:123], v[48:51], v[144:159]
    v_readlane_b32 s7, v15, 9
    v_exp_f32 v40, v40
    v_exp_f32 v41, v41
    v_exp_f32 v42, v42
    v_exp_f32 v43, v43
    v_cvt_pk_bf16_f32 v60, v40, v41
    v_cvt_pk_bf16_f32 v61, v42, v43
    v_mfma_f32_32x32x16_bf16 v[144:159], a[124:127], v[52:55], v[144:159]
    buffer_load_dwordx4 a[48:51], v13, s[32:35], s7 offen offset:0 sc1
    v_exp_f32 v44, v44
    v_exp_f32 v45, v45
    v_exp_f32 v46, v46
    v_exp_f32 v47, v47
    v_cvt_pk_bf16_f32 v62, v44, v45
    v_cvt_pk_bf16_f32 v63, v46, v47
    v_mfma_f32_32x32x16_bf16 v[32:47], a[112:115], v[88:91], 0
    s_waitcnt vmcnt(20)
    buffer_store_dword v241, v8, s[32:35], s30 offen sc1
    v_exp_f32 v16, v16
    v_exp_f32_e64 v17, v17
    v_exp_f32 v18, v18
    v_exp_f32 v19, v19
    v_cvt_pk_bf16_f32 v48, v16, v17
    v_cvt_pk_bf16_f32 v49, v18, v19
    v_mfma_f32_32x32x16_bf16 v[32:47], a[116:119], v[92:95], v[32:47]
    buffer_load_dwordx4 v3, s[40:43], s66 offen offset:0 lds
    v_exp_f32 v20, v20
    v_exp_f32 v21, v21
    v_exp_f32 v22, v22
    v_exp_f32 v23, v23
    v_cvt_pk_bf16_f32 v50, v20, v21
    v_cvt_pk_bf16_f32 v51, v22, v23
    v_mfma_f32_32x32x16_bf16 v[160:175], a[120:123], v[56:59], v[160:175]
    buffer_load_dwordx4 a[52:55], v13, s[32:35], s7 offen offset:1024 sc1
    v_exp_f32 v24, v24
    v_exp_f32 v25, v25
    v_exp_f32 v26, v26
    v_exp_f32 v27, v27
    v_cvt_pk_bf16_f32 v52, v24, v25
    v_cvt_pk_bf16_f32 v53, v26, v27
    v_mfma_f32_32x32x16_bf16 v[160:175], a[124:127], v[60:63], v[160:175]
    s_waitcnt vmcnt(16)
    v_exp_f32 v28, v28
    v_exp_f32_e64 v29, v29
    v_exp_f32 v30, v30
    v_exp_f32 v31, v31
    v_cvt_pk_bf16_f32 v54, v28, v29
    v_cvt_pk_bf16_f32 v55, v30, v31
    v_mfma_f32_32x32x16_bf16 v[16:31], a[0:3], v[64:67], 0
    buffer_load_dwordx4 a[56:59], v13, s[32:35], s7 offen offset:2048 sc1
    v_exp_f32 v32, v32
    v_exp_f32 v33, v33
    v_exp_f32 v34, v34
    v_exp_f32 v35, v35
    v_cvt_pk_bf16_f32 v56, v32, v33
    v_cvt_pk_bf16_f32 v57, v34, v35
    v_mfma_f32_32x32x16_bf16 v[16:31], a[4:7], v[68:71], v[16:31]
    buffer_load_dwordx4 a[60:63], v13, s[32:35], s7 offen offset:3072 sc1
    v_exp_f32 v36, v36
    v_exp_f32 v37, v37
    v_exp_f32 v38, v38
    v_exp_f32 v39, v39
    v_cvt_pk_bf16_f32 v58, v36, v37
    v_cvt_pk_bf16_f32 v59, v38, v39
    v_mfma_f32_32x32x16_bf16 v[176:191], a[120:123], v[48:51], v[176:191]
    v_readlane_b32 s6, v15, 10
    v_exp_f32 v40, v40
    v_exp_f32 v41, v41
    v_exp_f32 v42, v42
    v_exp_f32 v43, v43
    v_cvt_pk_bf16_f32 v60, v40, v41
    v_cvt_pk_bf16_f32 v61, v42, v43
    v_mfma_f32_32x32x16_bf16 v[176:191], a[124:127], v[52:55], v[176:191]
    buffer_load_dwordx4 v4, s[40:43], s66 offen offset:1024 lds
    v_exp_f32 v44, v44
    v_exp_f32 v45, v45
    v_exp_f32 v46, v46
    v_exp_f32 v47, v47
    v_cvt_pk_bf16_f32 v62, v44, v45
    v_cvt_pk_bf16_f32 v63, v46, v47
    v_mfma_f32_32x32x16_bf16 v[32:47], a[0:3], v[72:75], 0
    buffer_load_dwordx4 a[64:67], v13, s[32:35], s6 offen offset:0 sc1
    v_exp_f32 v16, v16
    v_exp_f32 v17, v17
    v_exp_f32 v18, v18
    v_exp_f32 v19, v19
    v_cvt_pk_bf16_f32 v48, v16, v17
    v_cvt_pk_bf16_f32 v49, v18, v19
    v_mfma_f32_32x32x16_bf16 v[32:47], a[4:7], v[76:79], v[32:47]
    buffer_load_dwordx4 a[68:71], v13, s[32:35], s6 offen offset:1024 sc1
    v_exp_f32 v20, v20
    v_exp_f32 v21, v21
    v_exp_f32 v22, v22
    v_exp_f32 v23, v23
    v_cvt_pk_bf16_f32 v50, v20, v21
    v_cvt_pk_bf16_f32 v51, v22, v23
    v_mfma_f32_32x32x16_bf16 v[192:207], a[120:123], v[56:59], v[192:207]
    buffer_load_dwordx4 a[72:75], v13, s[32:35], s6 offen offset:2048 sc1
    v_exp_f32 v24, v24
    v_exp_f32 v25, v25
    v_exp_f32 v26, v26
    v_exp_f32 v27, v27
    v_cvt_pk_bf16_f32 v52, v24, v25
    v_cvt_pk_bf16_f32 v53, v26, v27
    v_mfma_f32_32x32x16_bf16 v[192:207], a[124:127], v[60:63], v[192:207]
    v_exp_f32 v28, v28
    v_exp_f32 v29, v29
    v_exp_f32 v30, v30
    v_exp_f32 v31, v31
    v_cvt_pk_bf16_f32 v54, v28, v29
    v_cvt_pk_bf16_f32 v55, v30, v31
    v_mfma_f32_32x32x16_bf16 v[16:31], a[0:3], v[80:83], 0
    buffer_load_dwordx4 v5, s[40:43], s66 offen offset:2048 lds
    v_exp_f32 v32, v32
    v_exp_f32 v33, v33
    v_exp_f32 v34, v34
    v_exp_f32 v35, v35
    v_cvt_pk_bf16_f32 v56, v32, v33
    v_cvt_pk_bf16_f32 v57, v34, v35
    v_mfma_f32_32x32x16_bf16 v[16:31], a[4:7], v[84:87], v[16:31]
    buffer_load_dwordx4 a[76:79], v13, s[32:35], s6 offen offset:3072 sc1
    v_exp_f32 v36, v36
    v_exp_f32 v37, v37
    v_exp_f32 v38, v38
    v_exp_f32 v39, v39
    v_cvt_pk_bf16_f32 v58, v36, v37
    v_cvt_pk_bf16_f32 v59, v38, v39
    v_mfma_f32_32x32x16_bf16 v[144:159], a[8:11], v[48:51], v[144:159]
    v_readlane_b32 s7, v15, 11
    v_exp_f32 v40, v40
    v_exp_f32 v41, v41
    v_exp_f32 v42, v42
    v_exp_f32 v43, v43
    v_cvt_pk_bf16_f32 v60, v40, v41
    v_cvt_pk_bf16_f32 v61, v42, v43
    v_mfma_f32_32x32x16_bf16 v[144:159], a[12:15], v[52:55], v[144:159]
    buffer_load_dwordx4 a[80:83], v13, s[32:35], s7 offen offset:0 sc1
    v_exp_f32 v44, v44
    v_exp_f32 v45, v45
    v_exp_f32 v46, v46
    v_exp_f32 v47, v47
    v_cvt_pk_bf16_f32 v62, v44, v45
    v_cvt_pk_bf16_f32 v63, v46, v47
    v_mfma_f32_32x32x16_bf16 v[32:47], a[0:3], v[88:91], 0
    buffer_load_dwordx4 a[84:87], v13, s[32:35], s7 offen offset:1024 sc1
    v_exp_f32 v16, v16
    v_exp_f32 v17, v17
    v_exp_f32 v18, v18
    v_exp_f32 v19, v19
    v_cvt_pk_bf16_f32 v48, v16, v17
    v_cvt_pk_bf16_f32 v49, v18, v19
    v_mfma_f32_32x32x16_bf16 v[32:47], a[4:7], v[92:95], v[32:47]
    buffer_load_dwordx4 v6, s[40:43], s66 offen offset:3072 lds
    v_exp_f32 v20, v20
    v_exp_f32 v21, v21
    v_exp_f32 v22, v22
    v_exp_f32 v23, v23
    v_cvt_pk_bf16_f32 v50, v20, v21
    v_cvt_pk_bf16_f32 v51, v22, v23
    v_mfma_f32_32x32x16_bf16 v[160:175], a[8:11], v[56:59], v[160:175]
    buffer_load_dwordx4 a[88:91], v13, s[32:35], s7 offen offset:2048 sc1
    v_exp_f32 v24, v24
    v_exp_f32 v25, v25
    v_exp_f32 v26, v26
    v_exp_f32 v27, v27
    v_cvt_pk_bf16_f32 v52, v24, v25
    v_cvt_pk_bf16_f32 v53, v26, v27
    v_mfma_f32_32x32x16_bf16 v[160:175], a[12:15], v[60:63], v[160:175]
    s_waitcnt vmcnt(21)
    v_exp_f32 v28, v28
    v_exp_f32_e64 v29, v29
    v_exp_f32 v30, v30
    v_exp_f32 v31, v31
    v_cvt_pk_bf16_f32 v54, v28, v29
    v_cvt_pk_bf16_f32 v55, v30, v31
    v_mfma_f32_32x32x16_bf16 v[16:31], a[16:19], v[64:67], 0
    buffer_load_dwordx4 a[92:95], v13, s[32:35], s7 offen offset:3072 sc1
    v_exp_f32 v32, v32
    v_exp_f32 v33, v33
    v_exp_f32 v34, v34
    v_exp_f32 v35, v35
    v_cvt_pk_bf16_f32 v56, v32, v33
    v_cvt_pk_bf16_f32 v57, v34, v35
    v_mfma_f32_32x32x16_bf16 v[16:31], a[20:23], v[68:71], v[16:31]
    v_readlane_b32 s6, v15, 12
    s_add_u32 m0, m0, 16384
    s_add_u32 s66, s66, 229376
    v_exp_f32 v36, v36
    v_exp_f32 v37, v37
    v_exp_f32 v38, v38
    v_exp_f32 v39, v39
    v_cvt_pk_bf16_f32 v58, v36, v37
    v_cvt_pk_bf16_f32 v59, v38, v39
    v_mfma_f32_32x32x16_bf16 v[176:191], a[8:11], v[48:51], v[176:191]
    buffer_load_dwordx4 a[96:99], v13, s[32:35], s6 offen offset:0 sc1
    v_exp_f32 v40, v40
    v_exp_f32 v41, v41
    v_exp_f32 v42, v42
    v_exp_f32 v43, v43
    v_cvt_pk_bf16_f32 v60, v40, v41
    v_cvt_pk_bf16_f32 v61, v42, v43
    v_mfma_f32_32x32x16_bf16 v[176:191], a[12:15], v[52:55], v[176:191]
    buffer_load_dwordx4 a[100:103], v13, s[32:35], s6 offen offset:1024 sc1
    v_exp_f32 v44, v44
    v_exp_f32 v45, v45
    v_exp_f32 v46, v46
    v_exp_f32 v47, v47
    v_cvt_pk_bf16_f32 v62, v44, v45
    v_cvt_pk_bf16_f32 v63, v46, v47
    v_mfma_f32_32x32x16_bf16 v[32:47], a[16:19], v[72:75], 0
    buffer_load_dwordx4 a[104:107], v13, s[32:35], s6 offen offset:2048 sc1
    v_exp_f32 v16, v16
    v_exp_f32 v17, v17
    v_exp_f32 v18, v18
    v_exp_f32 v19, v19
    v_cvt_pk_bf16_f32 v48, v16, v17
    v_cvt_pk_bf16_f32 v49, v18, v19
    v_mfma_f32_32x32x16_bf16 v[32:47], a[20:23], v[76:79], v[32:47]
    buffer_load_dwordx4 a[108:111], v13, s[32:35], s6 offen offset:3072 sc1
    v_exp_f32 v20, v20
    v_exp_f32 v21, v21
    v_exp_f32 v22, v22
    v_exp_f32 v23, v23
    v_cvt_pk_bf16_f32 v50, v20, v21
    v_cvt_pk_bf16_f32 v51, v22, v23
    v_mfma_f32_32x32x16_bf16 v[192:207], a[8:11], v[56:59], v[192:207]
    v_readlane_b32 s7, v15, 13
    v_exp_f32 v24, v24
    v_exp_f32 v25, v25
    v_exp_f32 v26, v26
    v_exp_f32 v27, v27
    v_cvt_pk_bf16_f32 v52, v24, v25
    v_cvt_pk_bf16_f32 v53, v26, v27
    v_mfma_f32_32x32x16_bf16 v[192:207], a[12:15], v[60:63], v[192:207]
    buffer_load_dwordx4 v3, s[40:43], s66 offen offset:0 lds
    v_exp_f32 v28, v28
    v_exp_f32 v29, v29
    v_exp_f32 v30, v30
    v_exp_f32 v31, v31
    v_cvt_pk_bf16_f32 v54, v28, v29
    v_cvt_pk_bf16_f32 v55, v30, v31
    v_mfma_f32_32x32x16_bf16 v[16:31], a[16:19], v[80:83], 0
    buffer_load_dwordx4 a[112:115], v13, s[32:35], s7 offen offset:0 sc1
    v_exp_f32 v32, v32
    v_exp_f32 v33, v33
    v_exp_f32 v34, v34
    v_exp_f32 v35, v35
    v_cvt_pk_bf16_f32 v56, v32, v33
    v_cvt_pk_bf16_f32 v57, v34, v35
    v_mfma_f32_32x32x16_bf16 v[16:31], a[20:23], v[84:87], v[16:31]
    buffer_load_dwordx4 a[116:119], v13, s[32:35], s7 offen offset:1024 sc1
    v_exp_f32 v36, v36
    v_exp_f32 v37, v37
    v_exp_f32 v38, v38
    v_exp_f32 v39, v39
    v_cvt_pk_bf16_f32 v58, v36, v37
    v_cvt_pk_bf16_f32 v59, v38, v39
    v_mfma_f32_32x32x16_bf16 v[144:159], a[24:27], v[48:51], v[144:159]
    buffer_load_dwordx4 v4, s[40:43], s66 offen offset:1024 lds
    v_exp_f32 v40, v40
    v_exp_f32 v41, v41
    v_exp_f32 v42, v42
    v_exp_f32 v43, v43
    v_cvt_pk_bf16_f32 v60, v40, v41
    v_cvt_pk_bf16_f32 v61, v42, v43
    v_mfma_f32_32x32x16_bf16 v[144:159], a[28:31], v[52:55], v[144:159]
    buffer_load_dwordx4 a[120:123], v13, s[32:35], s7 offen offset:2048 sc1
    v_exp_f32 v44, v44
    v_exp_f32 v45, v45
    v_exp_f32 v46, v46
    v_exp_f32 v47, v47
    v_cvt_pk_bf16_f32 v62, v44, v45
    v_cvt_pk_bf16_f32 v63, v46, v47
    v_mfma_f32_32x32x16_bf16 v[32:47], a[16:19], v[88:91], 0
    buffer_load_dwordx4 a[124:127], v13, s[32:35], s7 offen offset:3072 sc1
    v_exp_f32 v16, v16
    v_exp_f32 v17, v17
    v_exp_f32 v18, v18
    v_exp_f32 v19, v19
    v_cvt_pk_bf16_f32 v48, v16, v17
    v_cvt_pk_bf16_f32 v49, v18, v19
    v_mfma_f32_32x32x16_bf16 v[32:47], a[20:23], v[92:95], v[32:47]
    buffer_load_dwordx4 a[128:131], v13, s[32:35], s70 offen offset:0 sc1
    v_exp_f32 v20, v20
    v_exp_f32 v21, v21
    v_exp_f32 v22, v22
    v_exp_f32 v23, v23
    v_cvt_pk_bf16_f32 v50, v20, v21
    v_cvt_pk_bf16_f32 v51, v22, v23
    v_mfma_f32_32x32x16_bf16 v[160:175], a[24:27], v[56:59], v[160:175]
    buffer_load_dwordx4 v5, s[40:43], s66 offen offset:2048 lds
    v_exp_f32 v24, v24
    v_exp_f32 v25, v25
    v_exp_f32 v26, v26
    v_exp_f32 v27, v27
    v_cvt_pk_bf16_f32 v52, v24, v25
    v_cvt_pk_bf16_f32 v53, v26, v27
    v_mfma_f32_32x32x16_bf16 v[160:175], a[28:31], v[60:63], v[160:175]
    s_waitcnt vmcnt(29)
    v_exp_f32 v28, v28
    v_exp_f32_e64 v29, v29
    v_exp_f32 v30, v30
    v_exp_f32 v31, v31
    v_cvt_pk_bf16_f32 v54, v28, v29
    v_cvt_pk_bf16_f32 v55, v30, v31
    v_mfma_f32_32x32x16_bf16 v[16:31], a[32:35], v[64:67], 0
    buffer_load_dwordx4 a[132:135], v13, s[32:35], s70 offen offset:1024 sc1
    v_exp_f32 v32, v32
    v_exp_f32 v33, v33
    v_exp_f32 v34, v34
    v_exp_f32 v35, v35
    v_cvt_pk_bf16_f32 v56, v32, v33
    v_cvt_pk_bf16_f32 v57, v34, v35
    v_mfma_f32_32x32x16_bf16 v[16:31], a[36:39], v[68:71], v[16:31]
    buffer_load_dwordx4 a[136:139], v13, s[32:35], s70 offen offset:2048 sc1
    v_exp_f32 v36, v36
    v_exp_f32 v37, v37
    v_exp_f32 v38, v38
    v_exp_f32 v39, v39
    v_cvt_pk_bf16_f32 v58, v36, v37
    v_cvt_pk_bf16_f32 v59, v38, v39
    v_mfma_f32_32x32x16_bf16 v[176:191], a[24:27], v[48:51], v[176:191]
    buffer_load_dwordx4 a[140:143], v13, s[32:35], s70 offen offset:3072 sc1
    v_exp_f32 v40, v40
    v_exp_f32 v41, v41
    v_exp_f32 v42, v42
    v_exp_f32 v43, v43
    v_cvt_pk_bf16_f32 v60, v40, v41
    v_cvt_pk_bf16_f32 v61, v42, v43
    v_mfma_f32_32x32x16_bf16 v[176:191], a[28:31], v[52:55], v[176:191]
    buffer_load_dwordx4 v6, s[40:43], s66 offen offset:3072 lds
    s_waitcnt vmcnt(27)
    v_exp_f32 v44, v44
    v_exp_f32_e64 v45, v45
    v_exp_f32 v46, v46
    v_exp_f32 v47, v47
    v_cvt_pk_bf16_f32 v62, v44, v45
    v_cvt_pk_bf16_f32 v63, v46, v47
    v_mfma_f32_32x32x16_bf16 v[32:47], a[48:51], v[64:67], 0
    buffer_load_dwordx4 a[144:147], v2, s[32:35], s70 offen offset:0 sc1
    v_exp_f32 v16, v16
    v_exp_f32 v17, v17
    v_exp_f32 v18, v18
    v_exp_f32 v19, v19
    v_cvt_pk_bf16_f32 v48, v16, v17
    v_cvt_pk_bf16_f32 v49, v18, v19
    v_mfma_f32_32x32x16_bf16 v[32:47], a[52:55], v[68:71], v[32:47]
    s_add_u32 m0, m0, 16384
    s_add_u32 s66, s66, 229376
    v_exp_f32 v20, v20
    v_exp_f32 v21, v21
    v_exp_f32 v22, v22
    v_exp_f32 v23, v23
    v_cvt_pk_bf16_f32 v50, v20, v21
    v_cvt_pk_bf16_f32 v51, v22, v23
    v_mfma_f32_32x32x16_bf16 v[192:207], a[24:27], v[56:59], v[192:207]
    buffer_load_dwordx4 a[148:151], v2, s[32:35], s70 offen offset:1024 sc1
    v_exp_f32 v24, v24
    v_exp_f32 v25, v25
    v_exp_f32 v26, v26
    v_exp_f32 v27, v27
    v_cvt_pk_bf16_f32 v52, v24, v25
    v_cvt_pk_bf16_f32 v53, v26, v27
    v_mfma_f32_32x32x16_bf16 v[192:207], a[28:31], v[60:63], v[192:207]
    global_load_dword v14, v229, s[10:11]
    s_waitcnt vmcnt(24)
    v_exp_f32 v28, v28
    v_exp_f32_e64 v29, v29
    v_exp_f32 v30, v30
    v_exp_f32 v31, v31
    v_cvt_pk_bf16_f32 v54, v28, v29
    v_cvt_pk_bf16_f32 v55, v30, v31
    v_mfma_f32_32x32x16_bf16 v[16:31], a[64:67], v[64:67], 0
    buffer_load_dwordx4 a[152:155], v2, s[32:35], s70 offen offset:2048 sc1
    v_exp_f32 v32, v32
    v_exp_f32 v33, v33
    v_exp_f32 v34, v34
    v_exp_f32 v35, v35
    v_cvt_pk_bf16_f32 v56, v32, v33
    v_cvt_pk_bf16_f32 v57, v34, v35
    v_mfma_f32_32x32x16_bf16 v[16:31], a[68:71], v[68:71], v[16:31]
    buffer_load_dwordx4 a[156:159], v13, s[32:35], s71 offen offset:0 sc1
    v_exp_f32 v36, v36
    v_exp_f32 v37, v37
    v_exp_f32 v38, v38
    v_exp_f32 v39, v39
    v_cvt_pk_bf16_f32 v58, v36, v37
    v_cvt_pk_bf16_f32 v59, v38, v39
    v_mfma_f32_32x32x16_bf16 v[144:159], a[40:43], v[48:51], v[144:159]
    buffer_load_dwordx4 v3, s[40:43], s66 offen offset:0 lds
    v_exp_f32 v40, v40
    v_exp_f32 v41, v41
    v_exp_f32 v42, v42
    v_exp_f32 v43, v43
    v_cvt_pk_bf16_f32 v60, v40, v41
    v_cvt_pk_bf16_f32 v61, v42, v43
    v_mfma_f32_32x32x16_bf16 v[144:159], a[44:47], v[52:55], v[144:159]
    s_waitcnt vmcnt(22)
    v_exp_f32 v44, v44
    v_exp_f32_e64 v45, v45
    v_exp_f32 v46, v46
    v_exp_f32 v47, v47
    v_cvt_pk_bf16_f32 v62, v44, v45
    v_cvt_pk_bf16_f32 v63, v46, v47
    v_mfma_f32_32x32x16_bf16 v[32:47], a[80:83], v[64:67], 0
    buffer_load_dwordx4 a[160:163], v13, s[32:35], s71 offen offset:1024 sc1
    v_exp_f32 v16, v16
    v_exp_f32 v17, v17
    v_exp_f32 v18, v18
    v_exp_f32 v19, v19
    v_cvt_pk_bf16_f32 v48, v16, v17
    v_cvt_pk_bf16_f32 v49, v18, v19
    v_mfma_f32_32x32x16_bf16 v[32:47], a[84:87], v[68:71], v[32:47]
    buffer_load_dwordx4 a[164:167], v13, s[32:35], s71 offen offset:2048 sc1
    v_exp_f32 v20, v20
    v_exp_f32 v21, v21
    v_exp_f32 v22, v22
    v_exp_f32 v23, v23
    v_cvt_pk_bf16_f32 v50, v20, v21
    v_cvt_pk_bf16_f32 v51, v22, v23
    v_mfma_f32_32x32x16_bf16 v[144:159], a[56:59], v[56:59], v[144:159]
    buffer_load_dword v9, v254, s[32:35], 0 offen sc1
    v_exp_f32 v24, v24
    v_exp_f32 v25, v25
    v_exp_f32 v26, v26
    v_exp_f32 v27, v27
    v_cvt_pk_bf16_f32 v52, v24, v25
    v_cvt_pk_bf16_f32 v53, v26, v27
    v_mfma_f32_32x32x16_bf16 v[144:159], a[60:63], v[60:63], v[144:159]
    buffer_load_dwordx4 a[168:171], v13, s[32:35], s71 offen offset:3072 sc1
    s_waitcnt vmcnt(22)
    v_exp_f32 v28, v28
    v_exp_f32_e64 v29, v29
    v_exp_f32 v30, v30
    v_exp_f32 v31, v31
    v_cvt_pk_bf16_f32 v54, v28, v29
    v_cvt_pk_bf16_f32 v55, v30, v31
    v_mfma_f32_32x32x16_bf16 v[16:31], a[96:99], v[64:67], 0
    buffer_load_dwordx4 v4, s[40:43], s66 offen offset:1024 lds
    v_exp_f32 v32, v32
    v_exp_f32 v33, v33
    v_exp_f32 v34, v34
    v_exp_f32 v35, v35
    v_cvt_pk_bf16_f32 v56, v32, v33
    v_cvt_pk_bf16_f32 v57, v34, v35
    v_mfma_f32_32x32x16_bf16 v[16:31], a[100:103], v[68:71], v[16:31]
    buffer_load_dwordx4 a[172:175], v2, s[32:35], s71 offen offset:0 sc1
    v_exp_f32 v36, v36
    v_exp_f32 v37, v37
    v_exp_f32 v38, v38
    v_exp_f32 v39, v39
    v_cvt_pk_bf16_f32 v58, v36, v37
    v_cvt_pk_bf16_f32 v59, v38, v39
    v_mfma_f32_32x32x16_bf16 v[144:159], a[72:75], v[48:51], v[144:159]
    buffer_load_dwordx4 a[176:179], v2, s[32:35], s71 offen offset:1024 sc1
    v_exp_f32 v40, v40
    v_exp_f32 v41, v41
    v_exp_f32 v42, v42
    v_exp_f32 v43, v43
    v_cvt_pk_bf16_f32 v60, v40, v41
    v_cvt_pk_bf16_f32 v61, v42, v43
    v_mfma_f32_32x32x16_bf16 v[144:159], a[76:79], v[52:55], v[144:159]
    s_waitcnt vmcnt(19)
    v_exp_f32 v44, v44
    v_exp_f32_e64 v45, v45
    v_exp_f32 v46, v46
    v_exp_f32 v47, v47
    v_cvt_pk_bf16_f32 v62, v44, v45
    v_cvt_pk_bf16_f32 v63, v46, v47
    v_mfma_f32_32x32x16_bf16 v[32:47], a[112:115], v[64:67], 0
    buffer_load_dwordx4 a[180:183], v2, s[32:35], s71 offen offset:2048 sc1
    v_exp_f32 v16, v16
    v_exp_f32 v17, v17
    v_exp_f32 v18, v18
    v_exp_f32 v19, v19
    v_cvt_pk_bf16_f32 v48, v16, v17
    v_cvt_pk_bf16_f32 v49, v18, v19
    v_mfma_f32_32x32x16_bf16 v[32:47], a[116:119], v[68:71], v[32:47]
    buffer_load_dwordx4 v5, s[40:43], s66 offen offset:2048 lds
    v_exp_f32 v20, v20
    v_exp_f32 v21, v21
    v_exp_f32 v22, v22
    v_exp_f32 v23, v23
    v_cvt_pk_bf16_f32 v50, v20, v21
    v_cvt_pk_bf16_f32 v51, v22, v23
    v_mfma_f32_32x32x16_bf16 v[144:159], a[88:91], v[56:59], v[144:159]
    buffer_load_dwordx4 a[184:187], v13, s[32:35], s72 offen offset:0 sc1
    v_exp_f32 v24, v24
    v_exp_f32 v25, v25
    v_exp_f32 v26, v26
    v_exp_f32 v27, v27
    v_cvt_pk_bf16_f32 v52, v24, v25
    v_cvt_pk_bf16_f32 v53, v26, v27
    v_mfma_f32_32x32x16_bf16 v[144:159], a[92:95], v[60:63], v[144:159]
    buffer_load_dwordx4 a[188:191], v13, s[32:35], s72 offen offset:1024 sc1
    v_exp_f32 v28, v28
    v_exp_f32 v29, v29
    v_exp_f32 v30, v30
    v_exp_f32 v31, v31
    v_cvt_pk_bf16_f32 v54, v28, v29
    v_cvt_pk_bf16_f32 v55, v30, v31
    v_mfma_f32_32x32x16_bf16 v[16:31], a[32:35], v[72:75], 0
    buffer_load_dwordx4 v6, s[40:43], s66 offen offset:3072 lds
    v_exp_f32 v32, v32
    v_exp_f32 v33, v33
    v_exp_f32 v34, v34
    v_exp_f32 v35, v35
    v_cvt_pk_bf16_f32 v56, v32, v33
    v_cvt_pk_bf16_f32 v57, v34, v35
    v_mfma_f32_32x32x16_bf16 v[16:31], a[36:39], v[76:79], v[16:31]
    buffer_load_dwordx4 a[192:195], v13, s[32:35], s72 offen offset:2048 sc1
    v_exp_f32 v36, v36
    v_exp_f32 v37, v37
    v_exp_f32 v38, v38
    v_exp_f32 v39, v39
    v_cvt_pk_bf16_f32 v58, v36, v37
    v_cvt_pk_bf16_f32 v59, v38, v39
    v_mfma_f32_32x32x16_bf16 v[144:159], a[104:107], v[48:51], v[144:159]
    buffer_load_dwordx4 a[196:199], v13, s[32:35], s72 offen offset:3072 sc1
    v_exp_f32 v40, v40
    v_exp_f32 v41, v41
    v_exp_f32 v42, v42
    v_exp_f32 v43, v43
    v_cvt_pk_bf16_f32 v60, v40, v41
    v_cvt_pk_bf16_f32 v61, v42, v43
    v_mfma_f32_32x32x16_bf16 v[144:159], a[108:111], v[52:55], v[144:159]
    s_add_u32 m0, m0, 16384
    s_add_u32 s66, s66, 229376
    v_exp_f32 v44, v44
    v_exp_f32 v45, v45
    v_exp_f32 v46, v46
    v_exp_f32 v47, v47
    v_cvt_pk_bf16_f32 v62, v44, v45
    v_cvt_pk_bf16_f32 v63, v46, v47
    v_mfma_f32_32x32x16_bf16 v[32:47], a[48:51], v[72:75], 0
    buffer_load_dwordx4 a[200:203], v2, s[32:35], s72 offen offset:0 sc1
    v_exp_f32 v16, v16
    v_exp_f32 v17, v17
    v_exp_f32 v18, v18
    v_exp_f32 v19, v19
    v_cvt_pk_bf16_f32 v48, v16, v17
    v_cvt_pk_bf16_f32 v49, v18, v19
    v_mfma_f32_32x32x16_bf16 v[32:47], a[52:55], v[76:79], v[32:47]
    v_exp_f32 v20, v20
    v_exp_f32 v21, v21
    v_exp_f32 v22, v22
    v_exp_f32 v23, v23
    v_cvt_pk_bf16_f32 v50, v20, v21
    v_cvt_pk_bf16_f32 v51, v22, v23
    v_mfma_f32_32x32x16_bf16 v[144:159], a[120:123], v[56:59], v[144:159]
    buffer_load_dwordx4 a[204:207], v2, s[32:35], s72 offen offset:1024 sc1
    v_exp_f32 v24, v24
    v_exp_f32 v25, v25
    v_exp_f32 v26, v26
    v_exp_f32 v27, v27
    v_cvt_pk_bf16_f32 v52, v24, v25
    v_cvt_pk_bf16_f32 v53, v26, v27
    v_mfma_f32_32x32x16_bf16 v[144:159], a[124:127], v[60:63], v[144:159]
    buffer_load_dwordx4 a[208:211], v2, s[32:35], s72 offen offset:2048 sc1
    v_exp_f32 v28, v28
    v_exp_f32 v29, v29
    v_exp_f32 v30, v30
    v_exp_f32 v31, v31
    v_cvt_pk_bf16_f32 v54, v28, v29
    v_cvt_pk_bf16_f32 v55, v30, v31
    v_mfma_f32_32x32x16_bf16 v[16:31], a[64:67], v[72:75], 0
    s_waitcnt vmcnt(14)
    v_cmp_ne_u32 vcc, s54, v9
    v_exp_f32 v32, v32
    v_exp_f32 v33, v33
    v_exp_f32 v34, v34
    v_exp_f32 v35, v35
    v_cvt_pk_bf16_f32 v56, v32, v33
    v_cvt_pk_bf16_f32 v57, v34, v35
    s_cbranch_vccnz L_fnc_w
L_fnc_ok:
    v_mfma_f32_32x32x16_bf16 v[16:31], a[68:71], v[76:79], v[16:31]
    buffer_load_dwordx4 a[212:215], v13, s[32:35], s73 offen offset:0 sc1
    v_exp_f32 v36, v36
    v_exp_f32_e64 v37, v37
    v_exp_f32 v38, v38
    v_exp_f32 v39, v39
    v_cvt_pk_bf16_f32 v58, v36, v37
    v_cvt_pk_bf16_f32 v59, v38, v39
    v_mfma_f32_32x32x16_bf16 v[160:175], a[40:43], v[48:51], v[160:175]
    s_add_u32 m0, s79, 147456
    s_add_u32 s79, s79, 131072
    v_exp_f32 v40, v40
    v_exp_f32 v41, v41
    v_exp_f32 v42, v42
    v_exp_f32 v43, v43
    v_cvt_pk_bf16_f32 v60, v40, v41
    v_cvt_pk_bf16_f32 v61, v42, v43
    v_mfma_f32_32x32x16_bf16 v[160:175], a[44:47], v[52:55], v[160:175]
    buffer_load_dwordx4 a[216:219], v13, s[32:35], s73 offen offset:1024 sc1
    v_exp_f32 v44, v44
    v_exp_f32 v45, v45
    v_exp_f32 v46, v46
    v_exp_f32 v47, v47
    v_cvt_pk_bf16_f32 v62, v44, v45
    v_cvt_pk_bf16_f32 v63, v46, v47
    v_mfma_f32_32x32x16_bf16 v[32:47], a[80:83], v[72:75], 0
    ds_write_b128 v235, v[144:147] offset:0
    v_exp_f32 v16, v16
    v_exp_f32 v17, v17
    v_exp_f32 v18, v18
    v_exp_f32 v19, v19
    v_cvt_pk_bf16_f32 v48, v16, v17
    v_cvt_pk_bf16_f32 v49, v18, v19
    v_mfma_f32_32x32x16_bf16 v[32:47], a[84:87], v[76:79], v[32:47]
    buffer_load_dwordx4 v13, s[32:35], s79 offen sc1 lds
    v_exp_f32 v20, v20
    v_exp_f32 v21, v21
    v_exp_f32 v22, v22
    v_exp_f32 v23, v23
    v_cvt_pk_bf16_f32 v50, v20, v21
    v_cvt_pk_bf16_f32 v51, v22, v23
    v_mfma_f32_32x32x16_bf16 v[160:175], a[56:59], v[56:59], v[160:175]
    buffer_load_dwordx4 a[220:223], v13, s[32:35], s73 offen offset:2048 sc1
    s_barrier
    v_exp_f32 v24, v24
    v_exp_f32_e64 v25, v25
    v_exp_f32 v26, v26
    v_exp_f32 v27, v27
    v_cvt_pk_bf16_f32 v52, v24, v25
    v_cvt_pk_bf16_f32 v53, v26, v27
    v_mfma_f32_32x32x16_bf16 v[160:175], a[60:63], v[60:63], v[160:175]
    s_mov_b32 exec_hi, 0xffff
    buffer_load_dwordx4 v13, s[32:35], s79 offen offset:1024 sc1 lds
    s_mov_b32 exec_hi, -1
    ds_write_b128 v235, v[148:151] offset:1024
    v_exp_f32 v28, v28
    v_exp_f32_e64 v29, v29
    v_exp_f32 v30, v30
    v_exp_f32 v31, v31
    v_cvt_pk_bf16_f32 v54, v28, v29
    v_cvt_pk_bf16_f32 v55, v30, v31
    v_mfma_f32_32x32x16_bf16 v[16:31], a[96:99], v[72:75], 0
    buffer_load_dwordx4 a[224:227], v13, s[32:35], s73 offen offset:3072 sc1
    v_exp_f32 v32, v32
    v_exp_f32 v33, v33
    v_exp_f32 v34, v34
    v_exp_f32 v35, v35
    v_cvt_pk_bf16_f32 v56, v32, v33
    v_cvt_pk_bf16_f32 v57, v34, v35
    v_mfma_f32_32x32x16_bf16 v[16:31], a[100:103], v[76:79], v[16:31]
    buffer_load_dwordx4 a[228:231], v2, s[32:35], s73 offen offset:0 sc1
    v_exp_f32 v36, v36
    v_exp_f32 v37, v37
    v_exp_f32 v38, v38
    v_exp_f32 v39, v39
    v_cvt_pk_bf16_f32 v58, v36, v37
    v_cvt_pk_bf16_f32 v59, v38, v39
    v_mfma_f32_32x32x16_bf16 v[160:175], a[72:75], v[48:51], v[160:175]
    buffer_load_dwordx4 a[232:235], v2, s[32:35], s73 offen offset:1024 sc1
    ds_write_b128 v235, v[152:155] offset:2048
    v_exp_f32 v40, v40
    v_exp_f32 v41, v41
    v_exp_f32 v42, v42
    v_exp_f32 v43, v43
    v_cvt_pk_bf16_f32 v60, v40, v41
    v_cvt_pk_bf16_f32 v61, v42, v43
    v_mfma_f32_32x32x16_bf16 v[160:175], a[76:79], v[52:55], v[160:175]
    buffer_load_dwordx4 a[236:239], v2, s[32:35], s73 offen offset:2048 sc1
    v_exp_f32 v44, v44
    v_exp_f32 v45, v45
    v_exp_f32 v46, v46
    v_exp_f32 v47, v47
    v_cvt_pk_bf16_f32 v62, v44, v45
    v_cvt_pk_bf16_f32 v63, v46, v47
    v_mfma_f32_32x32x16_bf16 v[32:47], a[112:115], v[72:75], 0
    ds_write_b128 v235, v[156:159] offset:3072
    v_exp_f32 v16, v16
    v_exp_f32 v17, v17
    v_exp_f32 v18, v18
    v_exp_f32 v19, v19
    v_cvt_pk_bf16_f32 v48, v16, v17
    v_cvt_pk_bf16_f32 v49, v18, v19
    v_mfma_f32_32x32x16_bf16 v[32:47], a[116:119], v[76:79], v[32:47]
    buffer_load_dwordx4 a[240:243], v13, s[32:35], s74 offen offset:0 sc1
    v_exp_f32 v20, v20
    v_exp_f32 v21, v21
    v_exp_f32 v22, v22
    v_exp_f32 v23, v23
    v_cvt_pk_bf16_f32 v50, v20, v21
    v_cvt_pk_bf16_f32 v51, v22, v23
    v_mfma_f32_32x32x16_bf16 v[160:175], a[88:91], v[56:59], v[160:175]
    buffer_load_dwordx4 a[0:3], v13, s[32:35], s16 offen offset:0 sc1
    v_exp_f32 v24, v24
    v_exp_f32 v25, v25
    v_exp_f32 v26, v26
    v_exp_f32 v27, v27
    v_cvt_pk_bf16_f32 v52, v24, v25
    v_cvt_pk_bf16_f32 v53, v26, v27
    v_mfma_f32_32x32x16_bf16 v[160:175], a[92:95], v[60:63], v[160:175]
    buffer_load_dwordx4 a[244:247], v13, s[32:35], s74 offen offset:1024 sc1
    v_exp_f32 v28, v28
    v_exp_f32 v29, v29
    v_exp_f32 v30, v30
    v_exp_f32 v31, v31
    v_cvt_pk_bf16_f32 v54, v28, v29
    v_cvt_pk_bf16_f32 v55, v30, v31
    v_mfma_f32_32x32x16_bf16 v[16:31], a[32:35], v[80:83], 0
    buffer_load_dwordx4 a[248:251], v13, s[32:35], s74 offen offset:2048 sc1
    v_exp_f32 v32, v32
    v_exp_f32 v33, v33
    v_exp_f32 v34, v34
    v_exp_f32 v35, v35
    v_cvt_pk_bf16_f32 v56, v32, v33
    v_cvt_pk_bf16_f32 v57, v34, v35
    v_mfma_f32_32x32x16_bf16 v[16:31], a[36:39], v[84:87], v[16:31]
    v_exp_f32 v36, v36
    v_exp_f32 v37, v37
    v_exp_f32 v38, v38
    v_exp_f32 v39, v39
    v_cvt_pk_bf16_f32 v58, v36, v37
    v_cvt_pk_bf16_f32 v59, v38, v39
    v_mfma_f32_32x32x16_bf16 v[160:175], a[104:107], v[48:51], v[160:175]
    buffer_load_dwordx4 a[252:255], v13, s[32:35], s74 offen offset:3072 sc1
    v_exp_f32 v40, v40
    v_exp_f32 v41, v41
    v_exp_f32 v42, v42
    v_exp_f32 v43, v43
    v_cvt_pk_bf16_f32 v60, v40, v41
    v_cvt_pk_bf16_f32 v61, v42, v43
    v_mfma_f32_32x32x16_bf16 v[160:175], a[108:111], v[52:55], v[160:175]
    buffer_load_dwordx4 a[4:7], v13, s[32:35], s16 offen offset:1024 sc1
    v_exp_f32 v44, v44
    v_exp_f32 v45, v45
    v_exp_f32 v46, v46
    v_exp_f32 v47, v47
    v_cvt_pk_bf16_f32 v62, v44, v45
    v_cvt_pk_bf16_f32 v63, v46, v47
    v_mfma_f32_32x32x16_bf16 v[32:47], a[48:51], v[80:83], 0
    buffer_load_dwordx4 v[208:211], v2, s[32:35], s74 offen offset:0 sc1
    v_exp_f32 v16, v16
    v_exp_f32 v17, v17
    v_exp_f32 v18, v18
    v_exp_f32 v19, v19
    v_cvt_pk_bf16_f32 v48, v16, v17
    v_cvt_pk_bf16_f32 v49, v18, v19
    v_mfma_f32_32x32x16_bf16 v[32:47], a[52:55], v[84:87], v[32:47]
    buffer_load_dwordx4 v[212:215], v2, s[32:35], s74 offen offset:1024 sc1
    v_exp_f32 v20, v20
    v_exp_f32 v21, v21
    v_exp_f32 v22, v22
    v_exp_f32 v23, v23
    v_cvt_pk_bf16_f32 v50, v20, v21
    v_cvt_pk_bf16_f32 v51, v22, v23
    v_mfma_f32_32x32x16_bf16 v[160:175], a[120:123], v[56:59], v[160:175]
    v_exp_f32 v24, v24
    v_exp_f32 v25, v25
    v_exp_f32 v26, v26
    v_exp_f32 v27, v27
    v_cvt_pk_bf16_f32 v52, v24, v25
    v_cvt_pk_bf16_f32 v53, v26, v27
    v_mfma_f32_32x32x16_bf16 v[160:175], a[124:127], v[60:63], v[160:175]
    buffer_load_dwordx4 v[216:219], v2, s[32:35], s74 offen offset:2048 sc1
    v_exp_f32 v28, v28
    v_exp_f32 v29, v29
    v_exp_f32 v30, v30
    v_exp_f32 v31, v31
    v_cvt_pk_bf16_f32 v54, v28, v29
    v_cvt_pk_bf16_f32 v55, v30, v31
    v_mfma_f32_32x32x16_bf16 v[16:31], a[64:67], v[80:83], 0
    buffer_load_dwordx4 a[8:11], v13, s[32:35], s16 offen offset:2048 sc1
    v_exp_f32 v32, v32
    v_exp_f32 v33, v33
    v_exp_f32 v34, v34
    v_exp_f32 v35, v35
    v_cvt_pk_bf16_f32 v56, v32, v33
    v_cvt_pk_bf16_f32 v57, v34, v35
    v_mfma_f32_32x32x16_bf16 v[16:31], a[68:71], v[84:87], v[16:31]
    buffer_load_dwordx4 v[220:223], v13, s[32:35], s75 offen offset:0 sc1
    v_exp_f32 v36, v36
    v_exp_f32 v37, v37
    v_exp_f32 v38, v38
    v_exp_f32 v39, v39
    v_cvt_pk_bf16_f32 v58, v36, v37
    v_cvt_pk_bf16_f32 v59, v38, v39
    v_mfma_f32_32x32x16_bf16 v[176:191], a[40:43], v[48:51], v[176:191]
    buffer_load_dwordx4 v[224:227], v13, s[32:35], s75 offen offset:1024 sc1
    v_exp_f32 v40, v40
    v_exp_f32 v41, v41
    v_exp_f32 v42, v42
    v_exp_f32 v43, v43
    v_cvt_pk_bf16_f32 v60, v40, v41
    v_cvt_pk_bf16_f32 v61, v42, v43
    v_mfma_f32_32x32x16_bf16 v[176:191], a[44:47], v[52:55], v[176:191]
    ds_write_b128 v235, v[160:163] offset:4096
    v_exp_f32 v44, v44
    v_exp_f32 v45, v45
    v_exp_f32 v46, v46
    v_exp_f32 v47, v47
    v_cvt_pk_bf16_f32 v62, v44, v45
    v_cvt_pk_bf16_f32 v63, v46, v47
    v_mfma_f32_32x32x16_bf16 v[32:47], a[80:83], v[80:83], 0
    buffer_load_dwordx4 v[96:99], v13, s[32:35], s75 offen offset:2048 sc1
    v_exp_f32 v16, v16
    v_exp_f32 v17, v17
    v_exp_f32 v18, v18
    v_exp_f32 v19, v19
    v_cvt_pk_bf16_f32 v48, v16, v17
    v_cvt_pk_bf16_f32 v49, v18, v19
    v_mfma_f32_32x32x16_bf16 v[32:47], a[84:87], v[84:87], v[32:47]
    buffer_load_dwordx4 a[12:15], v13, s[32:35], s16 offen offset:3072 sc1
    v_exp_f32 v20, v20
    v_exp_f32 v21, v21
    v_exp_f32 v22, v22
    v_exp_f32 v23, v23
    v_cvt_pk_bf16_f32 v50, v20, v21
    v_cvt_pk_bf16_f32 v51, v22, v23
    v_mfma_f32_32x32x16_bf16 v[176:191], a[56:59], v[56:59], v[176:191]
    buffer_load_dwordx4 v[100:103], v13, s[32:35], s75 offen offset:3072 sc1
    v_exp_f32 v24, v24
    v_exp_f32 v25, v25
    v_exp_f32 v26, v26
    v_exp_f32 v27, v27
    v_cvt_pk_bf16_f32 v52, v24, v25
    v_cvt_pk_bf16_f32 v53, v26, v27
    v_mfma_f32_32x32x16_bf16 v[176:191], a[60:63], v[60:63], v[176:191]
    ds_write_b128 v235, v[164:167] offset:5120
    v_exp_f32 v28, v28
    v_exp_f32 v29, v29
    v_exp_f32 v30, v30
    v_exp_f32 v31, v31
    v_cvt_pk_bf16_f32 v54, v28, v29
    v_cvt_pk_bf16_f32 v55, v30, v31
    v_mfma_f32_32x32x16_bf16 v[16:31], a[96:99], v[80:83], 0
    buffer_load_dwordx4 v[104:107], v2, s[32:35], s75 offen offset:0 sc1
    v_exp_f32 v32, v32
    v_exp_f32 v33, v33
    v_exp_f32 v34, v34
    v_exp_f32 v35, v35
    v_cvt_pk_bf16_f32 v56, v32, v33
    v_cvt_pk_bf16_f32 v57, v34, v35
    v_mfma_f32_32x32x16_bf16 v[16:31], a[100:103], v[84:87], v[16:31]
    buffer_load_dwordx4 v[108:111], v2, s[32:35], s75 offen offset:1024 sc1
    v_exp_f32 v36, v36
    v_exp_f32 v37, v37
    v_exp_f32 v38, v38
    v_exp_f32 v39, v39
    v_cvt_pk_bf16_f32 v58, v36, v37
    v_cvt_pk_bf16_f32 v59, v38, v39
    v_mfma_f32_32x32x16_bf16 v[176:191], a[72:75], v[48:51], v[176:191]
    buffer_load_dwordx4 a[16:19], v13, s[32:35], s17 offen offset:0 sc1
    ds_write_b128 v235, v[168:171] offset:6144
    v_exp_f32 v40, v40
    v_exp_f32 v41, v41
    v_exp_f32 v42, v42
    v_exp_f32 v43, v43
    v_cvt_pk_bf16_f32 v60, v40, v41
    v_cvt_pk_bf16_f32 v61, v42, v43
    v_mfma_f32_32x32x16_bf16 v[176:191], a[76:79], v[52:55], v[176:191]
    buffer_load_dwordx4 v[112:115], v2, s[32:35], s75 offen offset:2048 sc1
    v_exp_f32 v44, v44
    v_exp_f32 v45, v45
    v_exp_f32 v46, v46
    v_exp_f32 v47, v47
    v_cvt_pk_bf16_f32 v62, v44, v45
    v_cvt_pk_bf16_f32 v63, v46, v47
    v_mfma_f32_32x32x16_bf16 v[32:47], a[112:115], v[80:83], 0
    ds_write_b128 v235, v[172:175] offset:7168
    v_exp_f32 v16, v16
    v_exp_f32 v17, v17
    v_exp_f32 v18, v18
    v_exp_f32 v19, v19
    v_cvt_pk_bf16_f32 v48, v16, v17
    v_cvt_pk_bf16_f32 v49, v18, v19
    v_mfma_f32_32x32x16_bf16 v[32:47], a[116:119], v[84:87], v[32:47]
    buffer_load_dwordx4 v[116:119], v13, s[32:35], s76 offen offset:0 sc1
    v_exp_f32 v20, v20
    v_exp_f32 v21, v21
    v_exp_f32 v22, v22
    v_exp_f32 v23, v23
    v_cvt_pk_bf16_f32 v50, v20, v21
    v_cvt_pk_bf16_f32 v51, v22, v23
    v_mfma_f32_32x32x16_bf16 v[176:191], a[88:91], v[56:59], v[176:191]
    buffer_load_dwordx4 v[120:123], v13, s[32:35], s76 offen offset:1024 sc1
    v_exp_f32 v24, v24
    v_exp_f32 v25, v25
    v_exp_f32 v26, v26
    v_exp_f32 v27, v27
    v_cvt_pk_bf16_f32 v52, v24, v25
    v_cvt_pk_bf16_f32 v53, v26, v27
    v_mfma_f32_32x32x16_bf16 v[176:191], a[92:95], v[60:63], v[176:191]
    buffer_load_dwordx4 a[20:23], v13, s[32:35], s17 offen offset:1024 sc1
    v_exp_f32 v28, v28
    v_exp_f32 v29, v29
    v_exp_f32 v30, v30
    v_exp_f32 v31, v31
    v_cvt_pk_bf16_f32 v54, v28, v29
    v_cvt_pk_bf16_f32 v55, v30, v31
    v_mfma_f32_32x32x16_bf16 v[16:31], a[32:35], v[88:91], 0
    buffer_load_dwordx4 v[124:127], v13, s[32:35], s76 offen offset:2048 sc1
    v_exp_f32 v32, v32
    v_exp_f32 v33, v33
    v_exp_f32 v34, v34
    v_exp_f32 v35, v35
    v_cvt_pk_bf16_f32 v56, v32, v33
    v_cvt_pk_bf16_f32 v57, v34, v35
    v_mfma_f32_32x32x16_bf16 v[16:31], a[36:39], v[92:95], v[16:31]
    v_exp_f32 v36, v36
    v_exp_f32 v37, v37
    v_exp_f32 v38, v38
    v_exp_f32 v39, v39
    v_cvt_pk_bf16_f32 v58, v36, v37
    v_cvt_pk_bf16_f32 v59, v38, v39
    v_mfma_f32_32x32x16_bf16 v[176:191], a[104:107], v[48:51], v[176:191]
    buffer_load_dwordx4 v[128:131], v13, s[32:35], s76 offen offset:3072 sc1
    v_exp_f32 v40, v40
    v_exp_f32 v41, v41
    v_exp_f32 v42, v42
    v_exp_f32 v43, v43
    v_cvt_pk_bf16_f32 v60, v40, v41
    v_cvt_pk_bf16_f32 v61, v42, v43
    v_mfma_f32_32x32x16_bf16 v[176:191], a[108:111], v[52:55], v[176:191]
    buffer_load_dwordx4 a[24:27], v13, s[32:35], s17 offen offset:2048 sc1
    v_exp_f32 v44, v44
    v_exp_f32 v45, v45
    v_exp_f32 v46, v46
    v_exp_f32 v47, v47
    v_cvt_pk_bf16_f32 v62, v44, v45
    v_cvt_pk_bf16_f32 v63, v46, v47
    v_mfma_f32_32x32x16_bf16 v[32:47], a[48:51], v[88:91], 0
    buffer_load_dwordx4 v[132:135], v2, s[32:35], s76 offen offset:0 sc1
    v_exp_f32 v16, v16
    v_exp_f32 v17, v17
    v_exp_f32 v18, v18
    v_exp_f32 v19, v19
    v_cvt_pk_bf16_f32 v48, v16, v17
    v_cvt_pk_bf16_f32 v49, v18, v19
    v_mfma_f32_32x32x16_bf16 v[32:47], a[52:55], v[92:95], v[32:47]
    v_exp_f32 v20, v20
    v_exp_f32 v21, v21
    v_exp_f32 v22, v22
    v_exp_f32 v23, v23
    v_cvt_pk_bf16_f32 v50, v20, v21
    v_cvt_pk_bf16_f32 v51, v22, v23
    v_mfma_f32_32x32x16_bf16 v[176:191], a[120:123], v[56:59], v[176:191]
    global_load_dword v14, v229, s[10:11]
    v_exp_f32 v24, v24
    v_exp_f32 v25, v25
    v_exp_f32 v26, v26
    v_exp_f32 v27, v27
    v_cvt_pk_bf16_f32 v52, v24, v25
    v_cvt_pk_bf16_f32 v53, v26, v27
    v_mfma_f32_32x32x16_bf16 v[176:191], a[124:127], v[60:63], v[176:191]
    v_exp_f32 v28, v28
    v_exp_f32 v29, v29
    v_exp_f32 v30, v30
    v_exp_f32 v31, v31
    v_cvt_pk_bf16_f32 v54, v28, v29
    v_cvt_pk_bf16_f32 v55, v30, v31
    v_mfma_f32_32x32x16_bf16 v[16:31], a[64:67], v[88:91], 0
    buffer_load_dwordx4 a[28:31], v13, s[32:35], s17 offen offset:3072 sc1
    v_exp_f32 v32, v32
    v_exp_f32 v33, v33
    v_exp_f32 v34, v34
    v_exp_f32 v35, v35
    v_cvt_pk_bf16_f32 v56, v32, v33
    v_cvt_pk_bf16_f32 v57, v34, v35
    v_mfma_f32_32x32x16_bf16 v[16:31], a[68:71], v[92:95], v[16:31]
    ds_write_b128 v235, v[176:179] offset:8192
    v_exp_f32 v36, v36
    v_exp_f32 v37, v37
    v_exp_f32 v38, v38
    v_exp_f32 v39, v39
    v_cvt_pk_bf16_f32 v58, v36, v37
    v_cvt_pk_bf16_f32 v59, v38, v39
    v_mfma_f32_32x32x16_bf16 v[192:207], a[40:43], v[48:51], v[192:207]
    ds_write_b128 v235, v[180:183] offset:9216
    v_exp_f32 v40, v40
    v_exp_f32 v41, v41
    v_exp_f32 v42, v42
    v_exp_f32 v43, v43
    v_cvt_pk_bf16_f32 v60, v40, v41
    v_cvt_pk_bf16_f32 v61, v42, v43
    v_mfma_f32_32x32x16_bf16 v[192:207], a[44:47], v[52:55], v[192:207]
    ds_write_b128 v235, v[184:187] offset:10240
    v_exp_f32 v44, v44
    v_exp_f32 v45, v45
    v_exp_f32 v46, v46
    v_exp_f32 v47, v47
    v_cvt_pk_bf16_f32 v62, v44, v45
    v_cvt_pk_bf16_f32 v63, v46, v47
    v_mfma_f32_32x32x16_bf16 v[32:47], a[80:83], v[88:91], 0
    ds_write_b128 v235, v[188:191] offset:11264
    v_exp_f32 v16, v16
    v_exp_f32 v17, v17
    v_exp_f32 v18, v18
    v_exp_f32 v19, v19
    v_cvt_pk_bf16_f32 v48, v16, v17
    v_cvt_pk_bf16_f32 v49, v18, v19
    v_mfma_f32_32x32x16_bf16 v[32:47], a[84:87], v[92:95], v[32:47]
    v_exp_f32 v20, v20
    v_exp_f32 v21, v21
    v_exp_f32 v22, v22
    v_exp_f32 v23, v23
    v_cvt_pk_bf16_f32 v50, v20, v21
    v_cvt_pk_bf16_f32 v51, v22, v23
    v_mfma_f32_32x32x16_bf16 v[192:207], a[56:59], v[56:59], v[192:207]
    buffer_load_dwordx4 a[32:35], v2, s[32:35], s16 offen offset:0 sc1
    v_exp_f32 v24, v24
    v_exp_f32 v25, v25
    v_exp_f32 v26, v26
    v_exp_f32 v27, v27
    v_cvt_pk_bf16_f32 v52, v24, v25
    v_cvt_pk_bf16_f32 v53, v26, v27
    v_mfma_f32_32x32x16_bf16 v[192:207], a[60:63], v[60:63], v[192:207]
    s_waitcnt vmcnt(33)
    s_waitcnt lgkmcnt(0)
    s_barrier
    v_exp_f32 v28, v28
    v_exp_f32_e64 v29, v29
    v_exp_f32 v30, v30
    v_exp_f32 v31, v31
    v_cvt_pk_bf16_f32 v54, v28, v29
    v_cvt_pk_bf16_f32 v55, v30, v31
    v_mfma_f32_32x32x16_bf16 v[16:31], a[96:99], v[88:91], 0
    buffer_load_dwordx4 a[36:39], v2, s[32:35], s16 offen offset:1024 sc1
    ds_read_b128 v[144:147], v236 offset:0
    v_exp_f32 v32, v32
    v_exp_f32 v33, v33
    v_exp_f32 v34, v34
    v_exp_f32 v35, v35
    v_cvt_pk_bf16_f32 v56, v32, v33
    v_cvt_pk_bf16_f32 v57, v34, v35
    v_mfma_f32_32x32x16_bf16 v[16:31], a[100:103], v[92:95], v[16:31]
    buffer_load_dwordx4 a[40:43], v2, s[32:35], s16 offen offset:2048 sc1
    ds_read_b128 v[148:151], v236 offset:1024
    v_exp_f32 v36, v36
    v_exp_f32 v37, v37
    v_exp_f32 v38, v38
    v_exp_f32 v39, v39
    v_cvt_pk_bf16_f32 v58, v36, v37
    v_cvt_pk_bf16_f32 v59, v38, v39
    v_mfma_f32_32x32x16_bf16 v[192:207], a[72:75], v[48:51], v[192:207]
    buffer_load_dwordx4 a[44:47], v2, s[32:35], s16 offen offset:3072 sc1
    ds_read_b128 v[152:155], v236 offset:2048
    v_exp_f32 v40, v40
    v_exp_f32 v41, v41
    v_exp_f32 v42, v42
    v_exp_f32 v43, v43
    v_cvt_pk_bf16_f32 v60, v40, v41
    v_cvt_pk_bf16_f32 v61, v42, v43
    v_mfma_f32_32x32x16_bf16 v[192:207], a[76:79], v[52:55], v[192:207]
    buffer_load_dwordx4 a[48:51], v2, s[32:35], s17 offen offset:0 sc1
    ds_read_b128 v[156:159], v236 offset:3072
    v_exp_f32 v44, v44
    v_exp_f32 v45, v45
    v_exp_f32 v46, v46
    v_exp_f32 v47, v47
    v_cvt_pk_bf16_f32 v62, v44, v45
    v_cvt_pk_bf16_f32 v63, v46, v47
    v_mfma_f32_32x32x16_bf16 v[32:47], a[112:115], v[88:91], 0
    buffer_load_dwordx4 a[52:55], v2, s[32:35], s17 offen offset:1024 sc1
    ds_read_b128 v[160:163], v237 offset:0
    v_exp_f32 v16, v16
    v_exp_f32 v17, v17
    v_exp_f32 v18, v18
    v_exp_f32 v19, v19
    v_cvt_pk_bf16_f32 v48, v16, v17
    v_cvt_pk_bf16_f32 v49, v18, v19
    v_mfma_f32_32x32x16_bf16 v[32:47], a[116:119], v[92:95], v[32:47]
    buffer_load_dwordx4 a[56:59], v2, s[32:35], s17 offen offset:2048 sc1
    ds_read_b128 v[164:167], v237 offset:1024
    v_exp_f32 v20, v20
    v_exp_f32 v21, v21
    v_exp_f32 v22, v22
    v_exp_f32 v23, v23
    v_cvt_pk_bf16_f32 v50, v20, v21
    v_cvt_pk_bf16_f32 v51, v22, v23
    v_mfma_f32_32x32x16_bf16 v[192:207], a[88:91], v[56:59], v[192:207]
    buffer_load_dwordx4 a[60:63], v2, s[32:35], s17 offen offset:3072 sc1
    ds_read_b128 v[168:171], v237 offset:2048
    v_exp_f32 v24, v24
    v_exp_f32 v25, v25
    v_exp_f32 v26, v26
    v_exp_f32 v27, v27
    v_cvt_pk_bf16_f32 v52, v24, v25
    v_cvt_pk_bf16_f32 v53, v26, v27
    v_mfma_f32_32x32x16_bf16 v[192:207], a[92:95], v[60:63], v[192:207]
    ds_read_b128 v[172:175], v237 offset:3072
    v_exp_f32 v28, v28
    v_exp_f32 v29, v29
    v_exp_f32 v30, v30
    v_exp_f32 v31, v31
    v_cvt_pk_bf16_f32 v54, v28, v29
    v_cvt_pk_bf16_f32 v55, v30, v31
    ds_read_b128 v[176:179], v238 offset:0
    v_exp_f32 v32, v32
    v_exp_f32 v33, v33
    v_exp_f32 v34, v34
    v_exp_f32 v35, v35
    v_cvt_pk_bf16_f32 v56, v32, v33
    v_cvt_pk_bf16_f32 v57, v34, v35
    ds_read_b128 v[180:183], v238 offset:1024
    v_exp_f32 v36, v36
    v_exp_f32 v37, v37
    v_exp_f32 v38, v38
    v_exp_f32 v39, v39
    v_cvt_pk_bf16_f32 v58, v36, v37
    v_cvt_pk_bf16_f32 v59, v38, v39
    v_mfma_f32_32x32x16_bf16 v[192:207], a[104:107], v[48:51], v[192:207]
    ds_read_b128 v[184:187], v238 offset:2048
    v_exp_f32 v40, v40
    v_exp_f32 v41, v41
    v_exp_f32 v42, v42
    v_exp_f32 v43, v43
    v_cvt_pk_bf16_f32 v60, v40, v41
    v_cvt_pk_bf16_f32 v61, v42, v43
    v_mfma_f32_32x32x16_bf16 v[192:207], a[108:111], v[52:55], v[192:207]
    ds_read_b128 v[188:191], v238 offset:3072
    v_exp_f32 v44, v44
    v_exp_f32 v45, v45
    v_exp_f32 v46, v46
    v_exp_f32 v47, v47
    v_cvt_pk_bf16_f32 v62, v44, v45
    v_cvt_pk_bf16_f32 v63, v46, v47
    v_mfma_f32_32x32x16_bf16 v[192:207], a[120:123], v[56:59], v[192:207]
    s_waitcnt lgkmcnt(7)
    v_add_f32 v144, v144, v160
    v_add_f32 v145, v145, v161
    v_add_f32 v146, v146, v162
    v_add_f32 v147, v147, v163
    s_waitcnt lgkmcnt(6)
    v_add_f32 v148, v148, v164
    v_add_f32 v149, v149, v165
    v_add_f32 v150, v150, v166
    v_add_f32 v151, v151, v167
    v_mfma_f32_32x32x16_bf16 v[192:207], a[124:127], v[60:63], v[192:207]
    buffer_load_dwordx4 v[48:51], v2, s[32:35], s76 offen offset:1024 sc1
    buffer_load_dwordx4 v[52:55], v2, s[32:35], s76 offen offset:2048 sc1
    s_waitcnt lgkmcnt(5)
    v_add_f32 v152, v152, v168
    v_add_f32 v153, v153, v169
    v_add_f32 v154, v154, v170
    v_add_f32 v155, v155, v171
    s_waitcnt lgkmcnt(4)
    v_add_f32 v156, v156, v172
    v_add_f32 v157, v157, v173
    v_add_f32 v158, v158, v174
    v_add_f32 v159, v159, v175
    s_waitcnt lgkmcnt(3)
    v_pk_add_f32 v[144:145], v[144:145], v[176:177]
    v_pk_add_f32 v[146:147], v[146:147], v[178:179]
    s_waitcnt lgkmcnt(2)
    v_pk_add_f32 v[148:149], v[148:149], v[180:181]
    v_pk_add_f32 v[150:151], v[150:151], v[182:183]
    s_waitcnt lgkmcnt(1)
    v_pk_add_f32 v[152:153], v[152:153], v[184:185]
    v_pk_add_f32 v[154:155], v[154:155], v[186:187]
    s_waitcnt lgkmcnt(0)
    v_pk_add_f32 v[156:157], v[156:157], v[188:189]
    v_pk_add_f32 v[158:159], v[158:159], v[190:191]
    v_pk_add_f32 v[156:157], v[156:157], v[204:205]
    v_pk_add_f32 v[144:145], v[144:145], v[192:193]
    v_pk_add_f32 v[146:147], v[146:147], v[194:195]
    v_pk_add_f32 v[148:149], v[148:149], v[196:197]
    v_pk_add_f32 v[150:151], v[150:151], v[198:199]
    v_pk_add_f32 v[152:153], v[152:153], v[200:201]
    v_pk_add_f32 v[154:155], v[154:155], v[202:203]
    v_mov_b32 v16, v156
    v_mov_b32 v17, v156
    v_pk_add_f32 v[158:159], v[158:159], v[206:207]
    v_mov_b32 v18, 0
    v_permlane32_swap_b32 v16, v17
    s_mov_b32 s68, 0x12800000
    s_mov_b32 s69, 0x76800000
    v_rcp_f32 v16, v17
    v_cmp_nle_f32 s[80:81], s68, v17
    v_cmp_nge_f32 vcc, s69, v17
    v_mov_b32 v19, 0
    v_pk_mul_f32 v[144:145], v[144:145], v[16:17] op_sel_hi:[1,0]
    v_pk_mul_f32 v[146:147], v[146:147], v[16:17] op_sel_hi:[1,0]
    v_pk_mul_f32 v[148:149], v[148:149], v[16:17] op_sel_hi:[1,0]
    v_pk_mul_f32 v[150:151], v[150:151], v[16:17] op_sel_hi:[1,0]
    v_pk_mul_f32 v[152:153], v[152:153], v[16:17] op_sel_hi:[1,0]
    v_pk_mul_f32 v[154:155], v[154:155], v[16:17] op_sel_hi:[1,0]
    v_pk_mul_f32 v[156:157], v[156:157], v[16:17] op_sel_hi:[1,0]
    v_pk_mul_f32 v[158:159], v[158:159], v[16:17] op_sel_hi:[1,0]
    s_or_b64 s[80:81], s[80:81], vcc
    v_cvt_pk_bf16_f32 v20, v144, v145
    v_cvt_pk_bf16_f32 v21, v146, v147
    ds_write_b64 v242, v[20:21] offset:0
    v_cvt_pk_bf16_f32 v22, v148, v149
    v_cvt_pk_bf16_f32 v23, v150, v151
    ds_write_b64 v242, v[22:23] offset:8
    v_cvt_pk_bf16_f32 v24, v152, v153
    v_cvt_pk_bf16_f32 v25, v154, v155
    ds_write_b64 v242, v[24:25] offset:32
    v_cvt_pk_bf16_f32 v26, v156, v157
    v_cvt_pk_bf16_f32 v27, v158, v159
    s_mov_b32 exec_hi, 0
    ds_write_b64 v242, v[26:27] offset:40
    s_mov_b32 exec_hi, -1
    v_pk_fma_f32 v[18:19], v[144:145], 0, v[18:19] op_sel_hi:[1,0,1]
    v_pk_fma_f32 v[18:19], v[146:147], 0, v[18:19] op_sel_hi:[1,0,1]
    v_pk_fma_f32 v[18:19], v[148:149], 0, v[18:19] op_sel_hi:[1,0,1]
    v_pk_fma_f32 v[18:19], v[150:151], 0, v[18:19] op_sel_hi:[1,0,1]
    v_pk_fma_f32 v[18:19], v[152:153], 0, v[18:19] op_sel_hi:[1,0,1]
    v_pk_fma_f32 v[18:19], v[154:155], 0, v[18:19] op_sel_hi:[1,0,1]
    v_pk_fma_f32 v[18:19], v[156:157], 0, v[18:19] op_sel_hi:[1,0,1]
    v_pk_fma_f32 v[18:19], v[158:159], 0, v[18:19] op_sel_hi:[1,0,1]
    v_cmp_u_f32 vcc, v18, v19
    s_lshl_b32 s68, s53, 2
    s_add_u32 s68, s68, 162816
    v_mov_b32_e64 v18, s68
    s_or_b64 s[80:81], s[80:81], vcc
    s_cselect_b32 s69, 1, 0
    v_mov_b32 v19, s69
    ds_write_b32 v18, v19
    v_mov_b32 v18, 162816
    s_lshl_b32 s68, s53, 12
    s_add_u32 m0, s68, 98304
    s_waitcnt lgkmcnt(0)
    s_barrier
    ds_read_b128 v[44:47], v18
    ds_read_b128 v[144:147], v243 offset:0
    ds_read_b128 v[148:151], v243 offset:64
    ds_read_b128 v[152:155], v243 offset:128
    ds_read_b128 v[156:159], v243 offset:192
    ds_read_b128 v[160:163], v243 offset:256
    ds_read_b128 v[164:167], v243 offset:320
    ds_read_b128 v[168:171], v243 offset:384
    buffer_load_dwordx4 v3, s[40:43], s66 offen offset:0 lds
    buffer_load_dwordx4 v4, s[40:43], s66 offen offset:1024 lds
    buffer_load_dwordx4 v5, s[40:43], s66 offen offset:2048 lds
    buffer_load_dwordx4 v6, s[40:43], s66 offen offset:3072 lds
    s_waitcnt lgkmcnt(7)
    v_or3_b32 v44, v44, v45, v46
    v_or_b32 v44, v44, v47
    s_nop 0
    v_readfirstlane_b32 s68, v44
    s_nop 0
    s_andn2_b32 s68, s68, s63
    s_cbranch_scc1 L_truemax
    s_waitcnt vmcnt(16)
    s_waitcnt lgkmcnt(6)
    v_mfma_f32_16x16x32_bf16 v[16:19], a[128:131], v[144:147], 0
    buffer_load_dwordx4 a[64:67], v13, s[32:35], s18 offen offset:0 sc1
    v_mfma_f32_16x16x32_bf16 v[20:23], a[156:159], v[144:147], 0
    v_mfma_f32_16x16x32_bf16 v[24:27], a[184:187], v[144:147], 0
    s_waitcnt lgkmcnt(5)
    v_mfma_f32_16x16x32_bf16 v[16:19], a[132:135], v[148:151], v[16:19]
    v_mfma_f32_16x16x32_bf16 v[20:23], a[160:163], v[148:151], v[20:23]
    v_mfma_f32_16x16x32_bf16 v[24:27], a[188:191], v[148:151], v[24:27]
    s_waitcnt lgkmcnt(4)
    v_mfma_f32_16x16x32_bf16 v[16:19], a[136:139], v[152:155], v[16:19]
    v_mfma_f32_16x16x32_bf16 v[20:23], a[164:167], v[152:155], v[20:23]
    v_mfma_f32_16x16x32_bf16 v[24:27], a[192:195], v[152:155], v[24:27]
    s_waitcnt lgkmcnt(3)
    v_mfma_f32_16x16x32_bf16 v[16:19], a[140:143], v[156:159], v[16:19]
    v_mfma_f32_16x16x32_bf16 v[20:23], a[168:171], v[156:159], v[20:23]
    v_mfma_f32_16x16x32_bf16 v[24:27], a[196:199], v[156:159], v[24:27]
    s_waitcnt lgkmcnt(2)
    v_mfma_f32_16x16x32_bf16 v[16:19], a[144:147], v[160:163], v[16:19]
    v_mfma_f32_16x16x32_bf16 v[20:23], a[172:175], v[160:163], v[20:23]
    v_mfma_f32_16x16x32_bf16 v[24:27], a[200:203], v[160:163], v[24:27]
    s_waitcnt lgkmcnt(1)
    v_mfma_f32_16x16x32_bf16 v[16:19], a[148:151], v[164:167], v[16:19]
    v_mfma_f32_16x16x32_bf16 v[20:23], a[176:179], v[164:167], v[20:23]
    v_mfma_f32_16x16x32_bf16 v[24:27], a[204:207], v[164:167], v[24:27]
    s_waitcnt lgkmcnt(0)
    v_mfma_f32_16x16x32_bf16 v[16:19], a[152:155], v[168:171], v[16:19]
    v_mfma_f32_16x16x32_bf16 v[20:23], a[180:183], v[168:171], v[20:23]
    v_mfma_f32_16x16x32_bf16 v[24:27], a[208:211], v[168:171], v[24:27]
    v_mfma_f32_16x16x32_bf16 v[28:31], a[212:215], v[144:147], 0
    v_mfma_f32_16x16x32_bf16 v[32:35], a[240:243], v[144:147], 0
    v_mfma_f32_16x16x32_bf16 v[28:31], a[216:219], v[148:151], v[28:31]
    s_cmp_eq_u32 s2, 0
    s_cbranch_scc1 L_st_14_g
    s_nop 0
    buffer_store_dwordx4 v[16:19], v239, s[32:35], s78 offen offset:0
    v_mfma_f32_16x16x32_bf16 v[32:35], a[244:247], v[148:151], v[32:35]
    v_mfma_f32_16x16x32_bf16 v[28:31], a[220:223], v[152:155], v[28:31]
    ds_write_b128 v244, v[16:19] offset:0
    v_mfma_f32_16x16x32_bf16 v[32:35], a[248:251], v[152:155], v[32:35]
    v_mfma_f32_16x16x32_bf16 v[28:31], a[224:227], v[156:159], v[28:31]
    buffer_store_dwordx4 v[20:23], v239, s[32:35], s78 offen offset:512
    v_mfma_f32_16x16x32_bf16 v[32:35], a[252:255], v[156:159], v[32:35]
    v_mfma_f32_16x16x32_bf16 v[28:31], a[228:231], v[160:163], v[28:31]
    ds_write_b128 v244, v[20:23] offset:512
    v_mfma_f32_16x16x32_bf16 v[32:35], v[208:211], v[160:163], v[32:35]
    v_mfma_f32_16x16x32_bf16 v[28:31], a[232:235], v[164:167], v[28:31]
    buffer_store_dwordx4 v[24:27], v239, s[32:35], s78 offen offset:1024
L_st_14_j:
    v_mfma_f32_16x16x32_bf16 v[32:35], v[212:215], v[164:167], v[32:35]
    v_mfma_f32_16x16x32_bf16 v[28:31], a[236:239], v[168:171], v[28:31]
    ds_write_b128 v244, v[24:27] offset:1024
    v_mfma_f32_16x16x32_bf16 v[32:35], v[216:219], v[168:171], v[32:35]
    v_mfma_f32_16x16x32_bf16 v[36:39], v[220:223], v[144:147], 0
    v_mfma_f32_16x16x32_bf16 v[40:43], v[116:119], v[144:147], 0
    v_mfma_f32_16x16x32_bf16 v[36:39], v[224:227], v[148:151], v[36:39]
    s_cmp_eq_u32 s2, 0
    s_cbranch_scc1 L_st_15_g
    s_nop 0
    buffer_store_dwordx4 v[28:31], v239, s[32:35], s78 offen offset:1536
    v_mfma_f32_16x16x32_bf16 v[40:43], v[120:123], v[148:151], v[40:43]
    v_mfma_f32_16x16x32_bf16 v[36:39], v[96:99], v[152:155], v[36:39]
    ds_write_b128 v244, v[28:31] offset:1536
    v_mfma_f32_16x16x32_bf16 v[40:43], v[124:127], v[152:155], v[40:43]
    v_mfma_f32_16x16x32_bf16 v[36:39], v[100:103], v[156:159], v[36:39]
    buffer_store_dwordx4 v[32:35], v239, s[32:35], s78 offen offset:2048
L_st_15_j:
    v_mfma_f32_16x16x32_bf16 v[40:43], v[128:131], v[156:159], v[40:43]
    v_mfma_f32_16x16x32_bf16 v[36:39], v[104:107], v[160:163], v[36:39]
    ds_write_b128 v244, v[32:35] offset:2048
    v_mfma_f32_16x16x32_bf16 v[40:43], v[132:135], v[160:163], v[40:43]
    v_mfma_f32_16x16x32_bf16 v[36:39], v[108:111], v[164:167], v[36:39]
    s_waitcnt vmcnt(11)
    v_mfma_f32_16x16x32_bf16 v[40:43], v[48:51], v[164:167], v[40:43]
    v_mfma_f32_16x16x32_bf16 v[36:39], v[112:115], v[168:171], v[36:39]
    s_waitcnt vmcnt(10)
    v_mfma_f32_16x16x32_bf16 v[40:43], v[52:55], v[168:171], v[40:43]
    v_lshlrev_b32 v72, 16, v136
    v_and_b32 v73, s61, v136
    v_lshlrev_b32 v74, 16, v137
    v_and_b32 v75, s61, v137
    v_lshlrev_b32 v76, 16, v138
    v_and_b32 v77, s61, v138
    v_lshlrev_b32 v78, 16, v139
    v_and_b32_e64 v79, s61, v139
    s_cmp_eq_u32 s2, 0
    s_cbranch_scc1 L_st_16_g
    buffer_store_dwordx4 v[36:39], v239, s[32:35], s78 offen offset:2560
    buffer_store_dwordx4 v[40:43], v239, s[32:35], s78 offen offset:3072
L_st_16_j:
    ds_write_b128 v244, v[36:39] offset:2560
    ds_write_b128 v244, v[40:43] offset:3072
    v_mov_b32_e64 v44, 0
    s_mov_b32 exec_hi, 0xffffff
    buffer_load_dwordx4 v[208:211], v245, s[32:35], s3 offen offset:0 sc1
    buffer_load_dwordx4 v[212:215], v245, s[32:35], s3 offen offset:128 sc1
    buffer_load_dwordx4 v[216:219], v245, s[32:35], s3 offen offset:256 sc1
    buffer_load_dwordx4 v[220:223], v245, s[32:35], s3 offen offset:384 sc1
    ds_read_b128 v[48:51], v246 offset:0
    ds_read_b128 v[96:99], v247 offset:0
    ds_read_b128 v[52:55], v246 offset:128
    ds_read_b128 v[100:103], v247 offset:16
    ds_read_b128 v[56:59], v246 offset:256
    ds_read_b128 v[104:107], v247 offset:32
    ds_read_b128 v[60:63], v246 offset:384
    ds_read_b128 v[108:111], v247 offset:48
    v_lshlrev_b32 v80, 16, v140
    v_and_b32 v81, s61, v140
    v_lshlrev_b32 v82, 16, v141
    v_and_b32 v83, s61, v141
    v_lshlrev_b32 v84, 16, v142
    v_and_b32 v85, s61, v142
    v_lshlrev_b32 v86, 16, v143
    v_and_b32 v87, s61, v143
    s_waitcnt lgkmcnt(6)
    v_pk_fma_f32 v[72:73], v[48:49], v[96:97], v[72:73]
    v_pk_fma_f32 v[74:75], v[50:51], v[98:99], v[74:75]
    s_waitcnt lgkmcnt(4)
    v_pk_fma_f32 v[76:77], v[52:53], v[100:101], v[76:77]
    v_pk_fma_f32 v[78:79], v[54:55], v[102:103], v[78:79]
    s_waitcnt lgkmcnt(2)
    v_pk_fma_f32 v[80:81], v[56:57], v[104:105], v[80:81]
    v_pk_fma_f32 v[82:83], v[58:59], v[106:107], v[82:83]
    s_waitcnt lgkmcnt(0)
    v_pk_fma_f32 v[84:85], v[60:61], v[108:109], v[84:85]
    v_pk_fma_f32 v[86:87], v[62:63], v[110:111], v[86:87]
    ds_read_b128 v[112:115], v247 offset:3584
    ds_read_b128 v[128:131], v247 offset:1792
    ds_read_b128 v[116:119], v247 offset:3600
    ds_read_b128 v[132:135], v247 offset:1808
    ds_read_b128 v[120:123], v247 offset:3616
    ds_read_b128 v[136:139], v247 offset:1824
    ds_read_b128 v[124:127], v247 offset:3632
    ds_read_b128 v[140:143], v247 offset:1840
    v_pk_add_f32 v[50:51], v[72:73], v[74:75]
    v_pk_add_f32 v[46:47], v[76:77], v[78:79]
    v_pk_add_f32 v[50:51], v[50:51], v[80:81]
    v_pk_add_f32 v[46:47], v[46:47], v[82:83]
    v_pk_add_f32 v[50:51], v[50:51], v[84:85]
    v_pk_add_f32 v[46:47], v[46:47], v[86:87]
    v_pk_add_f32 v[50:51], v[50:51], v[46:47]
    v_add_f32 v44, v50, v51
    s_mov_b32 exec_hi, -1
    v_mov_b32 v60, 0
    v_mov_b32 v62, 0
    v_add_f32_dpp v44, v44, v44 row_ror:8 row_mask:0xf bank_mask:0xf
    v_mov_b32 v45, v44
    s_nop 1
    v_permlane16_swap_b32 v44, v45
    v_add_f32 v44, v44, v45
    v_mov_b32 v45, v44
    s_nop 1
    v_permlane32_swap_b32 v44, v45
    v_add_f32 v44, v44, v45
    v_mul_f32 v48, 0x3c124925, v44
    v_pk_add_f32 v[72:73], v[72:73], v[48:49] op_sel_hi:[1,0] neg_lo:[0,1] neg_hi:[0,1]
    v_pk_add_f32 v[74:75], v[74:75], v[48:49] op_sel_hi:[1,0] neg_lo:[0,1] neg_hi:[0,1]
    v_pk_add_f32 v[76:77], v[76:77], v[48:49] op_sel_hi:[1,0] neg_lo:[0,1] neg_hi:[0,1]
    v_pk_add_f32 v[78:79], v[78:79], v[48:49] op_sel_hi:[1,0] neg_lo:[0,1] neg_hi:[0,1]
    v_pk_add_f32 v[80:81], v[80:81], v[48:49] op_sel_hi:[1,0] neg_lo:[0,1] neg_hi:[0,1]
    v_pk_add_f32 v[82:83], v[82:83], v[48:49] op_sel_hi:[1,0] neg_lo:[0,1] neg_hi:[0,1]
    v_pk_add_f32 v[84:85], v[84:85], v[48:49] op_sel_hi:[1,0] neg_lo:[0,1] neg_hi:[0,1]
    v_pk_add_f32 v[86:87], v[86:87], v[48:49] op_sel_hi:[1,0] neg_lo:[0,1] neg_hi:[0,1]
    s_lshl_b32 s77, s55, 2
    s_mul_i32 s75, s56, 9363
    s_lshr_b32 s75, s75, 16
    s_add_u32 s78, s77, s75
    s_add_u32 s77, s77, s53
    s_lshl_b32 s77, s77, 1
    s_lshr_b32 s79, s52, 2
    s_lshl_b32 s79, s79, 3
    s_and_b32 s81, s52, 3
    s_add_u32 s79, s79, s81
    s_lshl_b32 s79, s79, 2
    s_add_u32 s79, s79, s53
    s_lshl_b32 s79, s79, 2
    s_add_u32 s25, s79, 73728
    s_lshl_b32 s11, s77, 7
    s_add_u32 s79, s11, 73728
    v_and_b32 v229, 15, v1
    v_lshl_add_u32 v229, v229, 2, s79
    v_bfe_u32 v231, v1, 4, 1
    v_lshl_add_u32 v7, v231, 7, v229
    buffer_load_dwordx4 a[68:71], v13, s[32:35], s18 offen offset:1024 sc1
    buffer_load_dwordx4 a[72:75], v13, s[32:35], s18 offen offset:2048 sc1
    s_mov_b32 exec_hi, 0xffffff
    s_waitcnt vmcnt(2)
    v_max3_u32 v9, v208, v212, v216
    v_max_u32 v9, v9, v220
    v_cmp_eq_u32 vcc, -1, v9
    s_cbranch_vccz L_xc_ok
    s_mov_b32 s62, 20000
    buffer_load_dwordx4 v[208:211], v245, s[32:35], s3 offen offset:0 sc1
    buffer_load_dwordx4 v[212:215], v245, s[32:35], s3 offen offset:128 sc1
    buffer_load_dwordx4 v[216:219], v245, s[32:35], s3 offen offset:256 sc1
    buffer_load_dwordx4 v[220:223], v245, s[32:35], s3 offen offset:384 sc1
L_xc_17:
    s_waitcnt vmcnt(0)
    v_max3_u32 v9, v208, v212, v216
    v_max_u32 v9, v9, v220
    v_cmp_eq_u32 vcc, -1, v9
    s_cbranch_vccz L_xc_17_ok
    s_sub_u32 s62, s62, 1
    s_cbranch_scc1 L_xc_17_ok
    buffer_load_dwordx4 v[208:211], v245, s[32:35], s3 offen offset:0 sc1
    buffer_load_dwordx4 v[212:215], v245, s[32:35], s3 offen offset:128 sc1
    buffer_load_dwordx4 v[216:219], v245, s[32:35], s3 offen offset:256 sc1
    buffer_load_dwordx4 v[220:223], v245, s[32:35], s3 offen offset:384 sc1
    s_branch L_xc_17
L_xc_17_ok:
L_xc_ok:
    s_mov_b32 exec_hi, 0xffffff
    s_nop 0
    v_pk_fma_f32 v[72:73], v[208:209], v[96:97], v[72:73]
    v_pk_fma_f32 v[74:75], v[210:211], v[98:99], v[74:75]
    v_pk_fma_f32 v[76:77], v[212:213], v[100:101], v[76:77]
    v_pk_fma_f32 v[78:79], v[214:215], v[102:103], v[78:79]
    v_pk_fma_f32 v[80:81], v[216:217], v[104:105], v[80:81]
    v_pk_fma_f32 v[82:83], v[218:219], v[106:107], v[82:83]
    v_pk_fma_f32 v[84:85], v[220:221], v[108:109], v[84:85]
    v_pk_fma_f32 v[86:87], v[222:223], v[110:111], v[86:87]
    v_pk_mul_f32 v[52:53], v[72:73], v[72:73]
    v_pk_add_f32 v[50:51], v[72:73], v[74:75]
    v_pk_mul_f32 v[54:55], v[74:75], v[74:75]
    v_pk_add_f32 v[46:47], v[76:77], v[78:79]
    v_pk_fma_f32 v[52:53], v[76:77], v[76:77], v[52:53]
    v_pk_add_f32 v[50:51], v[50:51], v[80:81]
    v_pk_fma_f32 v[54:55], v[78:79], v[78:79], v[54:55]
    v_pk_add_f32 v[46:47], v[46:47], v[82:83]
    v_pk_fma_f32 v[52:53], v[80:81], v[80:81], v[52:53]
    v_pk_add_f32 v[50:51], v[50:51], v[84:85]
    v_pk_fma_f32 v[54:55], v[82:83], v[82:83], v[54:55]
    v_pk_add_f32 v[46:47], v[46:47], v[86:87]
    v_pk_fma_f32 v[52:53], v[84:85], v[84:85], v[52:53]
    v_pk_add_f32 v[50:51], v[50:51], v[46:47]
    v_pk_fma_f32 v[54:55], v[86:87], v[86:87], v[54:55]
    v_add_f32_e64 v60, v50, v51
    v_pk_add_f32 v[52:53], v[52:53], v[54:55]
    v_add_f32 v62, v52, v53
    s_mov_b32 exec_hi, -1
    buffer_load_dwordx4 a[76:79], v13, s[32:35], s18 offen offset:3072 sc1
    buffer_load_dwordx4 a[80:83], v13, s[32:35], s19 offen offset:0 sc1
    v_pk_add_f32 v[208:209], v[72:73], v[48:49] op_sel_hi:[1,0]
    v_add_f32_dpp v60, v60, v60 row_ror:8 row_mask:0xf bank_mask:0xf
    v_add_f32_dpp v62, v62, v62 row_ror:8 row_mask:0xf bank_mask:0xf
    v_mov_b32 v61, v60
    v_mov_b32 v63, v62
    v_pk_add_f32 v[210:211], v[74:75], v[48:49] op_sel_hi:[1,0]
    v_permlane16_swap_b32 v60, v61
    v_permlane16_swap_b32 v62, v63
    v_add_f32 v60, v60, v61
    v_add_f32 v62, v62, v63
    v_mov_b32 v61, v60
    v_mov_b32 v63, v62
    v_pk_add_f32 v[212:213], v[76:77], v[48:49] op_sel_hi:[1,0]
    v_permlane32_swap_b32 v60, v61
    v_permlane32_swap_b32 v62, v63
    v_add_f32 v60, v60, v61
    v_add_f32 v62, v62, v63
    v_mul_f32 v61, 0x3c124925, v60
    v_pk_add_f32 v[214:215], v[78:79], v[48:49] op_sel_hi:[1,0]
    v_fma_f32 v65, -v60, v61, v62
    v_add_f32_e64 v64, v48, v61
    ds_write_b64 v249, v[64:65]
    buffer_load_dwordx4 a[84:87], v13, s[32:35], s19 offen offset:1024 sc1
    buffer_load_dwordx4 a[88:91], v13, s[32:35], s19 offen offset:2048 sc1
    v_pk_add_f32 v[216:217], v[80:81], v[48:49] op_sel_hi:[1,0]
    v_pk_add_f32 v[218:219], v[82:83], v[48:49] op_sel_hi:[1,0]
    v_pk_add_f32 v[220:221], v[84:85], v[48:49] op_sel_hi:[1,0]
    v_pk_add_f32 v[222:223], v[86:87], v[48:49] op_sel_hi:[1,0]
    v_cvt_pk_bf16_f32 v16, v208, v209
    v_cvt_pk_bf16_f32 v17, v210, v211
    v_cvt_pk_bf16_f32 v18, v212, v213
    v_cvt_pk_bf16_f32 v19, v214, v215
    v_cvt_pk_bf16_f32 v20, v216, v217
    v_cvt_pk_bf16_f32 v21, v218, v219
    v_cvt_pk_bf16_f32 v22, v220, v221
    v_cvt_pk_bf16_f32 v23, v222, v223
    s_cmp_eq_u32 s2, 0
    s_cbranch_scc1 L_st_18_g
    buffer_store_dwordx4 v[16:19], v248, s[32:35], s3 offen offset:1792 nt
    buffer_store_dwordx4 v[20:23], v248, s[32:35], s3 offen offset:1920 nt
L_st_18_j:
    s_waitcnt lgkmcnt(0)
    s_barrier
    ds_read_b128 v[52:55], v250
    ds_read_b128 v[56:59], v250 offset:16
    v_pk_mul_f32 v[72:73], v[72:73], v[112:113]
    v_pk_mul_f32 v[74:75], v[74:75], v[114:115]
    v_pk_mul_f32 v[76:77], v[76:77], v[116:117]
    v_pk_mul_f32 v[78:79], v[78:79], v[118:119]
    v_pk_mul_f32 v[80:81], v[80:81], v[120:121]
    v_pk_mul_f32 v[82:83], v[82:83], v[122:123]
    v_pk_mul_f32 v[84:85], v[84:85], v[124:125]
    v_pk_mul_f32 v[86:87], v[86:87], v[126:127]
    buffer_load_dwordx4 a[92:95], v13, s[32:35], s19 offen offset:3072 sc1
    buffer_load_dwordx4 a[96:99], v13, s[32:35], s20 offen offset:0 sc1
    s_mov_b32 s69, 0xbe800000
    v_mov_b32 v60, 0x3727c5ac
    s_waitcnt lgkmcnt(1)
    v_pk_add_f32 v[44:45], v[52:53], v[54:55]
    s_waitcnt lgkmcnt(0)
    v_pk_add_f32 v[46:47], v[56:57], v[58:59]
    v_pk_add_f32 v[44:45], v[44:45], v[46:47]
    v_fma_f32 v52, v44, s69, v52
    v_fma_f32 v54, v44, s69, v54
    v_fma_f32 v56, v44, s69, v56
    v_fma_f32 v58, v44, s69, v58
    v_fmac_f32 v60, 0x3b124925, v45
    v_mul_f32 v46, v52, v52
    v_fmac_f32 v46, v54, v54
    v_fmac_f32 v46, v56, v56
    v_fmac_f32 v46, v58, v58
    v_fmac_f32 v60, 0x3e800000, v46
    v_rsq_f32_e64 v46, v60
    v_fma_f32 v48, v44, s69, v48
    v_pk_fma_f32 v[72:73], v[112:113], v[48:49], v[72:73] op_sel_hi:[1,0,1]
    v_pk_fma_f32 v[74:75], v[114:115], v[48:49], v[74:75] op_sel_hi:[1,0,1]
    v_pk_fma_f32 v[76:77], v[116:117], v[48:49], v[76:77] op_sel_hi:[1,0,1]
    v_pk_fma_f32 v[78:79], v[118:119], v[48:49], v[78:79] op_sel_hi:[1,0,1]
    v_pk_fma_f32 v[72:73], v[72:73], v[46:47], v[128:129] op_sel_hi:[1,0,1]
    v_pk_fma_f32 v[74:75], v[74:75], v[46:47], v[130:131] op_sel_hi:[1,0,1]
    v_pk_fma_f32 v[76:77], v[76:77], v[46:47], v[132:133] op_sel_hi:[1,0,1]
    v_pk_fma_f32 v[78:79], v[78:79], v[46:47], v[134:135] op_sel_hi:[1,0,1]
    v_cvt_pk_bf16_f32 v24, v72, v73
    v_cvt_pk_bf16_f32 v25, v74, v75
    v_cvt_pk_bf16_f32 v26, v76, v77
    v_cvt_pk_bf16_f32 v27, v78, v79
    s_cmp_eq_u32 s2, 0
    s_cbranch_scc1 L_st_19_g
    buffer_store_dwordx4 v[24:27], v248, s[32:35], s3 offen offset:0
    v_pk_fma_f32 v[80:81], v[120:121], v[48:49], v[80:81] op_sel_hi:[1,0,1]
    v_pk_fma_f32 v[82:83], v[122:123], v[48:49], v[82:83] op_sel_hi:[1,0,1]
    v_pk_fma_f32 v[84:85], v[124:125], v[48:49], v[84:85] op_sel_hi:[1,0,1]
    v_pk_fma_f32 v[86:87], v[126:127], v[48:49], v[86:87] op_sel_hi:[1,0,1]
    v_pk_fma_f32 v[80:81], v[80:81], v[46:47], v[136:137] op_sel_hi:[1,0,1]
    v_pk_fma_f32 v[82:83], v[82:83], v[46:47], v[138:139] op_sel_hi:[1,0,1]
    v_pk_fma_f32 v[84:85], v[84:85], v[46:47], v[140:141] op_sel_hi:[1,0,1]
    v_pk_fma_f32 v[86:87], v[86:87], v[46:47], v[142:143] op_sel_hi:[1,0,1]
    v_cvt_pk_bf16_f32 v28, v80, v81
    v_cvt_pk_bf16_f32 v29, v82, v83
    v_cvt_pk_bf16_f32 v30, v84, v85
    v_cvt_pk_bf16_f32 v31, v86, v87
    buffer_store_dwordx4 v[28:31], v248, s[32:35], s3 offen offset:128
L_st_19_j:
    v_lshrrev_b32 v228, 4, v1
    v_bfe_u32 v229, v1, 2, 2
    v_and_b32 v230, 1, v1
    v_bfe_u32 v232, v1, 1, 1
    v_lshlrev_b32_e64 v230, 4, v230
    v_lshl_add_u32 v230, v232, 3, v230
    v_lshl_add_u32 v230, v229, 7, v230
    v_lshrrev_b32_e64 v229, 1, v229
    v_lshl_add_u32 v232, v231, 1, v229
    v_lshl_add_u32 v232, v232, 5, v230
    v_lshl_add_u32 v3, v228, 12, v232
    v_xor_b32 v4, 32, v3
    v_xor_b32 v5, 64, v3
    v_xor_b32 v6, 96, v3
    v_lshrrev_b32 v228, 5, v1
    v_and_b32 v230, 7, v1
    s_mul_i32 s64, s77, 86016
    s_add_u32 s64, s64, 16777216
    v_bfe_u32 v229, v1, 3, 2
    v_mul_u32_u24 v229, 21504, v229
    v_lshl_add_u32 v229, v228, 7, v229
    v_lshl_add_u32 v0, v230, 4, v229
    s_mul_i32 s76, s75, 7
    s_sub_u32 s76, s56, s76
    s_lshl_b32 s78, s78, 1
    s_lshl_b32 s29, s53, 13
    s_add_u32 s29, s29, 114688
    v_add_u32_e64 v243, s29, v13
    s_lshl_b32 s80, s76, 7
    s_mul_i32 s81, s78, 114688
    s_mul_i32 s28, s53, 28672
    s_add_u32 s81, s81, s28
    s_add_u32 s81, s81, 5242880
    s_lshl_b32 s28, s75, 13
    s_add_u32 s4, s81, s28
    s_add_u32 s28, s28, 4096
    s_cmp_eq_u32 s28, 28672
    s_cselect_b32 s28, 0, s28
    s_add_u32 s5, s81, s28
    s_add_u32 s28, s28, 4096
    s_cmp_eq_u32 s28, 28672
    s_cselect_b32 s28, 0, s28
    s_add_u32 s6, s81, s28
    s_add_u32 s28, s28, 4096
    s_cmp_eq_u32 s28, 28672
    s_cselect_b32 s28, 0, s28
    s_add_u32 s7, s81, s28
    s_add_u32 s28, s28, 4096
    s_cmp_eq_u32 s28, 28672
    s_cselect_b32 s28, 0, s28
    s_waitcnt vmcnt(0)
    s_cmp_eq_u32 s2, 0
    s_cbranch_scc1 L_st_20_g
    buffer_store_dword v241, v8, s[32:35], s25 offen
L_st_20_j:
    s_cmp_lt_u32 s56, 28
    s_cbranch_scc0 L_idle
    ds_read_b64_tr_b16 v[144:145], v3 offset:0
    ds_read_b64_tr_b16 v[146:147], v3 offset:512
    ds_read_b64_tr_b16 v[148:149], v4 offset:0
    ds_read_b64_tr_b16 v[150:151], v4 offset:512
    ds_read_b64_tr_b16 v[152:153], v5 offset:0
    ds_read_b64_tr_b16 v[154:155], v5 offset:512
    ds_read_b64_tr_b16 v[156:157], v6 offset:0
    ds_read_b64_tr_b16 v[158:159], v6 offset:512
    buffer_load_dwordx4 a[100:103], v13, s[32:35], s20 offen offset:1024 sc1
    s_add_u32 s8, s81, s28
    s_add_u32 s28, s28, 4096
    s_cmp_eq_u32 s28, 28672
    s_cselect_b32 s28, 0, s28
    s_add_u32 s9, s81, s28
    s_add_u32 s28, s28, 4096
    s_cmp_eq_u32 s28, 28672
    s_cselect_b32 s28, 0, s28
    buffer_load_dwordx4 a[104:107], v13, s[32:35], s20 offen offset:2048 sc1
    s_add_u32 s10, s81, s28
    s_mul_i32 s14, s77, 114688
    s_xor_b32 s81, s56, 0
    s_lshl_b32 s79, s81, 12
    s_add_u32 s14, s14, s79
    s_add_u32 s14, s14, 5242880
    s_add_u32 s15, s14, 114688
    s_lshl_b32 s79, s81, 2
    buffer_load_dword v9, v7, s[32:35], 0 offen sc1
    buffer_load_dwordx4 a[108:111], v13, s[32:35], s20 offen offset:3072 sc1
    s_add_u32 s11, s11, s79
    s_add_u32 s11, s11, 81920
    s_add_u32 s12, s11, 8192
    s_lshl_b32 s79, s78, 7
    s_mul_i32 s81, s53, 28
    s_add_u32 s79, s79, s81
    s_add_u32 s79, s79, 81920
    v_min_u32 v230, 6, v230
    buffer_load_dwordx4 a[112:115], v13, s[32:35], s21 offen offset:0 sc1
    v_lshl_add_u32 v12, v230, 2, s79
    s_movk_i32 s13, 0x2000
    s_lshl_b32 s81, s53, 5
    s_add_u32 s80, s80, s81
    s_mul_i32 s79, s78, 28672
    s_add_u32 s79, s79, s80
    v_and_b32_e64 v229, 31, v1
    v_mul_u32_u24 v229, 896, v229
    buffer_load_dwordx4 a[116:119], v13, s[32:35], s21 offen offset:1024 sc1
    v_lshl_add_u32 v229, v228, 4, v229
    v_add_u32 v240, s79, v229
    s_lshl_b32 s80, s80, 1
    s_add_u32 s80, s80, 152832
    v_lshl_add_u32 v242, v228, 5, s80
    s_lshl_b32 s79, s76, 2
    s_add_u32 s79, s79, s53
    s_mul_i32 s80, s79, 9363
    buffer_load_dwordx4 a[120:123], v13, s[32:35], s21 offen offset:2048 sc1
    s_lshr_b32 s80, s80, 16
    s_mul_i32 s80, s80, 1792
    s_lshl_b32 s79, s79, 8
    s_add_u32 s79, s79, s80
    s_mul_i32 s80, s78, 86016
    s_add_u32 s79, s79, s80
    s_add_u32 s70, s79, 16779008
    s_add_u32 s71, s79, 16865024
    s_xor_b32 s79, s53, 1
    s_lshl_b32 s79, s79, 13
    s_add_u32 s72, s79, 0
    s_xor_b32 s79, s53, 2
    s_lshl_b32 s79, s79, 13
    s_add_u32 s73, s79, 2048
    s_xor_b32 s79, s53, 3
    s_lshl_b32 s79, s79, 13
    s_add_u32 s74, s79, 4096
    s_mov_b32 s44, s26
    s_mov_b32 s45, s27
    s_mov_b32 s46, 1835008
    s_mov_b32 s47, 0x20000
    s_waitcnt vmcnt(4)
    v_cmp_ne_u32 vcc, s54, v9
    s_cbranch_vccz L_d3_ok
    s_mov_b32 s62, 20000
    buffer_load_dword v9, v7, s[32:35], 0 offen sc1
L_d3_21:
    s_waitcnt vmcnt(0)
    v_cmp_ne_u32 vcc, s54, v9
    s_cbranch_vccz L_d3_21_ok
    s_sub_u32 s62, s62, 1
    s_cbranch_scc1 L_d3_21_ok
    buffer_load_dword v9, v7, s[32:35], 0 offen sc1
    s_branch L_d3_21
L_d3_21_ok:
L_d3_ok:
    buffer_load_dwordx4 v[168:171], v0, s[32:35], s64 offen offset:0 sc1
    buffer_load_dwordx4 v[172:175], v0, s[32:35], s64 offen offset:256 sc1
    buffer_load_dwordx4 v[176:179], v0, s[32:35], s64 offen offset:512 sc1
    buffer_load_dwordx4 v[180:183], v0, s[32:35], s64 offen offset:768 sc1
    buffer_load_dwordx4 v[184:187], v0, s[32:35], s64 offen offset:1024 sc1
    buffer_load_dwordx4 v[188:191], v0, s[32:35], s64 offen offset:1280 sc1
    s_waitcnt vmcnt(5) lgkmcnt(6)
    v_mfma_f32_32x32x16_bf16 v[16:31], v[144:147], v[168:171], 0
    ds_read_b64_tr_b16 v[160:161], v3 offset:1024
    ds_read_b64_tr_b16 v[162:163], v3 offset:1536
    buffer_load_dwordx4 v[192:195], v0, s[32:35], s64 offen offset:1536 sc1
    s_add_u32 s64, s64, 3584
    s_waitcnt lgkmcnt(6)
    v_mfma_f32_32x32x16_bf16 v[32:47], v[148:151], v[168:171], 0
    ds_read_b64_tr_b16 v[164:165], v4 offset:1024
    ds_read_b64_tr_b16 v[166:167], v4 offset:1536
    s_waitcnt lgkmcnt(6)
    v_mfma_f32_32x32x16_bf16 v[48:63], v[152:155], v[168:171], 0
    ds_read_b64_tr_b16 v[144:145], v5 offset:1024
    ds_read_b64_tr_b16 v[146:147], v5 offset:1536
    buffer_load_dwordx4 v[196:199], v0, s[32:35], s64 offen offset:0 sc1
    s_waitcnt lgkmcnt(6)
    v_mfma_f32_32x32x16_bf16 v[64:79], v[156:159], v[168:171], 0
    ds_read_b64_tr_b16 v[148:149], v6 offset:1024
    ds_read_b64_tr_b16 v[150:151], v6 offset:1536
    s_waitcnt vmcnt(6) lgkmcnt(6)
    v_mfma_f32_32x32x16_bf16 v[16:31], v[160:163], v[172:175], v[16:31]
    ds_read_b64_tr_b16 v[152:153], v3 offset:2048
    ds_read_b64_tr_b16 v[154:155], v3 offset:2560
    buffer_load_dwordx4 v[200:203], v0, s[32:35], s64 offen offset:256 sc1
    s_waitcnt lgkmcnt(6)
    v_mfma_f32_32x32x16_bf16 v[32:47], v[164:167], v[172:175], v[32:47]
    ds_read_b64_tr_b16 v[156:157], v4 offset:2048
    ds_read_b64_tr_b16 v[158:159], v4 offset:2560
    s_waitcnt lgkmcnt(6)
    v_mfma_f32_32x32x16_bf16 v[48:63], v[144:147], v[172:175], v[48:63]
    ds_read_b64_tr_b16 v[160:161], v5 offset:2048
    ds_read_b64_tr_b16 v[162:163], v5 offset:2560
    buffer_load_dwordx4 v[204:207], v0, s[32:35], s64 offen offset:512 sc1
    s_waitcnt lgkmcnt(6)
    v_mfma_f32_32x32x16_bf16 v[64:79], v[148:151], v[172:175], v[64:79]
    ds_read_b64_tr_b16 v[164:165], v6 offset:2048
    ds_read_b64_tr_b16 v[166:167], v6 offset:2560
    s_waitcnt vmcnt(7) lgkmcnt(6)
    v_mfma_f32_32x32x16_bf16 v[16:31], v[152:155], v[176:179], v[16:31]
    ds_read_b64_tr_b16 v[144:145], v3 offset:3072
    ds_read_b64_tr_b16 v[146:147], v3 offset:3584
    buffer_load_dwordx4 v[208:211], v0, s[32:35], s64 offen offset:768 sc1
    s_waitcnt lgkmcnt(6)
    v_mfma_f32_32x32x16_bf16 v[32:47], v[156:159], v[176:179], v[32:47]
    ds_read_b64_tr_b16 v[148:149], v4 offset:3072
    ds_read_b64_tr_b16 v[150:151], v4 offset:3584
    s_waitcnt lgkmcnt(6)
    v_mfma_f32_32x32x16_bf16 v[48:63], v[160:163], v[176:179], v[48:63]
    ds_read_b64_tr_b16 v[152:153], v5 offset:3072
    ds_read_b64_tr_b16 v[154:155], v5 offset:3584
    s_waitcnt lgkmcnt(6)
    v_mfma_f32_32x32x16_bf16 v[64:79], v[164:167], v[176:179], v[64:79]
    ds_read_b64_tr_b16 v[156:157], v6 offset:3072
    ds_read_b64_tr_b16 v[158:159], v6 offset:3584
    buffer_load_dwordx4 v[212:215], v0, s[32:35], s64 offen offset:1024 sc1
    s_waitcnt vmcnt(8) lgkmcnt(6)
    v_mfma_f32_32x32x16_bf16 v[16:31], v[144:147], v[180:183], v[16:31]
    ds_read_b64_tr_b16 v[160:161], v3 offset:16384
    ds_read_b64_tr_b16 v[162:163], v3 offset:16896
    s_waitcnt lgkmcnt(6)
    v_mfma_f32_32x32x16_bf16 v[32:47], v[148:151], v[180:183], v[32:47]
    ds_read_b64_tr_b16 v[164:165], v4 offset:16384
    ds_read_b64_tr_b16 v[166:167], v4 offset:16896
    buffer_load_dwordx4 v[216:219], v0, s[32:35], s64 offen offset:1280 sc1
    s_waitcnt lgkmcnt(6)
    v_mfma_f32_32x32x16_bf16 v[48:63], v[152:155], v[180:183], v[48:63]
    ds_read_b64_tr_b16 v[144:145], v5 offset:16384
    ds_read_b64_tr_b16 v[146:147], v5 offset:16896
    s_waitcnt lgkmcnt(6)
    v_mfma_f32_32x32x16_bf16 v[64:79], v[156:159], v[180:183], v[64:79]
    ds_read_b64_tr_b16 v[148:149], v6 offset:16384
    ds_read_b64_tr_b16 v[150:151], v6 offset:16896
    buffer_load_dwordx4 v[220:223], v0, s[32:35], s64 offen offset:1536 sc1
    s_add_u32 s64, s64, 3584
    s_waitcnt vmcnt(9) lgkmcnt(6)
    v_mfma_f32_32x32x16_bf16 v[16:31], v[160:163], v[184:187], v[16:31]
    ds_read_b64_tr_b16 v[152:153], v3 offset:17408
    ds_read_b64_tr_b16 v[154:155], v3 offset:17920
    s_waitcnt lgkmcnt(6)
    v_mfma_f32_32x32x16_bf16 v[32:47], v[164:167], v[184:187], v[32:47]
    ds_read_b64_tr_b16 v[156:157], v4 offset:17408
    ds_read_b64_tr_b16 v[158:159], v4 offset:17920
    buffer_load_dwordx4 v[224:227], v0, s[32:35], s64 offen offset:0 sc1
    s_waitcnt lgkmcnt(6)
    v_mfma_f32_32x32x16_bf16 v[48:63], v[144:147], v[184:187], v[48:63]
    ds_read_b64_tr_b16 v[160:161], v5 offset:17408
    ds_read_b64_tr_b16 v[162:163], v5 offset:17920
    s_waitcnt lgkmcnt(6)
    v_mfma_f32_32x32x16_bf16 v[64:79], v[148:151], v[184:187], v[64:79]
    ds_read_b64_tr_b16 v[164:165], v6 offset:17408
    ds_read_b64_tr_b16 v[166:167], v6 offset:17920
    buffer_load_dwordx4 v[228:231], v0, s[32:35], s64 offen offset:256 sc1
    s_waitcnt vmcnt(10) lgkmcnt(6)
    v_mfma_f32_32x32x16_bf16 v[16:31], v[152:155], v[188:191], v[16:31]
    ds_read_b64_tr_b16 v[144:145], v3 offset:18432
    ds_read_b64_tr_b16 v[146:147], v3 offset:18944
    s_waitcnt lgkmcnt(6)
    v_mfma_f32_32x32x16_bf16 v[32:47], v[156:159], v[188:191], v[32:47]
    ds_read_b64_tr_b16 v[148:149], v4 offset:18432
    ds_read_b64_tr_b16 v[150:151], v4 offset:18944
    s_waitcnt lgkmcnt(6)
    v_mfma_f32_32x32x16_bf16 v[48:63], v[160:163], v[188:191], v[48:63]
    ds_read_b64_tr_b16 v[152:153], v5 offset:18432
    ds_read_b64_tr_b16 v[154:155], v5 offset:18944
    buffer_load_dwordx4 v[232:235], v0, s[32:35], s64 offen offset:512 sc1
    s_waitcnt lgkmcnt(6)
    v_mfma_f32_32x32x16_bf16 v[64:79], v[164:167], v[188:191], v[64:79]
    ds_read_b64_tr_b16 v[156:157], v6 offset:18432
    ds_read_b64_tr_b16 v[158:159], v6 offset:18944
    s_waitcnt vmcnt(10) lgkmcnt(6)
    v_mfma_f32_32x32x16_bf16 v[16:31], v[144:147], v[192:195], v[16:31]
    ds_read_b64_tr_b16 v[160:161], v3 offset:19456
    ds_read_b64_tr_b16 v[162:163], v3 offset:19968
    buffer_load_dwordx4 v[236:239], v0, s[32:35], s64 offen offset:768 sc1
    s_waitcnt lgkmcnt(6)
    v_mfma_f32_32x32x16_bf16 v[32:47], v[148:151], v[192:195], v[32:47]
    ds_read_b64_tr_b16 v[164:165], v4 offset:19456
    ds_read_b64_tr_b16 v[166:167], v4 offset:19968
    s_waitcnt lgkmcnt(6)
    v_mfma_f32_32x32x16_bf16 v[48:63], v[152:155], v[192:195], v[48:63]
    ds_read_b64_tr_b16 v[144:145], v5 offset:19456
    ds_read_b64_tr_b16 v[146:147], v5 offset:19968
    buffer_load_dwordx4 a[224:227], v0, s[32:35], s64 offen offset:1024 sc1
    s_waitcnt lgkmcnt(6)
    v_mfma_f32_32x32x16_bf16 v[64:79], v[156:159], v[192:195], v[64:79]
    ds_read_b64_tr_b16 v[148:149], v6 offset:19456
    ds_read_b64_tr_b16 v[150:151], v6 offset:19968
    s_waitcnt vmcnt(11) lgkmcnt(6)
    v_mfma_f32_32x32x16_bf16 v[16:31], v[160:163], v[196:199], v[16:31]
    ds_read_b64_tr_b16 v[152:153], v3 offset:32768
    ds_read_b64_tr_b16 v[154:155], v3 offset:33280
    buffer_load_dwordx4 a[228:231], v0, s[32:35], s64 offen offset:1280 sc1
    s_waitcnt lgkmcnt(6)
    v_mfma_f32_32x32x16_bf16 v[32:47], v[164:167], v[196:199], v[32:47]
    ds_read_b64_tr_b16 v[156:157], v4 offset:32768
    ds_read_b64_tr_b16 v[158:159], v4 offset:33280
    s_waitcnt lgkmcnt(6)
    v_mfma_f32_32x32x16_bf16 v[48:63], v[144:147], v[196:199], v[48:63]
    ds_read_b64_tr_b16 v[160:161], v5 offset:32768
    ds_read_b64_tr_b16 v[162:163], v5 offset:33280
    buffer_load_dwordx4 a[232:235], v0, s[32:35], s64 offen offset:1536 sc1
    s_add_u32 s64, s64, 3584
    s_waitcnt lgkmcnt(6)
    v_mfma_f32_32x32x16_bf16 v[64:79], v[148:151], v[196:199], v[64:79]
    ds_read_b64_tr_b16 v[164:165], v6 offset:32768
    ds_read_b64_tr_b16 v[166:167], v6 offset:33280
    s_waitcnt vmcnt(12) lgkmcnt(6)
    v_mfma_f32_32x32x16_bf16 v[16:31], v[152:155], v[200:203], v[16:31]
    ds_read_b64_tr_b16 v[144:145], v3 offset:33792
    ds_read_b64_tr_b16 v[146:147], v3 offset:34304
    s_waitcnt lgkmcnt(6)
    v_mfma_f32_32x32x16_bf16 v[32:47], v[156:159], v[200:203], v[32:47]
    ds_read_b64_tr_b16 v[148:149], v4 offset:33792
    ds_read_b64_tr_b16 v[150:151], v4 offset:34304
    buffer_load_dwordx4 a[236:239], v0, s[32:35], s64 offen offset:0 sc1
    s_waitcnt lgkmcnt(6)
    v_mfma_f32_32x32x16_bf16 v[48:63], v[160:163], v[200:203], v[48:63]
    ds_read_b64_tr_b16 v[152:153], v5 offset:33792
    ds_read_b64_tr_b16 v[154:155], v5 offset:34304
    s_waitcnt lgkmcnt(6)
    v_mfma_f32_32x32x16_bf16 v[64:79], v[164:167], v[200:203], v[64:79]
    ds_read_b64_tr_b16 v[156:157], v6 offset:33792
    ds_read_b64_tr_b16 v[158:159], v6 offset:34304
    buffer_load_dwordx4 a[240:243], v0, s[32:35], s64 offen offset:256 sc1
    s_waitcnt vmcnt(13) lgkmcnt(6)
    v_mfma_f32_32x32x16_bf16 v[16:31], v[144:147], v[204:207], v[16:31]
    ds_read_b64_tr_b16 v[160:161], v3 offset:34816
    ds_read_b64_tr_b16 v[162:163], v3 offset:35328
    s_waitcnt lgkmcnt(6)
    v_mfma_f32_32x32x16_bf16 v[32:47], v[148:151], v[204:207], v[32:47]
    ds_read_b64_tr_b16 v[164:165], v4 offset:34816
    ds_read_b64_tr_b16 v[166:167], v4 offset:35328
    buffer_load_dwordx4 a[244:247], v0, s[32:35], s64 offen offset:512 sc1
    s_waitcnt lgkmcnt(6)
    v_mfma_f32_32x32x16_bf16 v[48:63], v[152:155], v[204:207], v[48:63]
    ds_read_b64_tr_b16 v[144:145], v5 offset:34816
    ds_read_b64_tr_b16 v[146:147], v5 offset:35328
    s_waitcnt lgkmcnt(6)
    v_mfma_f32_32x32x16_bf16 v[64:79], v[156:159], v[204:207], v[64:79]
    ds_read_b64_tr_b16 v[148:149], v6 offset:34816
    ds_read_b64_tr_b16 v[150:151], v6 offset:35328
    buffer_load_dwordx4 a[248:251], v0, s[32:35], s64 offen offset:768 sc1
    s_waitcnt vmcnt(14) lgkmcnt(6)
    v_mfma_f32_32x32x16_bf16 v[16:31], v[160:163], v[208:211], v[16:31]
    ds_read_b64_tr_b16 v[152:153], v3 offset:35840
    ds_read_b64_tr_b16 v[154:155], v3 offset:36352
    s_waitcnt lgkmcnt(6)
    v_mfma_f32_32x32x16_bf16 v[32:47], v[164:167], v[208:211], v[32:47]
    ds_read_b64_tr_b16 v[156:157], v4 offset:35840
    ds_read_b64_tr_b16 v[158:159], v4 offset:36352
    buffer_load_dwordx4 a[252:255], v0, s[32:35], s64 offen offset:1024 sc1
    s_waitcnt lgkmcnt(6)
    v_mfma_f32_32x32x16_bf16 v[48:63], v[144:147], v[208:211], v[48:63]
    ds_read_b64_tr_b16 v[160:161], v5 offset:35840
    ds_read_b64_tr_b16 v[162:163], v5 offset:36352
    s_waitcnt lgkmcnt(6)
    v_mfma_f32_32x32x16_bf16 v[64:79], v[148:151], v[208:211], v[64:79]
    ds_read_b64_tr_b16 v[164:165], v6 offset:35840
    ds_read_b64_tr_b16 v[166:167], v6 offset:36352
    s_waitcnt vmcnt(14) lgkmcnt(6)
    v_mfma_f32_32x32x16_bf16 v[16:31], v[152:155], v[212:215], v[16:31]
    ds_read_b64_tr_b16 v[144:145], v3 offset:49152
    ds_read_b64_tr_b16 v[146:147], v3 offset:49664
    buffer_load_dwordx4 v[244:247], v0, s[32:35], s64 offen offset:1280 sc1
    s_waitcnt lgkmcnt(6)
    v_mfma_f32_32x32x16_bf16 v[32:47], v[156:159], v[212:215], v[32:47]
    ds_read_b64_tr_b16 v[148:149], v4 offset:49152
    ds_read_b64_tr_b16 v[150:151], v4 offset:49664
    s_waitcnt lgkmcnt(6)
    v_mfma_f32_32x32x16_bf16 v[48:63], v[160:163], v[212:215], v[48:63]
    ds_read_b64_tr_b16 v[152:153], v5 offset:49152
    ds_read_b64_tr_b16 v[154:155], v5 offset:49664
    buffer_load_dwordx4 v[248:251], v0, s[32:35], s64 offen offset:1536 sc1
    s_add_u32 s64, s64, 75264
    s_waitcnt lgkmcnt(6)
    v_mfma_f32_32x32x16_bf16 v[64:79], v[164:167], v[212:215], v[64:79]
    ds_read_b64_tr_b16 v[156:157], v6 offset:49152
    ds_read_b64_tr_b16 v[158:159], v6 offset:49664
    s_waitcnt vmcnt(15) lgkmcnt(6)
    v_mfma_f32_32x32x16_bf16 v[16:31], v[144:147], v[216:219], v[16:31]
    ds_read_b64_tr_b16 v[160:161], v3 offset:50176
    ds_read_b64_tr_b16 v[162:163], v3 offset:50688
    buffer_load_dwordx4 v[168:171], v0, s[32:35], s64 offen offset:0 sc1
    s_waitcnt lgkmcnt(6)
    v_mfma_f32_32x32x16_bf16 v[32:47], v[148:151], v[216:219], v[32:47]
    ds_read_b64_tr_b16 v[164:165], v4 offset:50176
    ds_read_b64_tr_b16 v[166:167], v4 offset:50688
    s_waitcnt lgkmcnt(6)
    v_mfma_f32_32x32x16_bf16 v[48:63], v[152:155], v[216:219], v[48:63]
    ds_read_b64_tr_b16 v[144:145], v5 offset:50176
    ds_read_b64_tr_b16 v[146:147], v5 offset:50688
    buffer_load_dwordx4 v[172:175], v0, s[32:35], s64 offen offset:256 sc1
    s_waitcnt lgkmcnt(6)
    v_mfma_f32_32x32x16_bf16 v[64:79], v[156:159], v[216:219], v[64:79]
    ds_read_b64_tr_b16 v[148:149], v6 offset:50176
    ds_read_b64_tr_b16 v[150:151], v6 offset:50688
    s_waitcnt vmcnt(16) lgkmcnt(6)
    v_mfma_f32_32x32x16_bf16 v[16:31], v[160:163], v[220:223], v[16:31]
    ds_read_b64_tr_b16 v[152:153], v3 offset:51200
    ds_read_b64_tr_b16 v[154:155], v3 offset:51712
    buffer_load_dwordx4 v[176:179], v0, s[32:35], s64 offen offset:512 sc1
    s_waitcnt lgkmcnt(6)
    v_mfma_f32_32x32x16_bf16 v[32:47], v[164:167], v[220:223], v[32:47]
    ds_read_b64_tr_b16 v[156:157], v4 offset:51200
    ds_read_b64_tr_b16 v[158:159], v4 offset:51712
    s_waitcnt lgkmcnt(6)
    v_mfma_f32_32x32x16_bf16 v[48:63], v[144:147], v[220:223], v[48:63]
    ds_read_b64_tr_b16 v[160:161], v5 offset:51200
    ds_read_b64_tr_b16 v[162:163], v5 offset:51712
    s_waitcnt lgkmcnt(6)
    v_mfma_f32_32x32x16_bf16 v[64:79], v[148:151], v[220:223], v[64:79]
    ds_read_b64_tr_b16 v[164:165], v6 offset:51200
    ds_read_b64_tr_b16 v[166:167], v6 offset:51712
    buffer_load_dwordx4 v[180:183], v0, s[32:35], s64 offen offset:768 sc1
    s_waitcnt vmcnt(17) lgkmcnt(6)
    v_mfma_f32_32x32x16_bf16 v[16:31], v[152:155], v[224:227], v[16:31]
    ds_read_b64_tr_b16 v[144:145], v3 offset:52224
    ds_read_b64_tr_b16 v[146:147], v3 offset:52736
    s_waitcnt lgkmcnt(6)
    v_mfma_f32_32x32x16_bf16 v[32:47], v[156:159], v[224:227], v[32:47]
    ds_read_b64_tr_b16 v[148:149], v4 offset:52224
    ds_read_b64_tr_b16 v[150:151], v4 offset:52736
    buffer_load_dwordx4 v[184:187], v0, s[32:35], s64 offen offset:1024 sc1
    s_waitcnt lgkmcnt(6)
    v_mfma_f32_32x32x16_bf16 v[48:63], v[160:163], v[224:227], v[48:63]
    ds_read_b64_tr_b16 v[152:153], v5 offset:52224
    ds_read_b64_tr_b16 v[154:155], v5 offset:52736
    s_waitcnt lgkmcnt(6)
    v_mfma_f32_32x32x16_bf16 v[64:79], v[164:167], v[224:227], v[64:79]
    ds_read_b64_tr_b16 v[156:157], v6 offset:52224
    ds_read_b64_tr_b16 v[158:159], v6 offset:52736
    buffer_load_dwordx4 v[188:191], v0, s[32:35], s64 offen offset:1280 sc1
    s_waitcnt vmcnt(18) lgkmcnt(6)
    v_mfma_f32_32x32x16_bf16 v[16:31], v[144:147], v[228:231], v[16:31]
    v_add_u32 v3, 0x10000, v3
    ds_read_b64_tr_b16 v[160:161], v3 offset:0
    ds_read_b64_tr_b16 v[162:163], v3 offset:512
    s_waitcnt lgkmcnt(6)
    v_mfma_f32_32x32x16_bf16 v[32:47], v[148:151], v[228:231], v[32:47]
    v_add_u32 v4, 0x10000, v4
    ds_read_b64_tr_b16 v[164:165], v4 offset:0
    ds_read_b64_tr_b16 v[166:167], v4 offset:512
    buffer_load_dwordx4 v[192:195], v0, s[32:35], s64 offen offset:1536 sc1
    s_add_u32 s64, s64, 3584
    s_waitcnt lgkmcnt(6)
    v_mfma_f32_32x32x16_bf16 v[48:63], v[152:155], v[228:231], v[48:63]
    v_add_u32 v5, 0x10000, v5
    ds_read_b64_tr_b16 v[144:145], v5 offset:0
    ds_read_b64_tr_b16 v[146:147], v5 offset:512
    s_waitcnt lgkmcnt(6)
    v_mfma_f32_32x32x16_bf16 v[64:79], v[156:159], v[228:231], v[64:79]
    v_add_u32 v6, 0x10000, v6
    ds_read_b64_tr_b16 v[148:149], v6 offset:0
    ds_read_b64_tr_b16 v[150:151], v6 offset:512
    buffer_load_dwordx4 v[196:199], v0, s[32:35], s64 offen offset:0 sc1
    s_waitcnt vmcnt(19) lgkmcnt(6)
    v_mfma_f32_32x32x16_bf16 v[16:31], v[160:163], v[232:235], v[16:31]
    ds_read_b64_tr_b16 v[152:153], v3 offset:1024
    ds_read_b64_tr_b16 v[154:155], v3 offset:1536
    s_waitcnt lgkmcnt(6)
    v_mfma_f32_32x32x16_bf16 v[32:47], v[164:167], v[232:235], v[32:47]
    ds_read_b64_tr_b16 v[156:157], v4 offset:1024
    ds_read_b64_tr_b16 v[158:159], v4 offset:1536
    s_waitcnt lgkmcnt(6)
    v_mfma_f32_32x32x16_bf16 v[48:63], v[144:147], v[232:235], v[48:63]
    ds_read_b64_tr_b16 v[160:161], v5 offset:1024
    ds_read_b64_tr_b16 v[162:163], v5 offset:1536
    buffer_load_dwordx4 v[200:203], v0, s[32:35], s64 offen offset:256 sc1
    s_waitcnt lgkmcnt(6)
    v_mfma_f32_32x32x16_bf16 v[64:79], v[148:151], v[232:235], v[64:79]
    ds_read_b64_tr_b16 v[164:165], v6 offset:1024
    ds_read_b64_tr_b16 v[166:167], v6 offset:1536
    s_waitcnt vmcnt(19) lgkmcnt(6)
    v_mfma_f32_32x32x16_bf16 v[16:31], v[152:155], v[236:239], v[16:31]
    ds_read_b64_tr_b16 v[144:145], v3 offset:2048
    ds_read_b64_tr_b16 v[146:147], v3 offset:2560
    buffer_load_dwordx4 v[204:207], v0, s[32:35], s64 offen offset:512 sc1
    s_waitcnt lgkmcnt(6)
    v_mfma_f32_32x32x16_bf16 v[32:47], v[156:159], v[236:239], v[32:47]
    ds_read_b64_tr_b16 v[148:149], v4 offset:2048
    ds_read_b64_tr_b16 v[150:151], v4 offset:2560
    s_waitcnt lgkmcnt(6)
    v_mfma_f32_32x32x16_bf16 v[48:63], v[160:163], v[236:239], v[48:63]
    ds_read_b64_tr_b16 v[152:153], v5 offset:2048
    ds_read_b64_tr_b16 v[154:155], v5 offset:2560
    buffer_load_dwordx4 v[208:211], v0, s[32:35], s64 offen offset:768 sc1
    s_waitcnt lgkmcnt(6)
    v_mfma_f32_32x32x16_bf16 v[64:79], v[164:167], v[236:239], v[64:79]
    ds_read_b64_tr_b16 v[156:157], v6 offset:2048
    ds_read_b64_tr_b16 v[158:159], v6 offset:2560
    s_waitcnt vmcnt(20) lgkmcnt(6)
    v_mfma_f32_32x32x16_bf16 v[16:31], v[144:147], a[224:227], v[16:31]
    ds_read_b64_tr_b16 v[160:161], v3 offset:3072
    ds_read_b64_tr_b16 v[162:163], v3 offset:3584
    buffer_load_dwordx4 v[212:215], v0, s[32:35], s64 offen offset:1024 sc1
    s_waitcnt lgkmcnt(6)
    v_mfma_f32_32x32x16_bf16 v[32:47], v[148:151], a[224:227], v[32:47]
    ds_read_b64_tr_b16 v[164:165], v4 offset:3072
    ds_read_b64_tr_b16 v[166:167], v4 offset:3584
    s_waitcnt lgkmcnt(6)
    v_mfma_f32_32x32x16_bf16 v[48:63], v[152:155], a[224:227], v[48:63]
    ds_read_b64_tr_b16 v[144:145], v5 offset:3072
    ds_read_b64_tr_b16 v[146:147], v5 offset:3584
    buffer_load_dwordx4 v[216:219], v0, s[32:35], s64 offen offset:1280 sc1
    s_waitcnt lgkmcnt(6)
    v_mfma_f32_32x32x16_bf16 v[64:79], v[156:159], a[224:227], v[64:79]
    ds_read_b64_tr_b16 v[148:149], v6 offset:3072
    ds_read_b64_tr_b16 v[150:151], v6 offset:3584
    s_waitcnt vmcnt(21) lgkmcnt(6)
    v_mfma_f32_32x32x16_bf16 v[16:31], v[160:163], a[228:231], v[16:31]
    ds_read_b64_tr_b16 v[152:153], v3 offset:16384
    ds_read_b64_tr_b16 v[154:155], v3 offset:16896
    s_waitcnt lgkmcnt(6)
    v_mfma_f32_32x32x16_bf16 v[32:47], v[164:167], a[228:231], v[32:47]
    ds_read_b64_tr_b16 v[156:157], v4 offset:16384
    ds_read_b64_tr_b16 v[158:159], v4 offset:16896
    buffer_load_dwordx4 v[220:223], v0, s[32:35], s64 offen offset:1536 sc1
    s_add_u32 s64, s64, 3584
    s_waitcnt lgkmcnt(6)
    v_mfma_f32_32x32x16_bf16 v[48:63], v[144:147], a[228:231], v[48:63]
    ds_read_b64_tr_b16 v[160:161], v5 offset:16384
    ds_read_b64_tr_b16 v[162:163], v5 offset:16896
    s_waitcnt lgkmcnt(6)
    v_mfma_f32_32x32x16_bf16 v[64:79], v[148:151], a[228:231], v[64:79]
    ds_read_b64_tr_b16 v[164:165], v6 offset:16384
    ds_read_b64_tr_b16 v[166:167], v6 offset:16896
    buffer_load_dwordx4 v[224:227], v0, s[32:35], s64 offen offset:0 sc1
    s_waitcnt vmcnt(22) lgkmcnt(6)
    v_mfma_f32_32x32x16_bf16 v[16:31], v[152:155], a[232:235], v[16:31]
    ds_read_b64_tr_b16 v[144:145], v3 offset:17408
    ds_read_b64_tr_b16 v[146:147], v3 offset:17920
    s_waitcnt lgkmcnt(6)
    v_mfma_f32_32x32x16_bf16 v[32:47], v[156:159], a[232:235], v[32:47]
    ds_read_b64_tr_b16 v[148:149], v4 offset:17408
    ds_read_b64_tr_b16 v[150:151], v4 offset:17920
    buffer_load_dwordx4 v[228:231], v0, s[32:35], s64 offen offset:256 sc1
    s_waitcnt lgkmcnt(6)
    v_mfma_f32_32x32x16_bf16 v[48:63], v[160:163], a[232:235], v[48:63]
    ds_read_b64_tr_b16 v[152:153], v5 offset:17408
    ds_read_b64_tr_b16 v[154:155], v5 offset:17920
    s_waitcnt lgkmcnt(6)
    v_mfma_f32_32x32x16_bf16 v[64:79], v[164:167], a[232:235], v[64:79]
    ds_read_b64_tr_b16 v[156:157], v6 offset:17408
    ds_read_b64_tr_b16 v[158:159], v6 offset:17920
    buffer_load_dwordx4 v[232:235], v0, s[32:35], s64 offen offset:512 sc1
    s_waitcnt vmcnt(23) lgkmcnt(6)
    v_mfma_f32_32x32x16_bf16 v[16:31], v[144:147], a[236:239], v[16:31]
    ds_read_b64_tr_b16 v[160:161], v3 offset:18432
    ds_read_b64_tr_b16 v[162:163], v3 offset:18944
    s_waitcnt lgkmcnt(6)
    v_mfma_f32_32x32x16_bf16 v[32:47], v[148:151], a[236:239], v[32:47]
    ds_read_b64_tr_b16 v[164:165], v4 offset:18432
    ds_read_b64_tr_b16 v[166:167], v4 offset:18944
    buffer_load_dwordx4 v[236:239], v0, s[32:35], s64 offen offset:768 sc1
    s_waitcnt lgkmcnt(6)
    v_mfma_f32_32x32x16_bf16 v[48:63], v[152:155], a[236:239], v[48:63]
    ds_read_b64_tr_b16 v[144:145], v5 offset:18432
    ds_read_b64_tr_b16 v[146:147], v5 offset:18944
    s_waitcnt lgkmcnt(6)
    v_mfma_f32_32x32x16_bf16 v[64:79], v[156:159], a[236:239], v[64:79]
    ds_read_b64_tr_b16 v[148:149], v6 offset:18432
    ds_read_b64_tr_b16 v[150:151], v6 offset:18944
    s_waitcnt vmcnt(23) lgkmcnt(6)
    v_mfma_f32_32x32x16_bf16 v[16:31], v[160:163], a[240:243], v[16:31]
    ds_read_b64_tr_b16 v[152:153], v3 offset:19456
    ds_read_b64_tr_b16 v[154:155], v3 offset:19968
    buffer_load_dwordx4 a[224:227], v0, s[32:35], s64 offen offset:1024 sc1
    s_waitcnt lgkmcnt(6)
    v_mfma_f32_32x32x16_bf16 v[32:47], v[164:167], a[240:243], v[32:47]
    ds_read_b64_tr_b16 v[156:157], v4 offset:19456
    ds_read_b64_tr_b16 v[158:159], v4 offset:19968
    s_waitcnt lgkmcnt(6)
    v_mfma_f32_32x32x16_bf16 v[48:63], v[144:147], a[240:243], v[48:63]
    ds_read_b64_tr_b16 v[160:161], v5 offset:19456
    ds_read_b64_tr_b16 v[162:163], v5 offset:19968
    buffer_load_dwordx4 a[228:231], v0, s[32:35], s64 offen offset:1280 sc1
    s_waitcnt lgkmcnt(6)
    v_mfma_f32_32x32x16_bf16 v[64:79], v[148:151], a[240:243], v[64:79]
    ds_read_b64_tr_b16 v[164:165], v6 offset:19456
    ds_read_b64_tr_b16 v[166:167], v6 offset:19968
    s_waitcnt vmcnt(24) lgkmcnt(6)
    v_mfma_f32_32x32x16_bf16 v[16:31], v[152:155], a[244:247], v[16:31]
    ds_read_b64_tr_b16 v[144:145], v3 offset:32768
    ds_read_b64_tr_b16 v[146:147], v3 offset:33280
    buffer_load_dwordx4 a[232:235], v0, s[32:35], s64 offen offset:1536 sc1
    s_add_u32 s64, s64, 3584
    s_waitcnt lgkmcnt(6)
    v_mfma_f32_32x32x16_bf16 v[32:47], v[156:159], a[244:247], v[32:47]
    ds_read_b64_tr_b16 v[148:149], v4 offset:32768
    ds_read_b64_tr_b16 v[150:151], v4 offset:33280
    s_waitcnt lgkmcnt(6)
    v_mfma_f32_32x32x16_bf16 v[48:63], v[160:163], a[244:247], v[48:63]
    ds_read_b64_tr_b16 v[152:153], v5 offset:32768
    ds_read_b64_tr_b16 v[154:155], v5 offset:33280
    buffer_load_dwordx4 a[236:239], v0, s[32:35], s64 offen offset:0 sc1
    s_waitcnt lgkmcnt(6)
    v_mfma_f32_32x32x16_bf16 v[64:79], v[164:167], a[244:247], v[64:79]
    ds_read_b64_tr_b16 v[156:157], v6 offset:32768
    ds_read_b64_tr_b16 v[158:159], v6 offset:33280
    s_waitcnt vmcnt(25) lgkmcnt(6)
    v_mfma_f32_32x32x16_bf16 v[16:31], v[144:147], a[248:251], v[16:31]
    ds_read_b64_tr_b16 v[160:161], v3 offset:33792
    ds_read_b64_tr_b16 v[162:163], v3 offset:34304
    buffer_load_dwordx4 a[240:243], v0, s[32:35], s64 offen offset:256 sc1
    s_waitcnt lgkmcnt(6)
    v_mfma_f32_32x32x16_bf16 v[32:47], v[148:151], a[248:251], v[32:47]
    ds_read_b64_tr_b16 v[164:165], v4 offset:33792
    ds_read_b64_tr_b16 v[166:167], v4 offset:34304
    s_waitcnt lgkmcnt(6)
    v_mfma_f32_32x32x16_bf16 v[48:63], v[152:155], a[248:251], v[48:63]
    ds_read_b64_tr_b16 v[144:145], v5 offset:33792
    ds_read_b64_tr_b16 v[146:147], v5 offset:34304
    s_waitcnt lgkmcnt(6)
    v_mfma_f32_32x32x16_bf16 v[64:79], v[156:159], a[248:251], v[64:79]
    ds_read_b64_tr_b16 v[148:149], v6 offset:33792
    ds_read_b64_tr_b16 v[150:151], v6 offset:34304
    buffer_load_dwordx4 a[244:247], v0, s[32:35], s64 offen offset:512 sc1
    s_waitcnt vmcnt(26) lgkmcnt(6)
    v_mfma_f32_32x32x16_bf16 v[16:31], v[160:163], a[252:255], v[16:31]
    ds_read_b64_tr_b16 v[152:153], v3 offset:34816
    ds_read_b64_tr_b16 v[154:155], v3 offset:35328
    s_waitcnt lgkmcnt(6)
    v_mfma_f32_32x32x16_bf16 v[32:47], v[164:167], a[252:255], v[32:47]
    ds_read_b64_tr_b16 v[156:157], v4 offset:34816
    ds_read_b64_tr_b16 v[158:159], v4 offset:35328
    buffer_load_dwordx4 a[248:251], v0, s[32:35], s64 offen offset:768 sc1
    s_waitcnt lgkmcnt(6)
    v_mfma_f32_32x32x16_bf16 v[48:63], v[144:147], a[252:255], v[48:63]
    ds_read_b64_tr_b16 v[160:161], v5 offset:34816
    ds_read_b64_tr_b16 v[162:163], v5 offset:35328
    s_waitcnt lgkmcnt(6)
    v_mfma_f32_32x32x16_bf16 v[64:79], v[148:151], a[252:255], v[64:79]
    ds_read_b64_tr_b16 v[164:165], v6 offset:34816
    ds_read_b64_tr_b16 v[166:167], v6 offset:35328
    buffer_load_dwordx4 a[124:127], v13, s[32:35], s21 offen offset:3072 sc1
    s_waitcnt vmcnt(27) lgkmcnt(6)
    v_mfma_f32_32x32x16_bf16 v[16:31], v[152:155], v[244:247], v[16:31]
    ds_read_b64_tr_b16 v[144:145], v3 offset:35840
    ds_read_b64_tr_b16 v[146:147], v3 offset:36352
    s_waitcnt lgkmcnt(6)
    v_mfma_f32_32x32x16_bf16 v[32:47], v[156:159], v[244:247], v[32:47]
    ds_read_b64_tr_b16 v[148:149], v4 offset:35840
    ds_read_b64_tr_b16 v[150:151], v4 offset:36352
    buffer_load_dwordx4 a[252:255], v0, s[32:35], s64 offen offset:1024 sc1
    s_waitcnt lgkmcnt(6)
    v_mfma_f32_32x32x16_bf16 v[48:63], v[160:163], v[244:247], v[48:63]
    ds_read_b64_tr_b16 v[152:153], v5 offset:35840
    ds_read_b64_tr_b16 v[154:155], v5 offset:36352
    s_waitcnt lgkmcnt(6)
    v_mfma_f32_32x32x16_bf16 v[64:79], v[164:167], v[244:247], v[64:79]
    ds_read_b64_tr_b16 v[156:157], v6 offset:35840
    ds_read_b64_tr_b16 v[158:159], v6 offset:36352
    buffer_load_dwordx4 a[128:131], v13, s[32:35], s22 offen offset:0 sc1
    s_waitcnt vmcnt(28) lgkmcnt(6)
    v_mfma_f32_32x32x16_bf16 v[16:31], v[144:147], v[248:251], v[16:31]
    v_subrev_u32 v3, 0x10000, v3
    ds_read_b64_tr_b16 v[160:161], v3 offset:0
    ds_read_b64_tr_b16 v[162:163], v3 offset:512
    s_waitcnt lgkmcnt(6)
    v_mfma_f32_32x32x16_bf16 v[32:47], v[148:151], v[248:251], v[32:47]
    v_subrev_u32 v4, 0x10000, v4
    ds_read_b64_tr_b16 v[164:165], v4 offset:0
    ds_read_b64_tr_b16 v[166:167], v4 offset:512
    s_waitcnt lgkmcnt(6)
    v_mfma_f32_32x32x16_bf16 v[48:63], v[152:155], v[248:251], v[48:63]
    ds_read_b64_tr_b16 v[144:145], v3 offset:1024
    ds_read_b64_tr_b16 v[146:147], v3 offset:1536
    buffer_load_dwordx4 v[244:247], v0, s[32:35], s64 offen offset:1280 sc1
    s_waitcnt lgkmcnt(6)
    v_mfma_f32_32x32x16_bf16 v[64:79], v[156:159], v[248:251], v[64:79]
    ds_read_b64_tr_b16 v[148:149], v4 offset:1024
    ds_read_b64_tr_b16 v[150:151], v4 offset:1536
    s_waitcnt vmcnt(28) lgkmcnt(6)
    v_mfma_f32_32x32x16_bf16 v[80:95], v[160:163], v[168:171], 0
    ds_read_b64_tr_b16 v[152:153], v3 offset:2048
    ds_read_b64_tr_b16 v[154:155], v3 offset:2560
    buffer_load_dwordx4 v[248:251], v0, s[32:35], s64 offen offset:1536 sc1
    s_add_u32 s64, s64, 75264
    s_waitcnt lgkmcnt(6)
    v_mfma_f32_32x32x16_bf16 v[96:111], v[164:167], v[168:171], 0
    ds_read_b64_tr_b16 v[156:157], v4 offset:2048
    ds_read_b64_tr_b16 v[158:159], v4 offset:2560
    s_waitcnt vmcnt(28) lgkmcnt(6)
    v_mfma_f32_32x32x16_bf16 v[80:95], v[144:147], v[172:175], v[80:95]
    ds_read_b64_tr_b16 v[160:161], v3 offset:3072
    ds_read_b64_tr_b16 v[162:163], v3 offset:3584
    buffer_load_dwordx4 a[132:135], v13, s[32:35], s22 offen offset:1024 sc1
    s_waitcnt lgkmcnt(6)
    v_mfma_f32_32x32x16_bf16 v[96:111], v[148:151], v[172:175], v[96:111]
    ds_read_b64_tr_b16 v[164:165], v4 offset:3072
    ds_read_b64_tr_b16 v[166:167], v4 offset:3584
    v_max_f32_e64 v16, 0, v16
    v_max_f32 v17, 0, v17
    s_waitcnt vmcnt(28) lgkmcnt(6)
    v_mfma_f32_32x32x16_bf16 v[80:95], v[152:155], v[176:179], v[80:95]
    ds_read_b64_tr_b16 v[144:145], v3 offset:16384
    ds_read_b64_tr_b16 v[146:147], v3 offset:16896
    buffer_load_dwordx4 a[136:139], v13, s[32:35], s22 offen offset:2048 sc1
    v_mul_f32_e64 v16, v16, v24
    v_mul_f32 v17, v17, v25
    v_cvt_pk_bf16_f32 v16, v16, v17
    s_waitcnt lgkmcnt(6)
    v_mfma_f32_32x32x16_bf16 v[96:111], v[156:159], v[176:179], v[96:111]
    ds_read_b64_tr_b16 v[148:149], v4 offset:16384
    ds_read_b64_tr_b16 v[150:151], v4 offset:16896
    v_max_f32_e64 v18, 0, v18
    v_max_f32 v19, 0, v19
    s_waitcnt vmcnt(28) lgkmcnt(6)
    v_mfma_f32_32x32x16_bf16 v[80:95], v[160:163], v[180:183], v[80:95]
    ds_read_b64_tr_b16 v[152:153], v3 offset:17408
    ds_read_b64_tr_b16 v[154:155], v3 offset:17920
    buffer_load_dwordx4 a[140:143], v13, s[32:35], s22 offen offset:3072 sc1
    v_mul_f32_e64 v18, v18, v26
    v_mul_f32 v19, v19, v27
    v_cvt_pk_bf16_f32 v17, v18, v19
    s_waitcnt lgkmcnt(6)
    v_mfma_f32_32x32x16_bf16 v[96:111], v[164:167], v[180:183], v[96:111]
    ds_read_b64_tr_b16 v[156:157], v4 offset:17408
    ds_read_b64_tr_b16 v[158:159], v4 offset:17920
    v_max_f32_e64 v20, 0, v20
    v_max_f32 v21, 0, v21
    s_waitcnt vmcnt(28) lgkmcnt(6)
    v_mfma_f32_32x32x16_bf16 v[80:95], v[144:147], v[184:187], v[80:95]
    ds_read_b64_tr_b16 v[160:161], v3 offset:18432
    ds_read_b64_tr_b16 v[162:163], v3 offset:18944
    v_mul_f32_e64 v20, v20, v28
    v_mul_f32 v21, v21, v29
    v_cvt_pk_bf16_f32 v18, v20, v21
    s_waitcnt lgkmcnt(6)
    v_mfma_f32_32x32x16_bf16 v[96:111], v[148:151], v[184:187], v[96:111]
    ds_read_b64_tr_b16 v[164:165], v4 offset:18432
    ds_read_b64_tr_b16 v[166:167], v4 offset:18944
    buffer_load_dwordx4 a[144:147], v2, s[32:35], s18 offen offset:0 sc1
    v_max_f32_e64 v22, 0, v22
    v_max_f32 v23, 0, v23
    s_waitcnt vmcnt(28) lgkmcnt(6)
    v_mfma_f32_32x32x16_bf16 v[80:95], v[152:155], v[188:191], v[80:95]
    ds_read_b64_tr_b16 v[144:145], v3 offset:19456
    ds_read_b64_tr_b16 v[146:147], v3 offset:19968
    v_mul_f32_e64 v22, v22, v30
    v_mul_f32 v23, v23, v31
    v_cvt_pk_bf16_f32 v19, v22, v23
    s_waitcnt lgkmcnt(6)
    v_mfma_f32_32x32x16_bf16 v[96:111], v[156:159], v[188:191], v[96:111]
    ds_read_b64_tr_b16 v[148:149], v4 offset:19456
    ds_read_b64_tr_b16 v[150:151], v4 offset:19968
    s_cmp_eq_u32 s2, 0
    s_cbranch_scc1 L_st_22_g
    buffer_store_dwordx4 v[16:19], v13, s[32:35], s14 offen offset:0 nt
L_st_22_j:
    v_max_f32_e64 v32, 0, v32
    v_max_f32 v33, 0, v33
    s_waitcnt vmcnt(28) lgkmcnt(6)
    v_mfma_f32_32x32x16_bf16 v[80:95], v[160:163], v[192:195], v[80:95]
    ds_read_b64_tr_b16 v[152:153], v3 offset:32768
    ds_read_b64_tr_b16 v[154:155], v3 offset:33280
    v_mul_f32_e64 v32, v32, v40
    v_mul_f32 v33, v33, v41
    v_cvt_pk_bf16_f32 v32, v32, v33
    s_waitcnt lgkmcnt(6)
    v_mfma_f32_32x32x16_bf16 v[96:111], v[164:167], v[192:195], v[96:111]
    ds_read_b64_tr_b16 v[156:157], v4 offset:32768
    ds_read_b64_tr_b16 v[158:159], v4 offset:33280
    buffer_load_dwordx4 a[148:151], v2, s[32:35], s18 offen offset:1024 sc1
    v_max_f32_e64 v34, 0, v34
    v_max_f32 v35, 0, v35
    s_waitcnt vmcnt(28) lgkmcnt(6)
    v_mfma_f32_32x32x16_bf16 v[80:95], v[144:147], v[196:199], v[80:95]
    ds_read_b64_tr_b16 v[160:161], v3 offset:33792
    ds_read_b64_tr_b16 v[162:163], v3 offset:34304
    v_mul_f32_e64 v34, v34, v42
    v_mul_f32 v35, v35, v43
    v_cvt_pk_bf16_f32 v33, v34, v35
    s_waitcnt lgkmcnt(6)
    v_mfma_f32_32x32x16_bf16 v[96:111], v[148:151], v[196:199], v[96:111]
    ds_read_b64_tr_b16 v[164:165], v4 offset:33792
    ds_read_b64_tr_b16 v[166:167], v4 offset:34304
    buffer_load_dwordx4 a[152:155], v2, s[32:35], s18 offen offset:2048 sc1
    v_max_f32_e64 v36, 0, v36
    v_max_f32 v37, 0, v37
    s_waitcnt vmcnt(28) lgkmcnt(6)
    v_mfma_f32_32x32x16_bf16 v[80:95], v[152:155], v[200:203], v[80:95]
    ds_read_b64_tr_b16 v[144:145], v3 offset:34816
    ds_read_b64_tr_b16 v[146:147], v3 offset:35328
    v_mul_f32_e64 v36, v36, v44
    v_mul_f32 v37, v37, v45
    v_cvt_pk_bf16_f32 v34, v36, v37
    s_waitcnt lgkmcnt(6)
    v_mfma_f32_32x32x16_bf16 v[96:111], v[156:159], v[200:203], v[96:111]
    ds_read_b64_tr_b16 v[148:149], v4 offset:34816
    ds_read_b64_tr_b16 v[150:151], v4 offset:35328
    buffer_load_dwordx4 a[156:159], v2, s[32:35], s18 offen offset:3072 sc1
    v_max_f32_e64 v38, 0, v38
    v_max_f32 v39, 0, v39
    s_waitcnt vmcnt(28) lgkmcnt(6)
    v_mfma_f32_32x32x16_bf16 v[80:95], v[160:163], v[204:207], v[80:95]
    ds_read_b64_tr_b16 v[152:153], v3 offset:35840
    ds_read_b64_tr_b16 v[154:155], v3 offset:36352
    v_mul_f32_e64 v38, v38, v46
    v_mul_f32 v39, v39, v47
    v_cvt_pk_bf16_f32 v35, v38, v39
    s_waitcnt lgkmcnt(6)
    v_mfma_f32_32x32x16_bf16 v[96:111], v[164:167], v[204:207], v[96:111]
    ds_read_b64_tr_b16 v[156:157], v4 offset:35840
    ds_read_b64_tr_b16 v[158:159], v4 offset:36352
    s_cmp_eq_u32 s2, 0
    s_cbranch_scc1 L_st_23_g
    buffer_store_dwordx4 v[32:35], v13, s[32:35], s14 offen offset:1024 nt
L_st_23_j:
    v_max_f32_e64 v48, 0, v48
    v_max_f32 v49, 0, v49
    s_waitcnt vmcnt(28) lgkmcnt(6)
    v_mfma_f32_32x32x16_bf16 v[80:95], v[144:147], v[208:211], v[80:95]
    ds_read_b64_tr_b16 v[160:161], v3 offset:49152
    ds_read_b64_tr_b16 v[162:163], v3 offset:49664
    buffer_load_dwordx4 a[160:163], v2, s[32:35], s19 offen offset:0 sc1
    v_mul_f32_e64 v48, v48, v56
    v_mul_f32 v49, v49, v57
    v_cvt_pk_bf16_f32 v48, v48, v49
    s_waitcnt lgkmcnt(6)
    v_mfma_f32_32x32x16_bf16 v[96:111], v[148:151], v[208:211], v[96:111]
    ds_read_b64_tr_b16 v[164:165], v4 offset:49152
    ds_read_b64_tr_b16 v[166:167], v4 offset:49664
    v_max_f32_e64 v50, 0, v50
    v_max_f32 v51, 0, v51
    s_waitcnt vmcnt(28) lgkmcnt(6)
    v_mfma_f32_32x32x16_bf16 v[80:95], v[152:155], v[212:215], v[80:95]
    ds_read_b64_tr_b16 v[144:145], v3 offset:50176
    ds_read_b64_tr_b16 v[146:147], v3 offset:50688
    buffer_load_dwordx4 a[164:167], v2, s[32:35], s19 offen offset:1024 sc1
    v_mul_f32_e64 v50, v50, v58
    v_mul_f32 v51, v51, v59
    v_cvt_pk_bf16_f32 v49, v50, v51
    s_waitcnt lgkmcnt(6)
    v_mfma_f32_32x32x16_bf16 v[96:111], v[156:159], v[212:215], v[96:111]
    ds_read_b64_tr_b16 v[148:149], v4 offset:50176
    ds_read_b64_tr_b16 v[150:151], v4 offset:50688
    v_max_f32_e64 v52, 0, v52
    v_max_f32 v53, 0, v53
    s_waitcnt vmcnt(28) lgkmcnt(6)
    v_mfma_f32_32x32x16_bf16 v[80:95], v[160:163], v[216:219], v[80:95]
    ds_read_b64_tr_b16 v[152:153], v3 offset:51200
    ds_read_b64_tr_b16 v[154:155], v3 offset:51712
    buffer_load_dwordx4 a[168:171], v2, s[32:35], s19 offen offset:2048 sc1
    v_mul_f32_e64 v52, v52, v60
    v_mul_f32 v53, v53, v61
    v_cvt_pk_bf16_f32 v50, v52, v53
    s_waitcnt lgkmcnt(6)
    v_mfma_f32_32x32x16_bf16 v[96:111], v[164:167], v[216:219], v[96:111]
    ds_read_b64_tr_b16 v[156:157], v4 offset:51200
    ds_read_b64_tr_b16 v[158:159], v4 offset:51712
    v_max_f32_e64 v54, 0, v54
    v_max_f32 v55, 0, v55
    s_waitcnt vmcnt(28) lgkmcnt(6)
    v_mfma_f32_32x32x16_bf16 v[80:95], v[144:147], v[220:223], v[80:95]
    ds_read_b64_tr_b16 v[160:161], v3 offset:52224
    ds_read_b64_tr_b16 v[162:163], v3 offset:52736
    v_mul_f32_e64 v54, v54, v62
    v_mul_f32 v55, v55, v63
    v_cvt_pk_bf16_f32 v51, v54, v55
    s_waitcnt lgkmcnt(6)
    v_mfma_f32_32x32x16_bf16 v[96:111], v[148:151], v[220:223], v[96:111]
    ds_read_b64_tr_b16 v[164:165], v4 offset:52224
    ds_read_b64_tr_b16 v[166:167], v4 offset:52736
    s_cmp_eq_u32 s2, 0
    s_cbranch_scc1 L_st_24_g
    buffer_store_dwordx4 v[48:51], v13, s[32:35], s14 offen offset:2048 nt
L_st_24_j:
    v_max_f32_e64 v64, 0, v64
    v_max_f32 v65, 0, v65
    s_waitcnt vmcnt(28) lgkmcnt(6)
    v_mfma_f32_32x32x16_bf16 v[80:95], v[152:155], v[224:227], v[80:95]
    v_add_u32 v3, 0x10000, v3
    ds_read_b64_tr_b16 v[144:145], v3 offset:0
    ds_read_b64_tr_b16 v[146:147], v3 offset:512
    v_mul_f32_e64 v64, v64, v72
    v_mul_f32 v65, v65, v73
    v_cvt_pk_bf16_f32 v64, v64, v65
    s_waitcnt lgkmcnt(6)
    v_mfma_f32_32x32x16_bf16 v[96:111], v[156:159], v[224:227], v[96:111]
    v_add_u32 v4, 0x10000, v4
    ds_read_b64_tr_b16 v[148:149], v4 offset:0
    ds_read_b64_tr_b16 v[150:151], v4 offset:512
    v_max_f32_e64 v66, 0, v66
    v_max_f32 v67, 0, v67
    s_waitcnt vmcnt(27) lgkmcnt(6)
    v_mfma_f32_32x32x16_bf16 v[80:95], v[160:163], v[228:231], v[80:95]
    ds_read_b64_tr_b16 v[152:153], v3 offset:1024
    ds_read_b64_tr_b16 v[154:155], v3 offset:1536
    v_mul_f32_e64 v66, v66, v74
    v_mul_f32 v67, v67, v75
    v_cvt_pk_bf16_f32 v65, v66, v67
    s_waitcnt lgkmcnt(6)
    v_mfma_f32_32x32x16_bf16 v[96:111], v[164:167], v[228:231], v[96:111]
    ds_read_b64_tr_b16 v[156:157], v4 offset:1024
    ds_read_b64_tr_b16 v[158:159], v4 offset:1536
    v_max_f32_e64 v68, 0, v68
    v_max_f32 v69, 0, v69
    s_waitcnt vmcnt(26) lgkmcnt(6)
    v_mfma_f32_32x32x16_bf16 v[80:95], v[144:147], v[232:235], v[80:95]
    ds_read_b64_tr_b16 v[160:161], v3 offset:2048
    ds_read_b64_tr_b16 v[162:163], v3 offset:2560
    v_mul_f32_e64 v68, v68, v76
    v_mul_f32 v69, v69, v77
    v_cvt_pk_bf16_f32 v66, v68, v69
    s_waitcnt lgkmcnt(6)
    v_mfma_f32_32x32x16_bf16 v[96:111], v[148:151], v[232:235], v[96:111]
    ds_read_b64_tr_b16 v[164:165], v4 offset:2048
    ds_read_b64_tr_b16 v[166:167], v4 offset:2560
    v_max_f32_e64 v70, 0, v70
    v_max_f32 v71, 0, v71
    s_waitcnt vmcnt(25) lgkmcnt(6)
    v_mfma_f32_32x32x16_bf16 v[80:95], v[152:155], v[236:239], v[80:95]
    ds_read_b64_tr_b16 v[144:145], v3 offset:3072
    ds_read_b64_tr_b16 v[146:147], v3 offset:3584
    v_mul_f32 v70, v70, v78
    v_mul_f32 v71, v71, v79
    v_cvt_pk_bf16_f32 v67, v70, v71
    s_waitcnt lgkmcnt(6)
    v_mfma_f32_32x32x16_bf16 v[96:111], v[156:159], v[236:239], v[96:111]
    ds_read_b64_tr_b16 v[148:149], v4 offset:3072
    ds_read_b64_tr_b16 v[150:151], v4 offset:3584
    s_cmp_eq_u32 s2, 0
    s_cbranch_scc1 L_st_25_g
    buffer_store_dwordx4 v[64:67], v13, s[32:35], s14 offen offset:3072 nt
L_st_25_j:
    s_waitcnt vmcnt(25) lgkmcnt(6)
    v_mfma_f32_32x32x16_bf16 v[80:95], v[160:163], a[224:227], v[80:95]
    ds_read_b64_tr_b16 v[152:153], v3 offset:16384
    ds_read_b64_tr_b16 v[154:155], v3 offset:16896
    s_waitcnt lgkmcnt(6)
    v_mfma_f32_32x32x16_bf16 v[96:111], v[164:167], a[224:227], v[96:111]
    ds_read_b64_tr_b16 v[156:157], v4 offset:16384
    ds_read_b64_tr_b16 v[158:159], v4 offset:16896
    s_waitcnt vmcnt(24) lgkmcnt(6)
    v_mfma_f32_32x32x16_bf16 v[80:95], v[144:147], a[228:231], v[80:95]
    ds_read_b64_tr_b16 v[160:161], v3 offset:17408
    ds_read_b64_tr_b16 v[162:163], v3 offset:17920
    buffer_load_dwordx4 a[172:175], v2, s[32:35], s19 offen offset:3072 sc1
    s_waitcnt lgkmcnt(6)
    v_mfma_f32_32x32x16_bf16 v[96:111], v[148:151], a[228:231], v[96:111]
    ds_read_b64_tr_b16 v[164:165], v4 offset:17408
    ds_read_b64_tr_b16 v[166:167], v4 offset:17920
    s_waitcnt vmcnt(24) lgkmcnt(6)
    v_mfma_f32_32x32x16_bf16 v[80:95], v[152:155], a[232:235], v[80:95]
    ds_read_b64_tr_b16 v[144:145], v3 offset:18432
    ds_read_b64_tr_b16 v[146:147], v3 offset:18944
    buffer_load_dwordx4 a[176:179], v2, s[32:35], s20 offen offset:0 sc1
    s_waitcnt lgkmcnt(6)
    v_mfma_f32_32x32x16_bf16 v[96:111], v[156:159], a[232:235], v[96:111]
    ds_read_b64_tr_b16 v[148:149], v4 offset:18432
    ds_read_b64_tr_b16 v[150:151], v4 offset:18944
    s_waitcnt vmcnt(24) lgkmcnt(6)
    v_mfma_f32_32x32x16_bf16 v[80:95], v[160:163], a[236:239], v[80:95]
    ds_read_b64_tr_b16 v[152:153], v3 offset:19456
    ds_read_b64_tr_b16 v[154:155], v3 offset:19968
    buffer_load_dwordx4 a[180:183], v2, s[32:35], s20 offen offset:1024 sc1
    s_waitcnt lgkmcnt(6)
    v_mfma_f32_32x32x16_bf16 v[96:111], v[164:167], a[236:239], v[96:111]
    ds_read_b64_tr_b16 v[156:157], v4 offset:19456
    ds_read_b64_tr_b16 v[158:159], v4 offset:19968
    s_waitcnt vmcnt(24) lgkmcnt(6)
    v_mfma_f32_32x32x16_bf16 v[80:95], v[144:147], a[240:243], v[80:95]
    ds_read_b64_tr_b16 v[160:161], v3 offset:32768
    ds_read_b64_tr_b16 v[162:163], v3 offset:33280
    buffer_load_dwordx4 a[184:187], v2, s[32:35], s20 offen offset:2048 sc1
    s_waitcnt lgkmcnt(6)
    v_mfma_f32_32x32x16_bf16 v[96:111], v[148:151], a[240:243], v[96:111]
    ds_read_b64_tr_b16 v[164:165], v4 offset:32768
    ds_read_b64_tr_b16 v[166:167], v4 offset:33280
    s_waitcnt vmcnt(24) lgkmcnt(6)
    v_mfma_f32_32x32x16_bf16 v[80:95], v[152:155], a[244:247], v[80:95]
    ds_read_b64_tr_b16 v[144:145], v3 offset:33792
    ds_read_b64_tr_b16 v[146:147], v3 offset:34304
    buffer_load_dwordx4 a[188:191], v2, s[32:35], s20 offen offset:3072 sc1
    s_waitcnt lgkmcnt(6)
    v_mfma_f32_32x32x16_bf16 v[96:111], v[156:159], a[244:247], v[96:111]
    ds_read_b64_tr_b16 v[148:149], v4 offset:33792
    ds_read_b64_tr_b16 v[150:151], v4 offset:34304
    s_waitcnt vmcnt(5)
    s_cmp_eq_u32 s2, 0
    s_cbranch_scc1 L_st_26_g
    buffer_store_dword v241, v8, s[32:35], s11 offen offset:0
L_st_26_j:
    s_waitcnt lgkmcnt(6)
    v_mfma_f32_32x32x16_bf16 v[80:95], v[160:163], a[248:251], v[80:95]
    ds_read_b64_tr_b16 v[152:153], v3 offset:34816
    ds_read_b64_tr_b16 v[154:155], v3 offset:35328
    s_waitcnt lgkmcnt(6)
    v_mfma_f32_32x32x16_bf16 v[96:111], v[164:167], a[248:251], v[96:111]
    ds_read_b64_tr_b16 v[156:157], v4 offset:34816
    ds_read_b64_tr_b16 v[158:159], v4 offset:35328
    buffer_load_dwordx4 a[192:195], v2, s[32:35], s21 offen offset:0 sc1
    s_waitcnt lgkmcnt(6)
    v_mfma_f32_32x32x16_bf16 v[80:95], v[144:147], a[252:255], v[80:95]
    ds_read_b64_tr_b16 v[160:161], v3 offset:35840
    ds_read_b64_tr_b16 v[162:163], v3 offset:36352
    s_waitcnt lgkmcnt(6)
    v_mfma_f32_32x32x16_bf16 v[96:111], v[148:151], a[252:255], v[96:111]
    ds_read_b64_tr_b16 v[164:165], v4 offset:35840
    ds_read_b64_tr_b16 v[166:167], v4 offset:36352
    buffer_load_dwordx4 a[196:199], v2, s[32:35], s21 offen offset:1024 sc1
    s_waitcnt lgkmcnt(6)
    v_mfma_f32_32x32x16_bf16 v[80:95], v[152:155], v[244:247], v[80:95]
    v_subrev_u32 v5, 0x10000, v5
    ds_read_b64_tr_b16 v[144:145], v5 offset:0
    ds_read_b64_tr_b16 v[146:147], v5 offset:512
    s_waitcnt lgkmcnt(6)
    v_mfma_f32_32x32x16_bf16 v[96:111], v[156:159], v[244:247], v[96:111]
    v_subrev_u32 v6, 0x10000, v6
    ds_read_b64_tr_b16 v[148:149], v6 offset:0
    ds_read_b64_tr_b16 v[150:151], v6 offset:512
    buffer_load_dwordx4 a[200:203], v2, s[32:35], s21 offen offset:2048 sc1
    s_waitcnt lgkmcnt(6)
    v_mfma_f32_32x32x16_bf16 v[80:95], v[160:163], v[248:251], v[80:95]
    ds_read_b64_tr_b16 v[152:153], v5 offset:1024
    ds_read_b64_tr_b16 v[154:155], v5 offset:1536
    s_waitcnt lgkmcnt(6)
    v_mfma_f32_32x32x16_bf16 v[96:111], v[164:167], v[248:251], v[96:111]
    ds_read_b64_tr_b16 v[156:157], v6 offset:1024
    ds_read_b64_tr_b16 v[158:159], v6 offset:1536
    buffer_load_dwordx4 a[204:207], v2, s[32:35], s21 offen offset:3072 sc1
    s_waitcnt lgkmcnt(6)
    v_mfma_f32_32x32x16_bf16 v[112:127], v[144:147], v[168:171], 0
    ds_read_b64_tr_b16 v[160:161], v5 offset:2048
    ds_read_b64_tr_b16 v[162:163], v5 offset:2560
    s_waitcnt lgkmcnt(6)
    v_mfma_f32_32x32x16_bf16 v[128:143], v[148:151], v[168:171], 0
    ds_read_b64_tr_b16 v[164:165], v6 offset:2048
    ds_read_b64_tr_b16 v[166:167], v6 offset:2560
    buffer_load_dword v9, v12, s[32:35], 0 offen offset:0 sc1
    s_waitcnt lgkmcnt(6)
    v_mfma_f32_32x32x16_bf16 v[112:127], v[152:155], v[172:175], v[112:127]
    ds_read_b64_tr_b16 v[144:145], v5 offset:3072
    ds_read_b64_tr_b16 v[146:147], v5 offset:3584
    buffer_load_dwordx4 a[208:211], v2, s[32:35], s22 offen offset:0 sc1
    s_waitcnt lgkmcnt(6)
    v_mfma_f32_32x32x16_bf16 v[128:143], v[156:159], v[172:175], v[128:143]
    ds_read_b64_tr_b16 v[148:149], v6 offset:3072
    ds_read_b64_tr_b16 v[150:151], v6 offset:3584
    v_max_f32_e64 v80, 0, v80
    v_max_f32 v81, 0, v81
    s_waitcnt lgkmcnt(6)
    v_mfma_f32_32x32x16_bf16 v[112:127], v[160:163], v[176:179], v[112:127]
    ds_read_b64_tr_b16 v[152:153], v5 offset:16384
    ds_read_b64_tr_b16 v[154:155], v5 offset:16896
    v_mul_f32_e64 v80, v80, v88
    v_mul_f32 v81, v81, v89
    v_cvt_pk_bf16_f32 v80, v80, v81
    s_waitcnt lgkmcnt(6)
    v_mfma_f32_32x32x16_bf16 v[128:143], v[164:167], v[176:179], v[128:143]
    ds_read_b64_tr_b16 v[156:157], v6 offset:16384
    ds_read_b64_tr_b16 v[158:159], v6 offset:16896
    buffer_load_dwordx4 a[212:215], v2, s[32:35], s22 offen offset:1024 sc1
    v_max_f32_e64 v82, 0, v82
    v_max_f32 v83, 0, v83
    s_waitcnt lgkmcnt(6)
    v_mfma_f32_32x32x16_bf16 v[112:127], v[144:147], v[180:183], v[112:127]
    ds_read_b64_tr_b16 v[160:161], v5 offset:17408
    ds_read_b64_tr_b16 v[162:163], v5 offset:17920
    v_mul_f32_e64 v82, v82, v90
    v_mul_f32 v83, v83, v91
    v_cvt_pk_bf16_f32 v81, v82, v83
    s_waitcnt lgkmcnt(6)
    v_mfma_f32_32x32x16_bf16 v[128:143], v[148:151], v[180:183], v[128:143]
    ds_read_b64_tr_b16 v[164:165], v6 offset:17408
    ds_read_b64_tr_b16 v[166:167], v6 offset:17920
    buffer_load_dwordx4 a[216:219], v2, s[32:35], s22 offen offset:2048 sc1
    v_max_f32_e64 v84, 0, v84
    v_max_f32 v85, 0, v85
    s_waitcnt lgkmcnt(6)
    v_mfma_f32_32x32x16_bf16 v[112:127], v[152:155], v[184:187], v[112:127]
    ds_read_b64_tr_b16 v[144:145], v5 offset:18432
    ds_read_b64_tr_b16 v[146:147], v5 offset:18944
    v_mul_f32_e64 v84, v84, v92
    v_mul_f32 v85, v85, v93
    v_cvt_pk_bf16_f32 v82, v84, v85
    s_waitcnt lgkmcnt(6)
    v_mfma_f32_32x32x16_bf16 v[128:143], v[156:159], v[184:187], v[128:143]
    ds_read_b64_tr_b16 v[148:149], v6 offset:18432
    ds_read_b64_tr_b16 v[150:151], v6 offset:18944
    buffer_load_dwordx4 a[220:223], v2, s[32:35], s22 offen offset:3072 sc1
    v_max_f32_e64 v86, 0, v86
    v_max_f32 v87, 0, v87
    s_waitcnt lgkmcnt(6)
    v_mfma_f32_32x32x16_bf16 v[112:127], v[160:163], v[188:191], v[112:127]
    ds_read_b64_tr_b16 v[152:153], v5 offset:19456
    ds_read_b64_tr_b16 v[154:155], v5 offset:19968
    v_mul_f32_e64 v86, v86, v94
    v_mul_f32 v87, v87, v95
    v_cvt_pk_bf16_f32 v83, v86, v87
    s_waitcnt lgkmcnt(6)
    v_mfma_f32_32x32x16_bf16 v[128:143], v[164:167], v[188:191], v[128:143]
    ds_read_b64_tr_b16 v[156:157], v6 offset:19456
    ds_read_b64_tr_b16 v[158:159], v6 offset:19968
    s_cmp_eq_u32 s2, 0
    s_cbranch_scc1 L_st_27_g
    buffer_store_dwordx4 v[80:83], v13, s[32:35], s15 offen offset:0 nt
L_st_27_j:
    s_waitcnt vmcnt(5)
    v_cmp_ne_u32_e64 vcc, s54, v9
    s_waitcnt lgkmcnt(6)
    v_mfma_f32_32x32x16_bf16 v[112:127], v[144:147], v[192:195], v[112:127]
    ds_read_b64_tr_b16 v[160:161], v5 offset:32768
    ds_read_b64_tr_b16 v[162:163], v5 offset:33280
    s_cbranch_vccnz L_f4a_w
L_f4a_ok:
    s_waitcnt lgkmcnt(6)
    v_mfma_f32_32x32x16_bf16 v[128:143], v[148:151], v[192:195], v[128:143]
    ds_read_b64_tr_b16 v[164:165], v6 offset:32768
    ds_read_b64_tr_b16 v[166:167], v6 offset:33280
    buffer_load_dwordx4 v[16:19], v13, s[32:35], s4 offen offset:0 sc1
    v_max_f32_e64 v96, 0, v96
    v_max_f32 v97, 0, v97
    s_waitcnt lgkmcnt(6)
    v_mfma_f32_32x32x16_bf16 v[112:127], v[152:155], v[196:199], v[112:127]
    ds_read_b64_tr_b16 v[144:145], v5 offset:33792
    ds_read_b64_tr_b16 v[146:147], v5 offset:34304
    v_mul_f32_e64 v96, v96, v104
    v_mul_f32 v97, v97, v105
    v_cvt_pk_bf16_f32 v96, v96, v97
    s_waitcnt lgkmcnt(6)
    v_mfma_f32_32x32x16_bf16 v[128:143], v[156:159], v[196:199], v[128:143]
    ds_read_b64_tr_b16 v[148:149], v6 offset:33792
    ds_read_b64_tr_b16 v[150:151], v6 offset:34304
    v_max_f32_e64 v98, 0, v98
    v_max_f32 v99, 0, v99
    s_waitcnt lgkmcnt(6)
    v_mfma_f32_32x32x16_bf16 v[112:127], v[160:163], v[200:203], v[112:127]
    ds_read_b64_tr_b16 v[152:153], v5 offset:34816
    ds_read_b64_tr_b16 v[154:155], v5 offset:35328
    buffer_load_dwordx4 v[20:23], v13, s[32:35], s4 offen offset:1024 sc1
    v_mul_f32_e64 v98, v98, v106
    v_mul_f32 v99, v99, v107
    v_cvt_pk_bf16_f32 v97, v98, v99
    s_waitcnt lgkmcnt(6)
    v_mfma_f32_32x32x16_bf16 v[128:143], v[164:167], v[200:203], v[128:143]
    ds_read_b64_tr_b16 v[156:157], v6 offset:34816
    ds_read_b64_tr_b16 v[158:159], v6 offset:35328
    v_max_f32_e64 v100, 0, v100
    v_max_f32 v101, 0, v101
    s_waitcnt lgkmcnt(6)
    v_mfma_f32_32x32x16_bf16 v[112:127], v[144:147], v[204:207], v[112:127]
    ds_read_b64_tr_b16 v[160:161], v5 offset:35840
    ds_read_b64_tr_b16 v[162:163], v5 offset:36352
    buffer_load_dwordx4 v[24:27], v13, s[32:35], s5 offen offset:0 sc1
    v_mul_f32_e64 v100, v100, v108
    v_mul_f32 v101, v101, v109
    v_cvt_pk_bf16_f32 v98, v100, v101
    s_waitcnt lgkmcnt(6)
    v_mfma_f32_32x32x16_bf16 v[128:143], v[148:151], v[204:207], v[128:143]
    ds_read_b64_tr_b16 v[164:165], v6 offset:35840
    ds_read_b64_tr_b16 v[166:167], v6 offset:36352
    v_max_f32_e64 v102, 0, v102
    v_max_f32 v103, 0, v103
    s_waitcnt lgkmcnt(6)
    v_mfma_f32_32x32x16_bf16 v[112:127], v[152:155], v[208:211], v[112:127]
    ds_read_b64_tr_b16 v[144:145], v5 offset:49152
    ds_read_b64_tr_b16 v[146:147], v5 offset:49664
    buffer_load_dwordx4 v[28:31], v13, s[32:35], s5 offen offset:1024 sc1
    v_mul_f32_e64 v102, v102, v110
    v_mul_f32 v103, v103, v111
    v_cvt_pk_bf16_f32 v99, v102, v103
    s_waitcnt lgkmcnt(6)
    v_mfma_f32_32x32x16_bf16 v[128:143], v[156:159], v[208:211], v[128:143]
    ds_read_b64_tr_b16 v[148:149], v6 offset:49152
    ds_read_b64_tr_b16 v[150:151], v6 offset:49664
    s_cmp_eq_u32 s2, 0
    s_cbranch_scc1 L_st_28_g
    buffer_store_dwordx4 v[96:99], v13, s[32:35], s15 offen offset:1024 nt
L_st_28_j:
    s_waitcnt lgkmcnt(6)
    v_mfma_f32_32x32x16_bf16 v[112:127], v[160:163], v[212:215], v[112:127]
    ds_read_b64_tr_b16 v[152:153], v5 offset:50176
    ds_read_b64_tr_b16 v[154:155], v5 offset:50688
    buffer_load_dwordx4 v[32:35], v13, s[32:35], s6 offen offset:0 sc1
    s_waitcnt lgkmcnt(6)
    v_mfma_f32_32x32x16_bf16 v[128:143], v[164:167], v[212:215], v[128:143]
    ds_read_b64_tr_b16 v[156:157], v6 offset:50176
    ds_read_b64_tr_b16 v[158:159], v6 offset:50688
    s_waitcnt lgkmcnt(6)
    v_mfma_f32_32x32x16_bf16 v[112:127], v[144:147], v[216:219], v[112:127]
    ds_read_b64_tr_b16 v[160:161], v5 offset:51200
    ds_read_b64_tr_b16 v[162:163], v5 offset:51712
    buffer_load_dwordx4 v[36:39], v13, s[32:35], s6 offen offset:1024 sc1
    s_waitcnt lgkmcnt(6)
    v_mfma_f32_32x32x16_bf16 v[128:143], v[148:151], v[216:219], v[128:143]
    ds_read_b64_tr_b16 v[164:165], v6 offset:51200
    ds_read_b64_tr_b16 v[166:167], v6 offset:51712
    s_waitcnt lgkmcnt(6)
    v_mfma_f32_32x32x16_bf16 v[112:127], v[152:155], v[220:223], v[112:127]
    ds_read_b64_tr_b16 v[144:145], v5 offset:52224
    ds_read_b64_tr_b16 v[146:147], v5 offset:52736
    s_waitcnt lgkmcnt(6)
    v_mfma_f32_32x32x16_bf16 v[128:143], v[156:159], v[220:223], v[128:143]
    ds_read_b64_tr_b16 v[148:149], v6 offset:52224
    ds_read_b64_tr_b16 v[150:151], v6 offset:52736
    buffer_load_dwordx4 v[40:43], v13, s[32:35], s7 offen offset:0 sc1
    s_waitcnt lgkmcnt(6)
    v_mfma_f32_32x32x16_bf16 v[112:127], v[160:163], v[224:227], v[112:127]
    v_add_u32 v5, 0x10000, v5
    ds_read_b64_tr_b16 v[152:153], v5 offset:0
    ds_read_b64_tr_b16 v[154:155], v5 offset:512
    s_waitcnt lgkmcnt(6)
    v_mfma_f32_32x32x16_bf16 v[128:143], v[164:167], v[224:227], v[128:143]
    v_add_u32 v6, 0x10000, v6
    ds_read_b64_tr_b16 v[156:157], v6 offset:0
    ds_read_b64_tr_b16 v[158:159], v6 offset:512
    buffer_load_dwordx4 v[44:47], v13, s[32:35], s7 offen offset:1024 sc1
    s_waitcnt lgkmcnt(6)
    v_mfma_f32_32x32x16_bf16 v[112:127], v[144:147], v[228:231], v[112:127]
    ds_read_b64_tr_b16 v[160:161], v5 offset:1024
    ds_read_b64_tr_b16 v[162:163], v5 offset:1536
    s_waitcnt lgkmcnt(6)
    v_mfma_f32_32x32x16_bf16 v[128:143], v[148:151], v[228:231], v[128:143]
    ds_read_b64_tr_b16 v[164:165], v6 offset:1024
    ds_read_b64_tr_b16 v[166:167], v6 offset:1536
    buffer_load_dwordx4 v[48:51], v13, s[32:35], s8 offen offset:0 sc1
    s_waitcnt lgkmcnt(6)
    v_mfma_f32_32x32x16_bf16 v[112:127], v[152:155], v[232:235], v[112:127]
    ds_read_b64_tr_b16 v[144:145], v5 offset:2048
    ds_read_b64_tr_b16 v[146:147], v5 offset:2560
    s_waitcnt lgkmcnt(6)
    v_mfma_f32_32x32x16_bf16 v[128:143], v[156:159], v[232:235], v[128:143]
    ds_read_b64_tr_b16 v[148:149], v6 offset:2048
    ds_read_b64_tr_b16 v[150:151], v6 offset:2560
    buffer_load_dwordx4 v[52:55], v13, s[32:35], s8 offen offset:1024 sc1
    s_waitcnt lgkmcnt(6)
    v_mfma_f32_32x32x16_bf16 v[112:127], v[160:163], v[236:239], v[112:127]
    ds_read_b64_tr_b16 v[152:153], v5 offset:3072
    ds_read_b64_tr_b16 v[154:155], v5 offset:3584
    s_waitcnt lgkmcnt(6)
    v_mfma_f32_32x32x16_bf16 v[128:143], v[164:167], v[236:239], v[128:143]
    ds_read_b64_tr_b16 v[156:157], v6 offset:3072
    ds_read_b64_tr_b16 v[158:159], v6 offset:3584
    buffer_load_dwordx4 v[56:59], v13, s[32:35], s9 offen offset:0 sc1
    s_waitcnt lgkmcnt(6)
    v_mfma_f32_32x32x16_bf16 v[112:127], v[144:147], a[224:227], v[112:127]
    ds_read_b64_tr_b16 v[160:161], v5 offset:16384
    ds_read_b64_tr_b16 v[162:163], v5 offset:16896
    s_waitcnt lgkmcnt(6)
    v_mfma_f32_32x32x16_bf16 v[128:143], v[148:151], a[224:227], v[128:143]
    ds_read_b64_tr_b16 v[164:165], v6 offset:16384
    ds_read_b64_tr_b16 v[166:167], v6 offset:16896
    s_waitcnt vmcnt(7)
    s_cmp_eq_u32 s2, 0
    s_cbranch_scc1 L_st_29_g
    buffer_store_dword v241, v8, s[32:35], s12 offen offset:128
L_st_29_j:
    s_waitcnt lgkmcnt(6)
    v_mfma_f32_32x32x16_bf16 v[112:127], v[152:155], a[228:231], v[112:127]
    ds_read_b64_tr_b16 v[144:145], v5 offset:17408
    ds_read_b64_tr_b16 v[146:147], v5 offset:17920
    buffer_load_dwordx4 v[60:63], v13, s[32:35], s9 offen offset:1024 sc1
    s_waitcnt lgkmcnt(6)
    v_mfma_f32_32x32x16_bf16 v[128:143], v[156:159], a[228:231], v[128:143]
    ds_read_b64_tr_b16 v[148:149], v6 offset:17408
    ds_read_b64_tr_b16 v[150:151], v6 offset:17920
    s_waitcnt lgkmcnt(6)
    v_mfma_f32_32x32x16_bf16 v[112:127], v[160:163], a[232:235], v[112:127]
    ds_read_b64_tr_b16 v[152:153], v5 offset:18432
    ds_read_b64_tr_b16 v[154:155], v5 offset:18944
    buffer_load_dwordx4 v[64:67], v13, s[32:35], s10 offen offset:0 sc1
    s_waitcnt lgkmcnt(6)
    v_mfma_f32_32x32x16_bf16 v[128:143], v[164:167], a[232:235], v[128:143]
    ds_read_b64_tr_b16 v[156:157], v6 offset:18432
    ds_read_b64_tr_b16 v[158:159], v6 offset:18944
    s_waitcnt lgkmcnt(6)
    v_mfma_f32_32x32x16_bf16 v[112:127], v[144:147], a[236:239], v[112:127]
    ds_read_b64_tr_b16 v[160:161], v5 offset:19456
    ds_read_b64_tr_b16 v[162:163], v5 offset:19968
    buffer_load_dwordx4 v[68:71], v13, s[32:35], s10 offen offset:1024 sc1
    s_waitcnt lgkmcnt(6)
    v_mfma_f32_32x32x16_bf16 v[128:143], v[148:151], a[236:239], v[128:143]
    ds_read_b64_tr_b16 v[164:165], v6 offset:19456
    ds_read_b64_tr_b16 v[166:167], v6 offset:19968
    s_waitcnt lgkmcnt(6)
    v_mfma_f32_32x32x16_bf16 v[112:127], v[152:155], a[240:243], v[112:127]
    ds_read_b64_tr_b16 v[144:145], v5 offset:32768
    ds_read_b64_tr_b16 v[146:147], v5 offset:33280
    buffer_load_dwordx4 v[72:75], v13, s[32:35], s4 offen offset:2048 sc1
    s_waitcnt lgkmcnt(6)
    v_mfma_f32_32x32x16_bf16 v[128:143], v[156:159], a[240:243], v[128:143]
    ds_read_b64_tr_b16 v[148:149], v6 offset:32768
    ds_read_b64_tr_b16 v[150:151], v6 offset:33280
    s_waitcnt lgkmcnt(6)
    v_mfma_f32_32x32x16_bf16 v[112:127], v[160:163], a[244:247], v[112:127]
    ds_read_b64_tr_b16 v[152:153], v5 offset:33792
    ds_read_b64_tr_b16 v[154:155], v5 offset:34304
    buffer_load_dwordx4 v[76:79], v13, s[32:35], s4 offen offset:3072 sc1
    s_waitcnt lgkmcnt(6)
    v_mfma_f32_32x32x16_bf16 v[128:143], v[164:167], a[244:247], v[128:143]
    ds_read_b64_tr_b16 v[156:157], v6 offset:33792
    ds_read_b64_tr_b16 v[158:159], v6 offset:34304
    s_waitcnt lgkmcnt(6)
    v_mfma_f32_32x32x16_bf16 v[112:127], v[144:147], a[248:251], v[112:127]
    ds_read_b64_tr_b16 v[160:161], v5 offset:34816
    ds_read_b64_tr_b16 v[162:163], v5 offset:35328
    s_waitcnt lgkmcnt(6)
    v_mfma_f32_32x32x16_bf16 v[128:143], v[148:151], a[248:251], v[128:143]
    ds_read_b64_tr_b16 v[164:165], v6 offset:34816
    ds_read_b64_tr_b16 v[166:167], v6 offset:35328
    buffer_load_dwordx4 v[168:171], v13, s[32:35], s5 offen offset:2048 sc1
    s_waitcnt lgkmcnt(6)
    v_mfma_f32_32x32x16_bf16 v[112:127], v[152:155], a[252:255], v[112:127]
    ds_read_b64_tr_b16 v[144:145], v5 offset:35840
    ds_read_b64_tr_b16 v[146:147], v5 offset:36352
    s_waitcnt lgkmcnt(6)
    v_mfma_f32_32x32x16_bf16 v[128:143], v[156:159], a[252:255], v[128:143]
    ds_read_b64_tr_b16 v[148:149], v6 offset:35840
    ds_read_b64_tr_b16 v[150:151], v6 offset:36352
    buffer_load_dwordx4 v[172:175], v13, s[32:35], s5 offen offset:3072 sc1
    s_waitcnt lgkmcnt(6)
    v_mfma_f32_32x32x16_bf16 v[112:127], v[160:163], v[244:247], v[112:127]
    s_waitcnt lgkmcnt(4)
    v_mfma_f32_32x32x16_bf16 v[128:143], v[164:167], v[244:247], v[128:143]
    buffer_load_dwordx4 v[176:179], v13, s[32:35], s6 offen offset:2048 sc1
    s_waitcnt lgkmcnt(2)
    v_mfma_f32_32x32x16_bf16 v[112:127], v[144:147], v[248:251], v[112:127]
    s_waitcnt lgkmcnt(0)
    v_mfma_f32_32x32x16_bf16 v[128:143], v[148:151], v[248:251], v[128:143]
    buffer_load_dwordx4 v[180:183], v13, s[32:35], s6 offen offset:3072 sc1
    v_mfma_f32_32x32x16_bf16 v[216:231], a[4:7], v[16:19], 0
    v_mfma_f32_32x32x16_bf16 v[144:159], a[0:3], v[16:19], 0
    buffer_load_dword v10, v12, s[32:35], s13 offen offset:128 sc1
    v_mfma_f32_32x32x16_bf16 v[216:231], a[12:15], v[20:23], v[216:231]
    buffer_load_dwordx4 v[252:255], v0, s[32:35], s70 offen sc1
    v_mfma_f32_32x32x16_bf16 v[144:159], a[8:11], v[20:23], v[144:159]
    s_nop 2
    v_max_f32 v112, 0, v112
    v_max_f32 v113, 0, v113
    v_mul_f32 v112, v112, v120
    v_mul_f32 v113, v113, v121
    v_cvt_pk_bf16_f32 v112, v112, v113
    v_mfma_f32_32x32x16_bf16 v[216:231], a[20:23], v[24:27], v[216:231]
    v_max_f32 v114, 0, v114
    v_max_f32 v115, 0, v115
    v_mul_f32 v114, v114, v122
    v_mul_f32 v115, v115, v123
    v_cvt_pk_bf16_f32 v113, v114, v115
    v_mfma_f32_32x32x16_bf16 v[144:159], a[16:19], v[24:27], v[144:159]
    buffer_load_dwordx4 v[184:187], v13, s[32:35], s7 offen offset:2048 sc1
    v_max_f32 v116, 0, v116
    v_max_f32 v117, 0, v117
    v_mul_f32 v116, v116, v124
    v_mul_f32 v117, v117, v125
    v_cvt_pk_bf16_f32 v114, v116, v117
    v_mfma_f32_32x32x16_bf16 v[216:231], a[28:31], v[28:31], v[216:231]
    v_max_f32 v118, 0, v118
    v_max_f32 v119, 0, v119
    v_mul_f32 v118, v118, v126
    v_mul_f32 v119, v119, v127
    v_cvt_pk_bf16_f32 v115, v118, v119
    v_mfma_f32_32x32x16_bf16 v[144:159], a[24:27], v[28:31], v[144:159]
    s_cmp_eq_u32 s2, 0
    s_cbranch_scc1 L_st_30_g
    buffer_store_dwordx4 v[112:115], v13, s[32:35], s15 offen offset:2048 nt
L_st_30_j:
    v_max_f32 v128, 0, v128
    v_max_f32 v129, 0, v129
    v_mul_f32 v128, v128, v136
    v_mul_f32 v129, v129, v137
    v_cvt_pk_bf16_f32 v128, v128, v129
    s_waitcnt vmcnt(20)
    v_mfma_f32_32x32x16_bf16 v[216:231], a[68:71], v[32:35], v[216:231]
    v_max_f32 v130, 0, v130
    v_max_f32 v131, 0, v131
    v_mul_f32 v130, v130, v138
    v_mul_f32 v131, v131, v139
    v_cvt_pk_bf16_f32 v129, v130, v131
    v_mfma_f32_32x32x16_bf16 v[144:159], a[64:67], v[32:35], v[144:159]
    buffer_load_dwordx4 v[188:191], v13, s[32:35], s7 offen offset:3072 sc1
    v_max_f32 v132, 0, v132
    v_max_f32 v133, 0, v133
    v_mul_f32 v132, v132, v140
    v_mul_f32 v133, v133, v141
    v_cvt_pk_bf16_f32 v130, v132, v133
    s_waitcnt vmcnt(20)
    v_mfma_f32_32x32x16_bf16 v[216:231], a[76:79], v[36:39], v[216:231]
    v_max_f32 v134, 0, v134
    v_max_f32 v135, 0, v135
    v_mul_f32 v134, v134, v142
    v_mul_f32 v135, v135, v143
    v_cvt_pk_bf16_f32 v131, v134, v135
    v_mfma_f32_32x32x16_bf16 v[144:159], a[72:75], v[36:39], v[144:159]
    s_cmp_eq_u32 s2, 0
    s_cbranch_scc1 L_st_31_g
    buffer_store_dwordx4 v[128:131], v13, s[32:35], s15 offen offset:3072 nt
L_st_31_j:
    s_waitcnt vmcnt(20)
    v_mfma_f32_32x32x16_bf16 v[216:231], a[84:87], v[40:43], v[216:231]
    v_mfma_f32_32x32x16_bf16 v[144:159], a[80:83], v[40:43], v[144:159]
    buffer_load_dwordx4 v[192:195], v13, s[32:35], s8 offen offset:2048 sc1
    s_waitcnt vmcnt(20)
    v_mfma_f32_32x32x16_bf16 v[216:231], a[92:95], v[44:47], v[216:231]
    v_mfma_f32_32x32x16_bf16 v[144:159], a[88:91], v[44:47], v[144:159]
    s_waitcnt vmcnt(6)
    v_cmp_ne_u32 vcc, s54, v10
    v_mfma_f32_32x32x16_bf16 v[216:231], a[100:103], v[48:51], v[216:231]
    buffer_load_dwordx4 v[196:199], v13, s[32:35], s8 offen offset:3072 sc1
    s_cbranch_vccnz L_f4b_w
L_f4b_ok:
    v_mfma_f32_32x32x16_bf16 v[144:159], a[96:99], v[48:51], v[144:159]
    v_mfma_f32_32x32x16_bf16 v[216:231], a[108:111], v[52:55], v[216:231]
    buffer_load_dwordx4 v[200:203], v13, s[32:35], s9 offen offset:2048 sc1
    v_mfma_f32_32x32x16_bf16 v[144:159], a[104:107], v[52:55], v[144:159]
    v_mfma_f32_32x32x16_bf16 v[216:231], a[116:119], v[56:59], v[216:231]
    buffer_load_dwordx4 v[204:207], v13, s[32:35], s9 offen offset:3072 sc1
    v_mfma_f32_32x32x16_bf16 v[144:159], a[112:115], v[56:59], v[144:159]
    v_mfma_f32_32x32x16_bf16 v[216:231], a[124:127], v[60:63], v[216:231]
    buffer_load_dwordx4 v[208:211], v13, s[32:35], s10 offen offset:2048 sc1
    v_mfma_f32_32x32x16_bf16 v[144:159], a[120:123], v[60:63], v[144:159]
    v_mfma_f32_32x32x16_bf16 v[216:231], a[132:135], v[64:67], v[216:231]
    buffer_load_dwordx4 v[212:215], v13, s[32:35], s10 offen offset:3072 sc1
    v_mfma_f32_32x32x16_bf16 v[144:159], a[128:131], v[64:67], v[144:159]
    s_waitcnt vmcnt(6)
    s_cmp_eq_u32 s2, 0
    s_cbranch_scc1 L_st_32_g
    buffer_store_dword v241, v8, s[32:35], s11 offen offset:128
L_st_32_j:
    v_mfma_f32_32x32x16_bf16 v[216:231], a[140:143], v[68:71], v[216:231]
    v_mfma_f32_32x32x16_bf16 v[144:159], a[136:139], v[68:71], v[144:159]
    v_add_u32 v2, 114688, v13
    v_mfma_f32_32x32x16_bf16 v[216:231], a[36:39], v[72:75], v[216:231]
    buffer_load_dwordx4 a[224:227], v2, s[32:35], s4 offen offset:0 sc1
    v_mfma_f32_32x32x16_bf16 v[144:159], a[32:35], v[72:75], v[144:159]
    v_mfma_f32_32x32x16_bf16 v[216:231], a[44:47], v[76:79], v[216:231]
    buffer_load_dwordx4 a[228:231], v2, s[32:35], s4 offen offset:1024 sc1
    ds_read_b128 v[160:163], v242 offset:0
    v_add_u32 v3, s72, v13
    v_add_u32 v3, 114688, v3
    v_mfma_f32_32x32x16_bf16 v[144:159], a[40:43], v[76:79], v[144:159]
    ds_read_b128 v[164:167], v242 offset:16
    v_add_u32 v4, s73, v13
    v_add_u32 v4, 114688, v4
    v_mfma_f32_32x32x16_bf16 v[216:231], a[52:55], v[168:171], v[216:231]
    buffer_load_dwordx4 a[232:235], v2, s[32:35], s5 offen offset:0 sc1
    v_add_u32 v5, s74, v13
    v_add_u32 v5, 114688, v5
    v_mfma_f32_32x32x16_bf16 v[144:159], a[48:51], v[168:171], v[144:159]
    v_lshlrev_b32 v232, 16, v252
    v_and_b32 v233, s61, v252
    v_mfma_f32_32x32x16_bf16 v[216:231], a[60:63], v[172:175], v[216:231]
    buffer_load_dwordx4 a[236:239], v2, s[32:35], s5 offen offset:1024 sc1
    v_lshlrev_b32 v234, 16, v253
    v_and_b32 v235, s61, v253
    v_mfma_f32_32x32x16_bf16 v[144:159], a[56:59], v[172:175], v[144:159]
    v_lshlrev_b32 v236, 16, v254
    v_and_b32 v237, s61, v254
    v_mfma_f32_32x32x16_bf16 v[216:231], a[148:151], v[176:179], v[216:231]
    buffer_load_dwordx4 a[240:243], v2, s[32:35], s6 offen offset:0 sc1
    v_lshlrev_b32 v238, 16, v255
    v_and_b32 v239, s61, v255
    v_mfma_f32_32x32x16_bf16 v[144:159], a[144:147], v[176:179], v[144:159]
    v_mfma_f32_32x32x16_bf16 v[216:231], a[156:159], v[180:183], v[216:231]
    v_mfma_f32_32x32x16_bf16 v[144:159], a[152:155], v[180:183], v[144:159]
    buffer_load_dwordx4 a[244:247], v2, s[32:35], s6 offen offset:1024 sc1
    v_mfma_f32_32x32x16_bf16 v[216:231], a[164:167], v[184:187], v[216:231]
    v_mfma_f32_32x32x16_bf16 v[144:159], a[160:163], v[184:187], v[144:159]
    buffer_load_dword v9, v12, s[32:35], 0 offen offset:128 sc1
    v_mfma_f32_32x32x16_bf16 v[216:231], a[172:175], v[188:191], v[216:231]
    buffer_load_dwordx4 a[248:251], v2, s[32:35], s7 offen offset:0 sc1
    v_mfma_f32_32x32x16_bf16 v[144:159], a[168:171], v[188:191], v[144:159]
    s_waitcnt vmcnt(14)
    v_mfma_f32_32x32x16_bf16 v[216:231], a[180:183], v[192:195], v[216:231]
    buffer_load_dwordx4 a[252:255], v2, s[32:35], s7 offen offset:1024 sc1
    v_mfma_f32_32x32x16_bf16 v[144:159], a[176:179], v[192:195], v[144:159]
    s_waitcnt vmcnt(14)
    v_mfma_f32_32x32x16_bf16 v[216:231], a[188:191], v[196:199], v[216:231]
    buffer_load_dwordx4 v[244:247], v2, s[32:35], s8 offen offset:0 sc1
    v_mfma_f32_32x32x16_bf16 v[144:159], a[184:187], v[196:199], v[144:159]
    s_waitcnt vmcnt(14)
    v_mfma_f32_32x32x16_bf16 v[216:231], a[196:199], v[200:203], v[216:231]
    buffer_load_dwordx4 v[248:251], v2, s[32:35], s8 offen offset:1024 sc1
    v_mfma_f32_32x32x16_bf16 v[144:159], a[192:195], v[200:203], v[144:159]
    s_waitcnt vmcnt(14)
    v_mfma_f32_32x32x16_bf16 v[216:231], a[204:207], v[204:207], v[216:231]
    v_mfma_f32_32x32x16_bf16 v[144:159], a[200:203], v[204:207], v[144:159]
    buffer_load_dwordx4 v[16:19], v2, s[32:35], s9 offen offset:0 sc1
    s_waitcnt vmcnt(14)
    v_mfma_f32_32x32x16_bf16 v[216:231], a[212:215], v[208:211], v[216:231]
    v_mfma_f32_32x32x16_bf16 v[144:159], a[208:211], v[208:211], v[144:159]
    buffer_load_dwordx4 v[20:23], v2, s[32:35], s9 offen offset:1024 sc1
    s_waitcnt vmcnt(6)
    v_cmp_ne_u32 vcc, s54, v9
    v_mfma_f32_32x32x16_bf16 v[216:231], a[220:223], v[212:215], v[216:231]
    s_cbranch_vccnz L_f4c_w
L_f4c_ok:
    v_mfma_f32_32x32x16_bf16 v[144:159], a[216:219], v[212:215], v[144:159]
    buffer_load_dwordx4 v[24:27], v2, s[32:35], s10 offen offset:0 sc1
    v_mfma_f32_32x32x16_bf16 v[96:111], a[4:7], a[224:227], 0
    v_mfma_f32_32x32x16_bf16 v[80:95], a[0:3], a[224:227], 0
    buffer_load_dwordx4 v[28:31], v2, s[32:35], s10 offen offset:1024 sc1
    v_mfma_f32_32x32x16_bf16 v[96:111], a[12:15], a[228:231], v[96:111]
    v_mfma_f32_32x32x16_bf16 v[80:95], a[8:11], a[228:231], v[80:95]
    buffer_load_dwordx4 v[32:35], v2, s[32:35], s4 offen offset:2048 sc1
    v_mfma_f32_32x32x16_bf16 v[96:111], a[20:23], a[232:235], v[96:111]
    s_nop 1
    ds_write_b128 v243, v[216:219] offset:2048
    v_mfma_f32_32x32x16_bf16 v[80:95], a[16:19], a[232:235], v[80:95]
    ds_write_b128 v243, v[220:223] offset:3072
    v_mfma_f32_32x32x16_bf16 v[96:111], a[28:31], a[236:239], v[96:111]
    buffer_load_dwordx4 v[36:39], v2, s[32:35], s4 offen offset:3072 sc1
    ds_write_b128 v243, v[224:227] offset:4096
    v_mfma_f32_32x32x16_bf16 v[80:95], a[24:27], a[236:239], v[80:95]
    ds_write_b128 v243, v[228:231] offset:5120
    v_mfma_f32_32x32x16_bf16 v[96:111], a[68:71], a[240:243], v[96:111]
    buffer_load_dwordx4 v[40:43], v2, s[32:35], s5 offen offset:2048 sc1
    ds_write_b128 v243, v[152:155] offset:0
    v_mfma_f32_32x32x16_bf16 v[80:95], a[64:67], a[240:243], v[80:95]
    ds_write_b128 v243, v[156:159] offset:1024
    v_mfma_f32_32x32x16_bf16 v[96:111], a[76:79], a[244:247], v[96:111]
    buffer_load_dwordx4 v[44:47], v2, s[32:35], s5 offen offset:3072 sc1
    v_mfma_f32_32x32x16_bf16 v[80:95], a[72:75], a[244:247], v[80:95]
    s_waitcnt vmcnt(11)
    v_mfma_f32_32x32x16_bf16 v[96:111], a[84:87], a[248:251], v[96:111]
    buffer_load_dwordx4 v[48:51], v2, s[32:35], s6 offen offset:2048 sc1
    v_mfma_f32_32x32x16_bf16 v[80:95], a[80:83], a[248:251], v[80:95]
    s_waitcnt lgkmcnt(0)
    s_barrier
    s_waitcnt vmcnt(11)
    v_mfma_f32_32x32x16_bf16 v[96:111], a[92:95], a[252:255], v[96:111]
    buffer_load_dwordx4 v[52:55], v2, s[32:35], s6 offen offset:3072 sc1
    ds_read_b128 v[152:155], v3 offset:0
    v_mfma_f32_32x32x16_bf16 v[80:95], a[88:91], a[252:255], v[80:95]
    ds_read_b128 v[156:159], v3 offset:1024
    s_waitcnt vmcnt(11)
    v_mfma_f32_32x32x16_bf16 v[96:111], a[100:103], v[244:247], v[96:111]
    ds_read_b128 v[216:219], v4 offset:0
    v_mfma_f32_32x32x16_bf16 v[80:95], a[96:99], v[244:247], v[80:95]
    buffer_load_dwordx4 v[56:59], v2, s[32:35], s7 offen offset:2048 sc1
    ds_read_b128 v[220:223], v4 offset:1024
    s_waitcnt vmcnt(11)
    v_mfma_f32_32x32x16_bf16 v[96:111], a[108:111], v[248:251], v[96:111]
    ds_read_b128 v[224:227], v5 offset:0
    v_mfma_f32_32x32x16_bf16 v[80:95], a[104:107], v[248:251], v[80:95]
    buffer_load_dwordx4 v[60:63], v2, s[32:35], s7 offen offset:3072 sc1
    ds_read_b128 v[228:231], v5 offset:1024
    s_waitcnt vmcnt(11)
    v_mfma_f32_32x32x16_bf16 v[96:111], a[116:119], v[16:19], v[96:111]
    v_mfma_f32_32x32x16_bf16 v[80:95], a[112:115], v[16:19], v[80:95]
    buffer_load_dwordx4 v[64:67], v2, s[32:35], s8 offen offset:2048 sc1
    s_waitcnt lgkmcnt(5)
    v_add_f32 v144, v144, v152
    v_add_f32 v145, v145, v153
    v_add_f32 v146, v146, v154
    s_waitcnt vmcnt(11)
    v_mfma_f32_32x32x16_bf16 v[96:111], a[124:127], v[20:23], v[96:111]
    v_add_f32 v147, v147, v155
    s_waitcnt lgkmcnt(4)
    v_add_f32 v148, v148, v156
    v_add_f32 v149, v149, v157
    v_mfma_f32_32x32x16_bf16 v[80:95], a[120:123], v[20:23], v[80:95]
    buffer_load_dwordx4 v[68:71], v2, s[32:35], s8 offen offset:3072 sc1
    v_add_f32 v150, v150, v158
    v_add_f32 v151, v151, v159
    s_waitcnt lgkmcnt(3)
    v_add_f32 v144, v144, v216
    s_waitcnt vmcnt(11)
    v_mfma_f32_32x32x16_bf16 v[96:111], a[132:135], v[24:27], v[96:111]
    v_add_f32 v145, v145, v217
    v_add_f32 v146, v146, v218
    v_add_f32 v147, v147, v219
    v_mfma_f32_32x32x16_bf16 v[80:95], a[128:131], v[24:27], v[80:95]
    buffer_load_dwordx4 v[72:75], v2, s[32:35], s9 offen offset:2048 sc1
    s_waitcnt lgkmcnt(2)
    v_add_f32 v148, v148, v220
    v_add_f32 v149, v149, v221
    v_add_f32 v150, v150, v222
    s_waitcnt vmcnt(11)
    v_mfma_f32_32x32x16_bf16 v[96:111], a[140:143], v[28:31], v[96:111]
    v_add_f32 v151, v151, v223
    s_waitcnt lgkmcnt(1)
    v_add_f32 v144, v144, v224
    v_add_f32 v145, v145, v225
    v_mfma_f32_32x32x16_bf16 v[80:95], a[136:139], v[28:31], v[80:95]
    v_add_f32 v146, v146, v226
    v_add_f32 v147, v147, v227
    s_waitcnt lgkmcnt(0)
    v_add_f32 v148, v148, v228
    s_waitcnt vmcnt(10)
    v_mfma_f32_32x32x16_bf16 v[96:111], a[36:39], v[32:35], v[96:111]
    buffer_load_dwordx4 v[252:255], v0, s[32:35], s71 offen sc1
    v_add_f32 v149, v149, v229
    v_add_f32 v150, v150, v230
    v_add_f32_e64 v151, v151, v231
    v_mfma_f32_32x32x16_bf16 v[80:95], a[32:35], v[32:35], v[80:95]
    v_fma_f32 v144, v144, v160, v232
    v_fma_f32 v145, v145, v161, v233
    v_fma_f32 v146, v146, v162, v234
    s_waitcnt vmcnt(10)
    v_mfma_f32_32x32x16_bf16 v[96:111], a[44:47], v[36:39], v[96:111]
    buffer_load_dwordx4 v[76:79], v2, s[32:35], s9 offen offset:3072 sc1
    v_fma_f32 v147, v147, v163, v235
    v_fma_f32 v148, v148, v164, v236
    v_fma_f32 v149, v149, v165, v237
    v_mfma_f32_32x32x16_bf16 v[80:95], a[40:43], v[36:39], v[80:95]
    v_fma_f32 v150, v150, v166, v238
    v_fma_f32 v151, v151, v167, v239
    v_cvt_pk_bf16_f32 v144, v144, v145
    s_waitcnt vmcnt(10)
    v_mfma_f32_32x32x16_bf16 v[96:111], a[52:55], v[40:43], v[96:111]
    buffer_load_dwordx4 v[168:171], v2, s[32:35], s10 offen offset:2048 sc1
    v_cvt_pk_bf16_f32 v145, v146, v147
    v_cvt_pk_bf16_f32 v146, v148, v149
    v_cvt_pk_bf16_f32 v147, v150, v151
    v_mfma_f32_32x32x16_bf16 v[80:95], a[48:51], v[40:43], v[80:95]
    s_waitcnt vmcnt(10)
    v_mfma_f32_32x32x16_bf16 v[96:111], a[60:63], v[44:47], v[96:111]
    buffer_store_dwordx4 v[144:147], v240, s[44:47], 0 offen
    v_mfma_f32_32x32x16_bf16 v[80:95], a[56:59], v[44:47], v[80:95]
    v_subrev_u32 v3, 114688, v3
    s_waitcnt vmcnt(10)
    v_mfma_f32_32x32x16_bf16 v[96:111], a[148:151], v[48:51], v[96:111]
    buffer_load_dwordx4 v[172:175], v2, s[32:35], s10 offen offset:3072 sc1
    v_subrev_u32 v4, 114688, v4
    v_mfma_f32_32x32x16_bf16 v[80:95], a[144:147], v[48:51], v[80:95]
    v_subrev_u32 v5, 114688, v5
    s_waitcnt vmcnt(10)
    v_mfma_f32_32x32x16_bf16 v[96:111], a[156:159], v[52:55], v[96:111]
    v_subrev_u32 v243, 114688, v243
    s_movk_i32 s79, 28672
    v_mfma_f32_32x32x16_bf16 v[80:95], a[152:155], v[52:55], v[80:95]
    s_waitcnt vmcnt(9)
    v_mfma_f32_32x32x16_bf16 v[96:111], a[164:167], v[56:59], v[96:111]
    v_mfma_f32_32x32x16_bf16 v[80:95], a[160:163], v[56:59], v[80:95]
    s_waitcnt vmcnt(8)
    v_mfma_f32_32x32x16_bf16 v[96:111], a[172:175], v[60:63], v[96:111]
    v_mfma_f32_32x32x16_bf16 v[80:95], a[168:171], v[60:63], v[80:95]
    s_waitcnt vmcnt(7)
    v_mfma_f32_32x32x16_bf16 v[96:111], a[180:183], v[64:67], v[96:111]
    v_mfma_f32_32x32x16_bf16 v[80:95], a[176:179], v[64:67], v[80:95]
    s_waitcnt vmcnt(6)
    v_mfma_f32_32x32x16_bf16 v[96:111], a[188:191], v[68:71], v[96:111]
    v_mfma_f32_32x32x16_bf16 v[80:95], a[184:187], v[68:71], v[80:95]
    s_waitcnt vmcnt(5)
    v_mfma_f32_32x32x16_bf16 v[96:111], a[196:199], v[72:75], v[96:111]
    v_mfma_f32_32x32x16_bf16 v[80:95], a[192:195], v[72:75], v[80:95]
    s_waitcnt vmcnt(3)
    v_mfma_f32_32x32x16_bf16 v[96:111], a[204:207], v[76:79], v[96:111]
    v_lshlrev_b32 v232, 16, v252
    v_and_b32 v233, s61, v252
    s_waitcnt vmcnt(2)
    v_mfma_f32_32x32x16_bf16 v[96:111], a[212:215], v[168:171], v[96:111]
    v_lshlrev_b32 v234, 16, v253
    v_and_b32 v235, s61, v253
    s_waitcnt vmcnt(0)
    v_mfma_f32_32x32x16_bf16 v[96:111], a[220:223], v[172:175], v[96:111]
    v_lshlrev_b32 v236, 16, v254
    v_and_b32 v237, s61, v254
    v_mfma_f32_32x32x16_bf16 v[80:95], a[200:203], v[76:79], v[80:95]
    v_lshlrev_b32 v238, 16, v255
    v_and_b32 v239, s61, v255
    v_mfma_f32_32x32x16_bf16 v[80:95], a[208:211], v[168:171], v[80:95]
    v_mfma_f32_32x32x16_bf16 v[80:95], a[216:219], v[172:175], v[80:95]
    s_nop 4
    ds_write_b128 v243, v[96:99] offset:2048
    ds_write_b128 v243, v[100:103] offset:3072
    ds_write_b128 v243, v[104:107] offset:4096
    ds_write_b128 v243, v[108:111] offset:5120
    s_nop 2
    ds_write_b128 v243, v[88:91] offset:0
    ds_write_b128 v243, v[92:95] offset:1024
    s_waitcnt lgkmcnt(0)
    s_barrier
    ds_read_b128 v[88:91], v3 offset:0
    ds_read_b128 v[92:95], v3 offset:1024
    ds_read_b128 v[96:99], v4 offset:0
    ds_read_b128 v[100:103], v4 offset:1024
    ds_read_b128 v[104:107], v5 offset:0
    ds_read_b128 v[108:111], v5 offset:1024
    s_waitcnt lgkmcnt(5)
    v_pk_add_f32 v[80:81], v[80:81], v[88:89]
    v_pk_add_f32 v[82:83], v[82:83], v[90:91]
    s_waitcnt lgkmcnt(4)
    v_pk_add_f32 v[84:85], v[84:85], v[92:93]
    v_pk_add_f32 v[86:87], v[86:87], v[94:95]
    s_waitcnt lgkmcnt(3)
    v_pk_add_f32 v[80:81], v[80:81], v[96:97]
    v_pk_add_f32 v[82:83], v[82:83], v[98:99]
    s_waitcnt lgkmcnt(2)
    v_pk_add_f32 v[84:85], v[84:85], v[100:101]
    v_pk_add_f32 v[86:87], v[86:87], v[102:103]
    s_waitcnt lgkmcnt(1)
    v_pk_add_f32 v[80:81], v[80:81], v[104:105]
    v_pk_add_f32 v[82:83], v[82:83], v[106:107]
    s_waitcnt lgkmcnt(0)
    v_pk_add_f32 v[84:85], v[84:85], v[108:109]
    v_pk_add_f32 v[86:87], v[86:87], v[110:111]
    v_pk_fma_f32 v[80:81], v[80:81], v[160:161], v[232:233]
    v_pk_fma_f32 v[82:83], v[82:83], v[162:163], v[234:235]
    v_pk_fma_f32 v[84:85], v[84:85], v[164:165], v[236:237]
    v_pk_fma_f32 v[86:87], v[86:87], v[166:167], v[238:239]
    v_cvt_pk_bf16_f32 v80, v80, v81
    v_cvt_pk_bf16_f32 v81, v82, v83
    v_cvt_pk_bf16_f32 v82, v84, v85
    v_cvt_pk_bf16_f32 v83, v86, v87
    buffer_store_dwordx4 v[80:83], v240, s[44:47], s79 offen
L_g2_done:
    s_cmp_eq_u32 s52, 255
    s_cbranch_scc0 L_fin
    s_cmp_eq_u32 s53, 0
    s_cbranch_scc0 L_fin
    s_mov_b32 s70, 0
    v_mov_b32 v9, s54
    s_mov_b64 exec, 1
    buffer_store_dword v9, off, s[32:35], s70 sc1
    s_mov_b64 exec, -1
L_fin:
L_end:
    s_endpgm
L_f4c_w:
    s_mov_b32 s62, 20000
    buffer_load_dword v9, v12, s[32:35], 0 offen offset:128 sc1
L_f4c_33:
    s_waitcnt vmcnt(0)
    v_cmp_ne_u32_e64 vcc, s54, v9
    s_cbranch_vccz L_f4c_33_ok
    s_sub_u32 s62, s62, 1
    s_cbranch_scc1 L_f4c_33_ok
    buffer_load_dword v9, v12, s[32:35], 0 offen offset:128 sc1
    s_branch L_f4c_33
L_f4c_33_ok:
    s_branch L_f4c_ok
L_f4b_w:
    s_mov_b32 s62, 20000
    buffer_load_dword v10, v12, s[32:35], s13 offen offset:128 sc1
L_f4b_34:
    s_waitcnt vmcnt(0)
    v_cmp_ne_u32 vcc, s54, v10
    s_cbranch_vccz L_f4b_34_ok
    s_sub_u32 s62, s62, 1
    s_cbranch_scc1 L_f4b_34_ok
    buffer_load_dword v10, v12, s[32:35], s13 offen offset:128 sc1
    s_branch L_f4b_34
L_f4b_34_ok:
    s_branch L_f4b_ok
L_f4a_w:
    s_mov_b32 s62, 20000
    buffer_load_dword v9, v12, s[32:35], 0 offen offset:0 sc1
L_f4a_35:
    s_waitcnt vmcnt(0)
    v_cmp_ne_u32 vcc, s54, v9
    s_cbranch_vccz L_f4a_35_ok
    s_sub_u32 s62, s62, 1
    s_cbranch_scc1 L_f4a_35_ok
    buffer_load_dword v9, v12, s[32:35], 0 offen offset:0 sc1
    s_branch L_f4a_35
L_f4a_35_ok:
    s_branch L_f4a_ok
L_wofl_w:
    s_mov_b32 s62, 20000
    buffer_load_dword v232, v231, s[32:35], 0 offen sc1
L_wofl_36:
    s_waitcnt vmcnt(0)
    v_cmp_ne_u32 vcc, s54, v232
    s_cbranch_vccz L_wofl_36_ok
    s_sub_u32 s62, s62, 1
    s_cbranch_scc1 L_wofl_36_ok
    buffer_load_dword v232, v231, s[32:35], 0 offen sc1
    s_branch L_wofl_36
L_wofl_36_ok:
    s_branch L_wofl_ok
L_fnc_w:
    s_mov_b32 s62, 20000
    buffer_load_dword v9, v254, s[32:35], 0 offen sc1
L_fnc_37:
    s_waitcnt vmcnt(0)
    v_cmp_ne_u32 vcc, s54, v9
    s_cbranch_vccz L_fnc_37_ok
    s_sub_u32 s62, s62, 1
    s_cbranch_scc1 L_fnc_37_ok
    buffer_load_dword v9, v254, s[32:35], 0 offen sc1
    s_branch L_fnc_37
L_fnc_37_ok:
    s_branch L_fnc_ok
L_nc2_w:
    s_mov_b32 s62, 20000
    buffer_load_dword v10, v233, s[32:35], 0 offen sc1
L_nc2_38:
    s_waitcnt vmcnt(0)
    v_xor_b32 v10, v10, v234
    v_and_b32 v11, 0xff, v10
    v_cmp_ne_u32 vcc, 0, v11
    s_cbranch_vccz L_nc2_38_ok
    s_sub_u32 s62, s62, 1
    s_cbranch_scc1 L_nc2_38_ok
    buffer_load_dword v10, v233, s[32:35], 0 offen sc1
    s_branch L_nc2_38
L_nc2_38_ok:
    s_branch L_nc2_ok
L_fk7_w:
    s_mov_b32 s62, 20000
    buffer_load_dword v9, v230, s[32:35], 0 offen sc1
L_fk7_39:
    s_waitcnt vmcnt(0)
    v_cmp_ne_u32_e64 vcc, s54, v9
    s_nop 0
    s_or_b32 vcc_lo, vcc_lo, vcc_hi
    s_and_b64 vcc, vcc, 16352
    s_cbranch_vccz L_fk7_39_ok
    s_sub_u32 s62, s62, 1
    s_cbranch_scc1 L_fk7_39_ok
    buffer_load_dword v9, v230, s[32:35], 0 offen sc1
    s_branch L_fk7_39
L_fk7_39_ok:
    s_branch L_fk7_ok
L_fk4_w:
    s_mov_b32 s62, 20000
    buffer_load_dword v9, v230, s[32:35], 0 offen sc1
L_fk4_40:
    s_waitcnt vmcnt(0)
    v_cmp_ne_u32 vcc, s54, v9
    s_nop 0
    s_or_b32 vcc_lo, vcc_lo, vcc_hi
    s_and_b64 vcc, vcc, 28
    s_cbranch_vccz L_fk4_40_ok
    s_sub_u32 s62, s62, 1
    s_cbranch_scc1 L_fk4_40_ok
    buffer_load_dword v9, v230, s[32:35], 0 offen sc1
    s_branch L_fk4_40
L_fk4_40_ok:
    s_branch L_fk4_ok
L_fk2_w:
    s_mov_b32 s62, 20000
    buffer_load_dword v9, v230, s[32:35], 0 offen sc1
L_fk2_41:
    s_waitcnt vmcnt(0)
    v_cmp_ne_u32 vcc, s54, v9
    s_nop 0
    s_or_b32 vcc_lo, vcc_lo, vcc_hi
    s_and_b64 vcc, vcc, 3
    s_cbranch_vccz L_fk2_41_ok
    s_sub_u32 s62, s62, 1
    s_cbranch_scc1 L_fk2_41_ok
    buffer_load_dword v9, v230, s[32:35], 0 offen sc1
    s_branch L_fk2_41
L_fk2_41_ok:
    s_branch L_fk2_ok
L_truemax:
    s_mov_b32 s63, 1
    s_waitcnt vmcnt(0) lgkmcnt(0)
    s_nop 7
    v_mov_b32 v241, s54
    v_mov_b32 v14, 1879048192
    v_mov_b32 v251, 0xff
    v_mov_b32 v8, v14
    v_writelane_b32 v8, 0, 0
    v_cmp_gt_u32 vcc, 28, v1
    v_lshlrev_b32 v10, 7, v1
    v_and_b32 v252, 7, v1
    v_cndmask_b32 v7, v14, v10, vcc
    v_lshrrev_b32 v253, 3, v1
    v_and_b32_e64 v254, 15, v1
    v_lshrrev_b32 v255, 4, v1
    s_lshr_b32 s70, s52, 2
    s_and_b32 s71, s52, 1
    s_lshl_b32 s72, s70, 7
    s_mul_i32 s73, s71, 28
    s_add_u32 s72, s72, s73
    s_add_u32 s72, s72, 65536
    v_min_u32 v10, 6, v252
    v_lshl_add_u32 v229, v10, 2, s72
    s_lshl_b32 s72, s55, 3
    s_add_u32 s72, s72, s53
    s_lshl_b32 s73, s72, 12
    s_add_u32 s4, s73, 524288
    s_add_u32 s5, s73, 540672
    s_lshl_b32 s72, s72, 7
    s_add_u32 s72, s72, 65592
    v_and_b32 v10, 1, v1
    v_lshl_add_u32 v10, v10, 2, s72
    v_bfe_u32 v11, v1, 1, 1
    v_cmp_eq_u32 vcc, 1, v255
    v_lshl_add_u32 v10, v11, 9, v10
    s_nop 0
    v_cndmask_b32 v229, v229, v10, vcc
    v_and_b32 v10, 1, v255
    v_mul_u32_u24 v10, 896, v10
    v_lshrrev_b32_e64 v11, 5, v1
    v_lshl_add_u32 v10, v11, 8, v10
    v_lshl_add_u32 v232, v254, 3, v10
    v_add_u32 v2, 4096, v13
    v_add_u32 v10, s56, v254
    v_mul_u32_u24 v11, 4682, v10
    v_lshrrev_b32 v11, 16, v11
    v_mul_u32_u24 v11, 14, v11
    v_sub_u32 v10, v10, v11
    s_lshl_b32 s72, s55, 1
    s_add_u32 s72, s72, 2
    v_add_u32_e64 v10, s72, v10
    v_and_b32 v10, 15, v10
    s_lshl_b32 s72, s53, 8
    s_add_u32 s72, s72, 16384
    v_lshl_add_u32 v10, v10, 10, s72
    v_lshrrev_b32_e64 v11, 5, v1
    v_lshl_add_u32 v230, v11, 7, v10
    s_and_b32 s73, s52, 1
    s_mul_i32 s72, s53, 7
    s_mul_i32 s73, s73, 896
    s_add_u32 s73, s73, 32768
    v_min_u32 v10, 6, v253
    v_min_u32 v11, 6, v252
    v_add_u32 v10, s72, v10
    v_lshrrev_b32 v10, 2, v10
    v_mul_u32_u24 v10, 14, v10
    v_add_u32 v10, v10, v11
    v_lshl_add_u32 v231, v10, 7, s73
    v_and_b32 v10, 1, v255
    v_mul_u32_u24 v10, 56, v10
    v_lshrrev_b32_e64 v11, 5, v1
    v_lshl_add_u32 v10, v11, 4, v10
    s_mul_i32 s72, s53, 112
    s_add_u32 s72, s72, 154624
    v_mul_u32_u24 v11, 480, v254
    v_add3_u32 v242, v10, v11, s72
    v_lshl_add_u32 v11, v255, 4, v11
    v_add_u32 v243, 154624, v11
    s_lshr_b32 s72, s52, 3
    s_mul_i32 s72, s72, 3584
    s_and_b32 s73, s52, 7
    s_lshl_b32 s73, s73, 6
    s_add_u32 s72, s72, s73
    s_and_b32 s73, s52, 1
    s_lshl_b32 s73, s73, 5
    s_add_u32 s72, s72, s73
    s_add_u32 s72, s72, 133120
    s_cmp_eq_u32 s67, 3
    s_cselect_b32 s72, s72, 1879048192
    v_lshl_add_u32 v10, v253, 9, s72
    v_lshl_add_u32 v10, v252, 2, v10
    v_and_b32 v11, 3, v1
    v_lshlrev_b32 v11, 3, v11
    v_lshrrev_b32 v11, v11, s54
    v_cmp_gt_u32 vcc, 56, v1
    v_and_b32 v11, 0xff, v11
    s_nop 0
    v_cndmask_b32 v233, v14, v10, vcc
    v_cndmask_b32 v234, 0, v11, vcc
    v_cmp_gt_u32_e64 vcc, 56, v1
    s_mul_i32 s72, s52, 7168
    s_mul_i32 s73, s53, 224
    s_and_b32 s71, s52, 1
    s_add_u32 s72, s72, s73
    v_mul_u32_u24 v10, 896, v252
    v_lshl_add_u32 v10, v253, 5, v10
    v_add_u32_e64 v10, s72, v10
    v_cndmask_b32 v240, v14, v10, vcc
    s_lshl_b32 s73, s73, 1
    s_add_u32 s73, s73, 147456
    v_lshl_add_u32 v247, v253, 6, s73
    s_lshl_b32 s74, s53, 13
    s_add_u32 s74, s74, 118784
    v_lshlrev_b32 v10, 4, v252
    v_lshl_add_u32 v11, v253, 8, v10
    v_cndmask_b32 v248, v14, v11, vcc
    v_lshl_add_u32 v11, v253, 9, v10
    v_cndmask_b32 v245, v14, v11, vcc
    v_add_u32 v246, s74, v11
    v_and_b32 v11, 1, v253
    v_cmp_eq_u32 vcc, s71, v11
    v_lshl_add_u32 v11, v255, 7, v10
    v_add_u32 v244, s74, v11
    v_cndmask_b32 v239, v11, v14, vcc
    v_subrev_u32 v10, 4096, v244
    v_cndmask_b32 v244, v10, v244, vcc
    v_lshlrev_b32 v10, 5, v252
    v_add_u32 v250, 162880, v10
    s_lshl_b32 s72, s53, 3
    v_add_u32_e64 v249, s72, v250
    s_mul_i32 s72, s53, 12288
    s_add_u32 s72, s72, 98304
    v_add_u32_e64 v235, s72, v13
    s_add_u32 s72, s53, 3
    s_and_b32 s72, s72, 3
    s_mul_i32 s72, s72, 12288
    s_add_u32 s72, s72, 98304
    v_add_u32_e64 v236, s72, v13
    s_add_u32 s72, s53, 2
    s_and_b32 s72, s72, 3
    s_mul_i32 s72, s72, 12288
    s_add_u32 s72, s72, 102400
    v_add_u32_e64 v237, s72, v13
    s_add_u32 s72, s53, 1
    s_and_b32 s72, s72, 3
    s_mul_i32 s72, s72, 12288
    s_add_u32 s72, s72, 106496
    v_add_u32 v238, s72, v13
    s_and_b32 s72, s53, 1
    s_lshl_b32 s72, s72, 2
    v_and_b32 v10, 2, v253
    v_xor_b32 v10, v10, v252
    v_xor_b32 v10, s72, v10
    v_mul_u32_u24 v11, 3584, v253
    v_lshl_add_u32 v3, v10, 4, v11
    v_add_u32 v4, 56320, v3
    v_add_u32 v5, 112640, v3
    v_add_u32 v6, 168960, v3
    v_cmp_gt_u32_e64 vcc, 8, v1
    s_lshl_b32 s72, s52, 5
    s_add_u32 s72, s72, 130048
    s_cmp_eq_u32 s67, 3
    s_cselect_b32 s72, s72, 1879048192
    v_lshl_add_u32 v10, v1, 2, s72
    v_cndmask_b32 v12, v14, v10, vcc
    v_cmp_gt_u32 vcc, 56, v1
    s_mul_i32 s72, s53, 1792
    s_add_u32 s72, s72, 50176
    s_lshl_b32 s73, s53, 8
    s_add_u32 s73, s73, 47360
    v_mov_b32 v10, s72
    v_mov_b32 v11, s73
    v_cndmask_b32 v10, v11, v10, vcc
    v_cmp_gt_u32 vcc, 32, v1
    v_lshl_add_u32 v254, v1, 5, v10
    v_lshlrev_b32 v10, 2, v1
    v_cndmask_b32_e64 v255, v14, v10, vcc
    s_add_u32 s81, s53, 1
    s_and_b32 s81, s81, 3
    s_mul_i32 s44, s81, 1792
    s_add_u32 s81, s53, 2
    s_and_b32 s81, s81, 3
    s_mul_i32 s45, s81, 1792
    s_add_u32 s81, s53, 3
    s_and_b32 s81, s81, 3
    s_mul_i32 s46, s81, 1792
    s_add_u32 s81, s53, 4
    s_and_b32 s81, s81, 3
    s_mul_i32 s47, s81, 1792
    s_lshr_b32 s81, s52, 2
    s_lshl_b32 s81, s81, 1
    s_add_u32 s81, s81, s53
    s_lshl_b32 s81, s81, 7
    s_add_u32 s12, s81, 16128
    s_and_b32 s81, s52, 3
    s_lshl_b32 s81, s81, 2
    s_add_u32 s81, s81, s53
    s_cmp_ge_u32 s81, 14
    s_cselect_b32 s12, s12, 1879048192
    s_lshl_b32 s81, s52, 5
    s_add_u32 s30, s81, 49152
    s_cmp_eq_u32 s53, 3
    s_cselect_b32 s30, s30, 1879048192
    s_mul_i32 s9, s53, 3584
    s_add_u32 s9, s9, 16777216
    s_xor_b32 s78, s52, 1
    s_mul_i32 s78, s78, 21504
    s_add_u32 s78, s78, s9
    s_mul_i32 s3, s52, 21504
    s_add_u32 s3, s3, s9
    s_movk_i32 s31, 14336
    s_lshr_b32 s81, s53, 1
    s_mul_i32 s81, s81, 28672
    s_lshl_b32 s66, s56, 7
    s_add_u32 s66, s66, s81
    s_cmp_lt_u32 s56, 28
    s_cselect_b32 s66, s66, 1879048192
    s_mul_i32 s79, s53, 1792
    s_sub_u32 s81, s52, 144
    s_cmp_lt_u32 s81, 56
    s_cselect_b32 s80, 1.0, 0
    s_add_u32 s69, s56, 0
    s_lshr_b32 s69, s69, 2
    s_min_u32 s69, s69, 7
    s_sub_u32 s69, s56, s69
    s_mul_i32 s77, s55, 25
    s_add_u32 s69, s69, s77
    s_bitcmp1_b32 0x8888888, s56
    s_cselect_b32 s69, 196, s69
    s_min_u32 s69, s69, 196
    s_lshl_b32 s77, s69, 13
    s_lshl_b32 s68, s53, 11
    s_and_b32 s68, s68, 4096
    s_add_u32 s68, s68, s77
    v_lshlrev_b32_e64 v7, 5, v255
    s_lshl_b32 s77, s69, 2
    s_add_u32 s77, s77, s53
    s_mul_i32 s81, s77, 9363
    s_lshr_b32 s81, s81, 16
    s_mul_i32 s10, s81, 7
    s_sub_u32 s77, s77, s10
    s_mul_i32 s23, s81, 14336
    s_lshl_b32 s10, s77, 7
    s_add_u32 s23, s23, s10
    s_mul_i32 s77, s77, 112
    s_add_u32 s77, s77, s81
    s_lshl_b32 s77, s77, 11
    s_add_u32 s24, s77, 13631488
    s_cmp_lt_u32 s69, 196
    s_cselect_b32 s24, s24, 1879048192
    s_mul_i32 s81, s81, 2341
    s_lshr_b32 s81, s81, 16
    v_and_b32 v10, 2, v253
    v_xor_b32 v10, s81, v10
    v_lshlrev_b32 v10, 1, v10
    v_xor_b32_e64 v10, v10, v252
    v_mul_u32_u24 v11, 896, v253
    v_lshl_add_u32 v212, v10, 4, v11
    v_add_u32 v213, 6144, v212
    s_lshl_b32 s77, s53, 11
    s_add_u32 s77, s77, 147456
    v_and_b32 v10, 1, v1
    v_lshl_add_u32 v10, v10, 4, s77
    v_and_b32 v11, 2, v1
    v_lshl_add_u32 v10, v11, 2, v10
    v_and_b32 v11, 12, v1
    v_lshl_add_u32 v10, v11, 5, v10
    v_and_b32 v11, 8, v1
    v_lshl_add_u32 v10, v11, 3, v10
    v_and_b32 v11, 16, v1
    v_lshl_add_u32 v10, v11, 1, v10
    v_and_b32 v11, 32, v1
    v_lshl_add_u32 v214, v11, 5, v10
    v_xor_b32 v215, 64, v214
    v_mov_b32 v48, 0xff800000
    v_mov_b32 v49, 0xff800000
    v_mov_b32 v50, 0xff800000
    v_mov_b32 v51, 0xff800000
    s_lshl_b32 s70, s53, 12
    s_add_u32 s70, s70, 262144
L_tm_loop:
    buffer_load_dwordx4 a[0:3], v13, s[32:35], s70 offen offset:0 sc1
    buffer_load_dwordx4 a[4:7], v13, s[32:35], s70 offen offset:1024 sc1
    s_waitcnt vmcnt(1)
    v_mfma_f32_32x32x16_bf16 v[144:159], a[0:3], v[64:67], 0
    s_waitcnt vmcnt(0)
    v_mfma_f32_32x32x16_bf16 v[144:159], a[4:7], v[68:71], v[144:159]
    v_mfma_f32_32x32x16_bf16 v[160:175], a[0:3], v[72:75], 0
    v_mfma_f32_32x32x16_bf16 v[160:175], a[4:7], v[76:79], v[160:175]
    v_mfma_f32_32x32x16_bf16 v[176:191], a[0:3], v[80:83], 0
    v_mfma_f32_32x32x16_bf16 v[176:191], a[4:7], v[84:87], v[176:191]
    v_mfma_f32_32x32x16_bf16 v[192:207], a[0:3], v[88:91], 0
    v_mfma_f32_32x32x16_bf16 v[192:207], a[4:7], v[92:95], v[192:207]
    s_nop 5
    v_max3_f32 v48, v48, v144, v145
    v_max3_f32 v48, v48, v146, v147
    v_max3_f32 v48, v48, v148, v149
    v_max3_f32 v48, v48, v150, v151
    v_max3_f32 v48, v48, v152, v153
    v_max3_f32 v48, v48, v154, v155
    v_max3_f32 v48, v48, v156, v157
    v_max3_f32 v48, v48, v158, v159
    v_max3_f32 v49, v49, v160, v161
    v_max3_f32 v49, v49, v162, v163
    v_max3_f32 v49, v49, v164, v165
    v_max3_f32 v49, v49, v166, v167
    v_max3_f32 v49, v49, v168, v169
    v_max3_f32 v49, v49, v170, v171
    v_max3_f32 v49, v49, v172, v173
    v_max3_f32 v49, v49, v174, v175
    v_max3_f32 v50, v50, v176, v177
    v_max3_f32 v50, v50, v178, v179
    v_max3_f32 v50, v50, v180, v181
    v_max3_f32 v50, v50, v182, v183
    v_max3_f32 v50, v50, v184, v185
    v_max3_f32 v50, v50, v186, v187
    v_max3_f32 v50, v50, v188, v189
    v_max3_f32 v50, v50, v190, v191
    v_max3_f32 v51, v51, v192, v193
    v_max3_f32 v51, v51, v194, v195
    v_max3_f32 v51, v51, v196, v197
    v_max3_f32 v51, v51, v198, v199
    v_max3_f32 v51, v51, v200, v201
    v_max3_f32 v51, v51, v202, v203
    v_max3_f32 v51, v51, v204, v205
    v_max3_f32 v51, v51, v206, v207
    s_add_u32 s70, s70, 0x4000
    s_cmp_lt_u32 s70, 524288
    s_cbranch_scc1 L_tm_loop
    v_and_b32 v10, 31, v1
    v_lshlrev_b32 v10, 4, v10
    s_lshl_b32 s71, s53, 2
    s_barrier
    v_mov_b32 v52, v48
    s_nop 1
    v_permlane32_swap_b32 v52, v48
    v_max_f32 v48, v48, v52
    s_add_u32 s70, s53, 1
    s_and_b32 s70, s70, 3
    s_lshl_b32 s70, s70, 9
    s_add_u32 s70, s70, 154624
    v_add_u32 v56, s70, v10
    v_add_u32 v11, s71, v56
    ds_write_b32 v11, v48
    v_mov_b32 v52, v49
    s_nop 1
    v_permlane32_swap_b32 v52, v49
    v_max_f32 v49, v49, v52
    s_add_u32 s70, s53, 2
    s_and_b32 s70, s70, 3
    s_lshl_b32 s70, s70, 9
    s_add_u32 s70, s70, 154624
    v_add_u32 v57, s70, v10
    v_add_u32 v11, s71, v57
    ds_write_b32 v11, v49
    v_mov_b32 v52, v50
    s_nop 1
    v_permlane32_swap_b32 v52, v50
    v_max_f32 v50, v50, v52
    s_add_u32 s70, s53, 3
    s_and_b32 s70, s70, 3
    s_lshl_b32 s70, s70, 9
    s_add_u32 s70, s70, 154624
    v_add_u32 v58, s70, v10
    v_add_u32 v11, s71, v58
    ds_write_b32 v11, v50
    v_mov_b32 v52, v51
    s_nop 1
    v_permlane32_swap_b32 v52, v51
    v_max_f32 v51, v51, v52
    s_add_u32 s70, s53, 4
    s_and_b32 s70, s70, 3
    s_lshl_b32 s70, s70, 9
    s_add_u32 s70, s70, 154624
    v_add_u32 v59, s70, v10
    v_add_u32_e64 v11, s71, v59
    ds_write_b32 v11, v51
    s_waitcnt lgkmcnt(0)
    s_barrier
    ds_read_b128 v[144:147], v56
    ds_read_b128 v[148:151], v57
    ds_read_b128 v[152:155], v58
    ds_read_b128 v[156:159], v59
    s_mov_b32 exec_lo, 0
    s_waitcnt lgkmcnt(3)
    v_max3_f32 v144, v144, v145, v146
    v_max_f32 v144, v144, v147
    v_and_b32 v145, s61, v144
    v_sub_f32 v144, v144, v145
    v_and_b32 v146, s61, v144
    v_sub_f32_e64 v144, v144, v146
    v_cvt_pk_bf16_f32 v70, -v145, -v146
    v_cvt_pk_bf16_f32 v71, -v144, 0
    s_waitcnt lgkmcnt(2)
    v_max3_f32 v148, v148, v149, v150
    v_max_f32 v148, v148, v151
    v_and_b32 v149, s61, v148
    v_sub_f32 v148, v148, v149
    v_and_b32 v150, s61, v148
    v_sub_f32 v148, v148, v150
    v_cvt_pk_bf16_f32 v78, -v149, -v150
    v_cvt_pk_bf16_f32 v79, -v148, 0
    s_waitcnt lgkmcnt(1)
    v_max3_f32 v152, v152, v153, v154
    v_max_f32 v152, v152, v155
    v_and_b32 v153, s61, v152
    v_sub_f32 v152, v152, v153
    v_and_b32 v154, s61, v152
    v_sub_f32 v152, v152, v154
    v_cvt_pk_bf16_f32 v86, -v153, -v154
    v_cvt_pk_bf16_f32 v87, -v152, 0
    s_waitcnt lgkmcnt(0)
    v_max3_f32 v156, v156, v157, v158
    v_max_f32 v156, v156, v159
    v_and_b32 v157, s61, v156
    v_sub_f32 v156, v156, v157
    v_and_b32_e64 v158, s61, v156
    v_sub_f32 v156, v156, v158
    v_cvt_pk_bf16_f32 v94, -v157, -v158
    v_cvt_pk_bf16_f32 v95, -v156, 0
    s_mov_b32 exec_lo, -1
    buffer_load_dwordx4 a[0:3], v13, s[32:35], s4 offen offset:0 sc1
    buffer_load_dwordx4 a[4:7], v13, s[32:35], s4 offen offset:1024 sc1
    buffer_load_dwordx4 a[8:11], v13, s[32:35], s4 offen offset:2048 sc1
    buffer_load_dwordx4 a[12:15], v13, s[32:35], s4 offen offset:3072 sc1
    buffer_load_dwordx4 a[16:19], v13, s[32:35], s5 offen offset:0 sc1
    buffer_load_dwordx4 a[20:23], v13, s[32:35], s5 offen offset:1024 sc1
    buffer_load_dwordx4 a[24:27], v13, s[32:35], s5 offen offset:2048 sc1
    buffer_load_dwordx4 a[28:31], v13, s[32:35], s5 offen offset:3072 sc1
    v_mov_b32 v188, 1879048192
    v_mov_b32 v228, 1879048192
    s_mul_i32 s70, s53, 100352
    s_and_b32 s81, s52, 1
    s_mul_i32 s81, s81, 7168
    s_add_u32 s70, s70, s81
    s_add_u32 s70, s70, 4718592
    s_add_u32 s71, s70, s31
    s_add_u32 s72, s71, s31
    s_add_u32 s73, s72, s31
    s_add_u32 s74, s73, s31
    s_add_u32 s75, s74, s31
    s_add_u32 s76, s75, s31
    s_lshl_b32 s81, s53, 11
    s_add_u32 m0, s81, 147456
    v_lshlrev_b32_e64 v15, 4, v230
    s_waitcnt vmcnt(0)
    v_mfma_f32_32x32x16_bf16 v[16:31], a[0:3], v[64:67], 0
    v_mfma_f32_32x32x16_bf16 v[16:31], a[4:7], v[68:71], v[16:31]
    s_nop 15
    s_branch L_att_main
L_d1_w:
    s_mov_b32 s62, 20000
    buffer_load_dwordx4 v[128:131], v183, s[32:35], 0 offen offset:0 sc1
    buffer_load_dwordx4 v[132:135], v183, s[32:35], 0 offen offset:128 sc1
    buffer_load_dwordx4 v[136:139], v183, s[32:35], 0 offen offset:256 sc1
    buffer_load_dwordx4 v[140:143], v183, s[32:35], 0 offen offset:384 sc1
    buffer_load_dword v144, v184, s[32:35], 0 offen sc1
L_d1_42:
    s_waitcnt vmcnt(0)
    v_xor_b32 v144, s54, v144
    v_cmp_lt_u32 s[70:71], 15, v144
    v_xor_b32 v128, s57, v128
    v_xor_b32 v129, s58, v129
    v_xor_b32 v130, s59, v130
    v_xor_b32 v131, s60, v131
    v_xor_b32 v132, s57, v132
    v_xor_b32 v133, s58, v133
    v_xor_b32 v134, s59, v134
    v_xor_b32 v135, s60, v135
    v_xor_b32 v136, s57, v136
    v_xor_b32 v137, s58, v137
    v_xor_b32 v138, s59, v138
    v_xor_b32 v139, s60, v139
    v_xor_b32 v140, s57, v140
    v_xor_b32 v141, s58, v141
    v_xor_b32 v142, s59, v142
    v_xor_b32 v143, s60, v143
    v_or_b32_e64 v145, v128, v129
    v_or3_b32 v145, v145, v130, v131
    v_or3_b32 v145, v145, v132, v133
    v_or3_b32 v145, v145, v134, v135
    v_or3_b32 v145, v145, v136, v137
    v_or3_b32 v145, v145, v138, v139
    v_or3_b32 v145, v145, v140, v141
    v_or3_b32 v145, v145, v142, v143
    v_and_b32 v145, 0xff, v145
    v_cmp_ne_u32_e64 vcc, 0, v145
    s_nop 0
    s_or_b64 vcc, vcc, s[70:71]
    s_cbranch_vccz L_d1_42_ok
    s_sub_u32 s62, s62, 1
    s_cbranch_scc1 L_d1_42_ok
    buffer_load_dwordx4 v[128:131], v183, s[32:35], 0 offen offset:0 sc1
    buffer_load_dwordx4 v[132:135], v183, s[32:35], 0 offen offset:128 sc1
    buffer_load_dwordx4 v[136:139], v183, s[32:35], 0 offen offset:256 sc1
    buffer_load_dwordx4 v[140:143], v183, s[32:35], 0 offen offset:384 sc1
    buffer_load_dword v144, v184, s[32:35], 0 offen sc1
    s_branch L_d1_42
L_d1_42_ok:
    s_branch L_d1_ok
L_st_5_g:
    s_nop 4
    buffer_store_dwordx2 v[24:25], v181, s[32:35], s70 offen offset:0 sc1
    buffer_store_dwordx2 v[26:27], v181, s[32:35], s70 offen offset:128 sc1
    buffer_store_dwordx2 v[28:29], v181, s[32:35], s70 offen offset:512 sc1
    buffer_store_dwordx2 v[30:31], v181, s[32:35], s70 offen offset:640 sc1
    s_branch L_st_5_j
L_st_6_g:
    s_nop 4
    buffer_store_dwordx4 v[24:27], v13, s[32:35], s74 offen sc1
    buffer_store_dwordx4 v[28:31], v13, s[32:35], s74 offen offset:1024 sc1
    s_branch L_st_6_j
L_st_7_g:
    s_nop 4
    buffer_store_dword v241, v8, s[32:35], s75 offen sc1
    s_branch L_st_7_j
L_st_9_g:
    s_nop 4
    buffer_load_dwordx4 v13, s[32:35], s70 offen sc1 lds
    buffer_load_dwordx4 v13, s[32:35], s71 offen offset:1024 sc1 lds
    s_branch L_st_9_j
L_st_10_g:
    s_nop 4
    buffer_load_dwordx4 a[0:3], v13, s[32:35], s4 offen offset:0 sc1
    buffer_load_dwordx4 a[4:7], v13, s[32:35], s4 offen offset:1024 sc1
    buffer_load_dwordx4 a[8:11], v13, s[32:35], s4 offen offset:2048 sc1
    buffer_load_dwordx4 a[12:15], v13, s[32:35], s4 offen offset:3072 sc1
    s_branch L_st_10_j
L_st_11_g:
    s_nop 4
    buffer_store_dwordx4 v[252:255], v245, s[32:35], s78 offen offset:0 sc1
    buffer_store_dwordx4 v[252:255], v245, s[32:35], s78 offen offset:128 sc1
    s_branch L_st_11_j
L_st_12_g:
    s_nop 4
    buffer_store_dwordx4 v[252:255], v245, s[32:35], s78 offen offset:256 sc1
    buffer_store_dwordx4 v[252:255], v245, s[32:35], s78 offen offset:384 sc1
    s_branch L_st_12_j
L_st_14_g:
    s_nop 4
    buffer_store_dwordx4 v[16:19], v239, s[32:35], s78 offen offset:0 sc1
    v_mfma_f32_16x16x32_bf16 v[32:35], a[244:247], v[148:151], v[32:35]
    v_mfma_f32_16x16x32_bf16 v[28:31], a[220:223], v[152:155], v[28:31]
    ds_write_b128 v244, v[16:19] offset:0
    v_mfma_f32_16x16x32_bf16 v[32:35], a[248:251], v[152:155], v[32:35]
    v_mfma_f32_16x16x32_bf16 v[28:31], a[224:227], v[156:159], v[28:31]
    buffer_store_dwordx4 v[20:23], v239, s[32:35], s78 offen offset:512 sc1
    v_mfma_f32_16x16x32_bf16 v[32:35], a[252:255], v[156:159], v[32:35]
    v_mfma_f32_16x16x32_bf16 v[28:31], a[228:231], v[160:163], v[28:31]
    ds_write_b128 v244, v[20:23] offset:512
    v_mfma_f32_16x16x32_bf16 v[32:35], v[208:211], v[160:163], v[32:35]
    v_mfma_f32_16x16x32_bf16 v[28:31], a[232:235], v[164:167], v[28:31]
    buffer_store_dwordx4 v[24:27], v239, s[32:35], s78 offen offset:1024 sc1
    s_branch L_st_14_j
L_st_15_g:
    s_nop 4
    s_nop 0
    buffer_store_dwordx4 v[28:31], v239, s[32:35], s78 offen offset:1536 sc1
    v_mfma_f32_16x16x32_bf16 v[40:43], v[120:123], v[148:151], v[40:43]
    v_mfma_f32_16x16x32_bf16 v[36:39], v[96:99], v[152:155], v[36:39]
    ds_write_b128 v244, v[28:31] offset:1536
    v_mfma_f32_16x16x32_bf16 v[40:43], v[124:127], v[152:155], v[40:43]
    v_mfma_f32_16x16x32_bf16 v[36:39], v[100:103], v[156:159], v[36:39]
    buffer_store_dwordx4 v[32:35], v239, s[32:35], s78 offen offset:2048 sc1
    s_branch L_st_15_j
L_st_16_g:
    s_nop 4
    s_nop 0
    buffer_store_dwordx4 v[36:39], v239, s[32:35], s78 offen offset:2560 sc1
    buffer_store_dwordx4 v[40:43], v239, s[32:35], s78 offen offset:3072 sc1
    s_branch L_st_16_j
L_st_18_g:
    s_nop 4
    buffer_store_dwordx4 v[16:19], v248, s[32:35], s3 offen offset:1792 nt sc1
    buffer_store_dwordx4 v[20:23], v248, s[32:35], s3 offen offset:1920 nt sc1
    s_branch L_st_18_j
L_st_19_g:
    s_nop 4
    buffer_store_dwordx4 v[24:27], v248, s[32:35], s3 offen offset:0 sc1
    v_pk_fma_f32 v[80:81], v[120:121], v[48:49], v[80:81] op_sel_hi:[1,0,1]
    v_pk_fma_f32 v[82:83], v[122:123], v[48:49], v[82:83] op_sel_hi:[1,0,1]
    v_pk_fma_f32 v[84:85], v[124:125], v[48:49], v[84:85] op_sel_hi:[1,0,1]
    v_pk_fma_f32 v[86:87], v[126:127], v[48:49], v[86:87] op_sel_hi:[1,0,1]
    v_pk_fma_f32 v[80:81], v[80:81], v[46:47], v[136:137] op_sel_hi:[1,0,1]
    v_pk_fma_f32 v[82:83], v[82:83], v[46:47], v[138:139] op_sel_hi:[1,0,1]
    v_pk_fma_f32 v[84:85], v[84:85], v[46:47], v[140:141] op_sel_hi:[1,0,1]
    v_pk_fma_f32 v[86:87], v[86:87], v[46:47], v[142:143] op_sel_hi:[1,0,1]
    v_cvt_pk_bf16_f32 v28, v80, v81
    v_cvt_pk_bf16_f32 v29, v82, v83
    v_cvt_pk_bf16_f32 v30, v84, v85
    v_cvt_pk_bf16_f32 v31, v86, v87
    buffer_store_dwordx4 v[28:31], v248, s[32:35], s3 offen offset:128 sc1
    s_branch L_st_19_j
L_st_20_g:
    s_nop 4
    buffer_store_dword v241, v8, s[32:35], s25 offen sc1
    s_branch L_st_20_j
L_idle:
    s_waitcnt vmcnt(0)
    s_lshl_b32 s70, s55, 2
    s_add_u32 s70, s70, s56
    s_sub_u32 s70, s70, 28
    s_mul_i32 s70, s70, 229376
    s_mul_i32 s71, s53, 28672
    s_add_u32 s70, s70, s71
    s_add_u32 s70, s70, 5242880
    v_lshlrev_b32_e64 v2, 7, v1
    s_mov_b32 exec_hi, 0xffffff
    buffer_load_dword v16, v2, s[32:35], s70 offen sc1
    s_add_u32 s70, s70, 7168
    buffer_load_dword v17, v2, s[32:35], s70 offen sc1
    s_add_u32 s70, s70, 7168
    buffer_load_dword v18, v2, s[32:35], s70 offen sc1
    s_add_u32 s70, s70, 7168
    buffer_load_dword v19, v2, s[32:35], s70 offen sc1
    s_add_u32 s70, s70, 93184
    buffer_load_dword v20, v2, s[32:35], s70 offen sc1
    s_add_u32 s70, s70, 7168
    buffer_load_dword v21, v2, s[32:35], s70 offen sc1
    s_add_u32 s70, s70, 7168
    buffer_load_dword v22, v2, s[32:35], s70 offen sc1
    s_add_u32 s70, s70, 7168
    buffer_load_dword v23, v2, s[32:35], s70 offen sc1
    s_add_u32 s70, s70, 7168
    s_mov_b32 exec_hi, -1
    s_waitcnt vmcnt(0)
    s_branch L_g2_done
L_st_22_g:
    s_nop 4
    buffer_store_dwordx4 v[16:19], v13, s[32:35], s14 offen offset:0 nt sc1
    s_branch L_st_22_j
L_st_23_g:
    s_nop 4
    buffer_store_dwordx4 v[32:35], v13, s[32:35], s14 offen offset:1024 nt sc1
    s_branch L_st_23_j
L_st_24_g:
    s_nop 4
    buffer_store_dwordx4 v[48:51], v13, s[32:35], s14 offen offset:2048 nt sc1
    s_branch L_st_24_j
L_st_25_g:
    s_nop 4
    buffer_store_dwordx4 v[64:67], v13, s[32:35], s14 offen offset:3072 nt sc1
    s_branch L_st_25_j
L_st_26_g:
    s_nop 4
    buffer_store_dword v241, v8, s[32:35], s11 offen offset:0 sc1
    s_branch L_st_26_j
L_st_27_g:
    s_nop 4
    buffer_store_dwordx4 v[80:83], v13, s[32:35], s15 offen offset:0 nt sc1
    s_branch L_st_27_j
L_st_28_g:
    s_nop 4
    buffer_store_dwordx4 v[96:99], v13, s[32:35], s15 offen offset:1024 nt sc1
    s_branch L_st_28_j
L_st_29_g:
    s_nop 4
    buffer_store_dword v241, v8, s[32:35], s12 offen offset:128 sc1
    s_branch L_st_29_j
L_st_30_g:
    s_nop 4
    buffer_store_dwordx4 v[112:115], v13, s[32:35], s15 offen offset:2048 nt sc1
    s_branch L_st_30_j
L_st_31_g:
    s_nop 4
    buffer_store_dwordx4 v[128:131], v13, s[32:35], s15 offen offset:3072 nt sc1
    s_branch L_st_31_j
L_st_32_g:
    s_nop 4
    buffer_store_dword v241, v8, s[32:35], s11 offen offset:128 sc1
    s_branch L_st_32_j
L_code_end:
.section .rodata,"a"
.p2align 6
.amdhsa_kernel adaLN_cond__grouped_kv_mqa__glu_gated_reglu__prompt_kernel
  .amdhsa_next_free_vgpr 512
  .amdhsa_next_free_sgpr 102
  .amdhsa_accum_offset 256
  .amdhsa_group_segment_fixed_size 0
  .amdhsa_kernarg_size 112
  .amdhsa_user_sgpr_count 2
  .amdhsa_user_sgpr_kernarg_segment_ptr 1
  .amdhsa_system_sgpr_workgroup_id_x 1
.end_amdhsa_kernel
```
